```python
import torch

def _softmax(x, axis=-1):
    return torch.softmax(x, dim=axis)
def _gelu(x):
    return torch.nn.functional.gelu(x, approximate="tanh")
def _silu(x):
    return torch.nn.functional.silu(x)
def _sigmoid(x):
    return torch.sigmoid(x)
def _layernorm(x, axis=-1, eps=1e-5):
    m = x.mean(dim=axis, keepdim=True)
    v = x.var(dim=axis, keepdim=True, unbiased=False)
    return (x - m) / torch.sqrt(v + eps)
def _scatter_add(tgt, idx, src, axis=0):
    return tgt.clone().index_add_(axis, idx, src)
def _segment_sum(src, seg, n):
    out = torch.zeros((n,) + src.shape[1:], dtype=src.dtype)
    return out.index_add_(0, seg, src)
def _pad(x, pw):
    flat = tuple(v for pair in reversed(pw) for v in pair)
    return torch.nn.functional.pad(x, flat)

kernel_name = 'interleave_layers__linear_attn_block__linear_kernel_hedgehog__prompt'

def setup_inputs():

    _w = (lambda a: (lambda t: t.to(torch.bfloat16) if t.is_floating_point() else t)(torch.as_tensor(a)))
    def _A_setup():
        B, S, D = 1, 2048, 640
        return {
            "x": _w((lambda *s: torch.randn(*s, dtype=torch.bfloat16) * 0.4)(B, S, D)),
            "wqkv": _w((lambda *s: torch.randn(*s, dtype=torch.bfloat16) * 0.8)(D, 3 * D)),
            "wo": _w((lambda *s: torch.randn(*s, dtype=torch.bfloat16) * 0.8)(D, D)),
        }
    _A_in = _A_setup()

    def _B_setup():
        B, S, D, H = 1, 2048, 640, 32
        Dh = D // H
        return {
            "x": _w((lambda *s: torch.randn(*s, dtype=torch.bfloat16) * 0.4)(B, S, D)),
            "wqkv": _w((lambda *s: torch.randn(*s, dtype=torch.bfloat16) * 0.8)(D, 3 * D)),
            "w_phi": _w((lambda *s: torch.randn(*s, dtype=torch.bfloat16) * 0.8)(H, Dh, Dh) * (Dh ** -0.5)),
            "wo": _w((lambda *s: torch.randn(*s, dtype=torch.bfloat16) * 0.4)(D, D)),
        }
    _B_in = _B_setup()

    return {
        "A_x": _A_in["x"],
        "A_wqkv": _A_in["wqkv"],
        "A_wo": _A_in["wo"],
        "B_x": _B_in["x"],
        "B_wqkv": _B_in["wqkv"],
        "B_w_phi": _B_in["w_phi"],
        "B_wo": _B_in["wo"],
    }

def reference(A_x, A_wqkv, A_wo, B_x, B_wqkv, B_w_phi, B_wo):
    def _A_ref(x, wqkv, wo):
        B, S, D = x.shape
        H = 32; Dh = D // H
        qkv = (lambda x, *d: x.permute(*d))((x @ wqkv).reshape(B, S, 3, H, Dh), 2, 0, 3, 1, 4)
        q, k, v = qkv[0], qkv[1], qkv[2]
        phi = lambda t: torch.where(t > 0, t + 1, torch.exp(t)) + 1e-6
        pq, pk = phi(q), phi(k)
        kv = torch.einsum("bhsd,bhse->bhde", pk, v)
        z = torch.einsum("bhsd->bhd", pk)
        num = torch.einsum("bhqd,bhde->bhqe", pq, kv)
        den = torch.einsum("bhqd,bhd->bhq", pq, z)[..., None] + 1e-6
        o = num / den
        return (lambda x, *d: x.permute(*d))(o, 0, 2, 1, 3).reshape(B, S, D) @ wo

    def _B_ref(x, wqkv, w_phi, wo):
        B, S, D = x.shape
        H = 32; Dh = D // H
        qkv = (lambda x, *d: x.permute(*d))((x @ wqkv).reshape(B, S, 3, H, Dh), 2, 0, 3, 1, 4)
        q, k, v = qkv[0], qkv[1], qkv[2]
        pq = torch.einsum("bhsd,hdf->bhsf", q, w_phi)
        pk = torch.einsum("bhsd,hdf->bhsf", k, w_phi)
        phi_q = torch.concatenate([_softmax(pq, axis=-1), _softmax(-pq, axis=-1)], axis=-1)
        phi_k = torch.concatenate([_softmax(pk, axis=-1), _softmax(-pk, axis=-1)], axis=-1)
        kv = torch.einsum("bhsf,bhsd->bhfd", phi_k, v)
        z  = torch.einsum("bhsf->bhf", phi_k)
        num = torch.einsum("bhqf,bhfd->bhqd", phi_q, kv)
        den = torch.einsum("bhqf,bhf->bhq", phi_q, z)[..., None] + 1e-6
        o = num / den
        return (lambda x, *d: x.permute(*d))(o, 0, 2, 1, 3).reshape(B, S, D) @ wo

    x = A_x
    x = x + _A_ref(_layernorm(x, axis=-1), A_wqkv, A_wo)
    x = x + _B_ref(_layernorm(x, axis=-1), B_wqkv, B_w_phi, B_wo)
    x = x + _A_ref(_layernorm(x, axis=-1), A_wqkv, A_wo)
    x = x + _B_ref(_layernorm(x, axis=-1), B_wqkv, B_w_phi, B_wo)
    return x
```

```asm
; @launch kernel=pk_kernel grid=(256,1,1) block=(256,1,1) lds=163840
.amdgcn_target "amdgcn-amd-amdhsa--gfx950"
.text
.globl pk_kernel
.p2align 8
.type pk_kernel,@function
pk_kernel:
    s_load_dwordx2 s[4:5], s[0:1], 72
    s_load_dwordx16 s[64:79], s[0:1], 0
    s_memrealtime s[80:81]
    s_cmp_ge_u32 s2, 256
    s_cbranch_scc1 pk_END
    s_getpc_b64 s[30:31]
pk_pcb:
    s_lshr_b32 s32, s2, 3
    s_mul_i32 s32, s32, 2816
    v_lshrrev_b32 v2, 6, v0
    v_and_b32 v1, 63, v0
    v_min_u32 v3, 10, v1
    v_mul_u32_u24 v4, 11, v2
    v_add_lshl_u32 v3, v3, v4, 6
    v_add_u32 v3, s32, v3
    v_min_u32 v3, pk_END-pk_pcb, v3
    global_load_dword v246, v3, s[30:31]
    v_lshrrev_b32 v2, 6, v0
    v_and_b32 v0, 63, v0
    v_readfirstlane_b32 s3, v2
    v_lshlrev_b32 v1, 4, v0
    s_and_b32 s30, s2, 7
    s_lshr_b32 s31, s2, 3
    s_lshl_b32 s20, s30, 1
    s_and_b32 s30, s31, 1
    s_add_u32 s20, s20, s30
    s_lshr_b32 s21, s31, 1
    s_mov_b32 s10, 268435456
    s_mov_b32 s11, 0x00020000
    s_lshl_b32 s83, s20, 4
    s_add_u32 s83, s83, s21
    s_lshl_b32 s83, s83, 3
    s_lshr_b32 s39, s83, 1
    s_add_u32 s39, s39, 30412800
    s_lshr_b32 s28, s21, 1
    s_and_b32 s30, s21, 1
    s_lshl_b32 s82, s20, 1
    s_add_u32 s82, s82, s30
    s_lshl_b32 s30, s30, 2
    s_lshl_b32 s27, s20, 3
    s_add_u32 s27, s27, s30
    s_add_u32 s27, s27, s3
    s_lshl_b32 s25, s3, 11
    s_lshl_b32 s37, s3, 10
    s_mov_b32 s22, 400000
    s_mov_b32 s24, 0x358637bd
    s_getreg_b32 s26, hwreg(HW_REG_XCC_ID, 0, 16)
    s_mov_b32 s14, 163840
    s_mov_b32 s15, 0x00020000
    s_mov_b32 s19, 0x00020000
    s_mov_b32 s95, 0x00020000
    s_mov_b32 s99, 0x00020000
    s_mov_b32 s87, 0x00020000
    s_mov_b32 s98, 819200
    s_mul_i32 s34, s20, 163840
    s_mul_i32 s35, s21, 80
    s_sub_u32 s18, 2457600, s35
    s_mul_i32 s6, s3, 10240
    s_mul_i32 s7, s3, 61440
    s_lshl_b32 s100, s3, 12
    s_lshr_b32 s32, s20, 1
    s_sub_u32 s33, s32, 5
    s_min_u32 s32, s32, s33
    s_and_b32 s33, s20, 1
    s_mul_i32 s33, s33, 5
    s_add_u32 s29, s32, s33
    s_mul_i32 s63, s29, 245760
    s_add_u32 s7, s7, s63
    s_lshl_b32 s32, s29, 7
    s_add_u32 s6, s6, s32
    s_lshl_b32 s38, s2, 2
    s_add_u32 s38, s38, s3
    v_min_u32 v124, 59, v0
    v_mul_u32_u24 v125, 205, v124
    v_lshrrev_b32 v125, 10, v125
    v_mul_u32_u24 v125, 1200, v125
    v_lshl_add_u32 v245, v124, 4, v125
    v_lshlrev_b32 v242, 6, v124
    v_min_u32 v243, 2496, v242
    s_lshr_b32 s30, s2, 3
    s_lshl_b32 s30, s30, 2
    s_add_u32 s30, s30, s3
    s_mul_i32 s30, s30, 3840
    s_add_u32 s63, s30, s63
    s_lshl_b32 s30, s3, 7
    v_add_u32 v124, s30, v0
    v_min_u32 v124, 399, v124
    v_mul_u32_u24 v125, 205, v124
    v_lshrrev_b32 v125, 11, v125
    v_mul_u32_u24 v125, 1120, v125
    v_lshl_add_u32 v74, v124, 4, v125
    v_add_u32 v124, s30, v0
    v_add_u32 v124, 64, v124
    v_min_u32 v124, 399, v124
    v_mul_u32_u24 v125, 205, v124
    v_lshrrev_b32 v125, 11, v125
    v_mul_u32_u24 v125, 1120, v125
    v_lshl_add_u32 v75, v124, 4, v125
    v_lshrrev_b32 v124, 3, v0
    v_and_b32 v125, 6, v124
    v_mul_u32_u24 v124, 1280, v124
    v_and_b32 v126, 7, v0
    v_xor_b32 v125, v125, v126
    v_lshl_add_u32 v244, v125, 4, v124
    s_and_b32 s30, s3, 1
    s_lshl_b32 s30, s30, 4
    v_xor_b32 v244, s30, v244
    s_xor_b32 s91, s21, 1
    s_mul_i32 s30, s91, 80
    s_sub_u32 s94, 2457600, s30
    s_mul_i32 s31, s91, 1600
    s_and_b32 s32, s3, 1
    s_mul_i32 s32, s32, 800
    s_add_u32 s31, s31, s32
    s_add_u32 s86, s31, 800
    s_mul_i32 s32, s20, 153600
    s_and_b32 s33, s82, 15
    s_mul_i32 s33, s33, 51200
    s_mul_i32 s36, s28, 160
    s_add_u32 s33, s33, s36
    v_lshrrev_b32 v120, 5, v0
    v_bfe_u32 v124, v0, 3, 2
    v_and_b32 v125, 3, v0
    v_lshl_add_u32 v122, v124, 2, v125
    v_bfe_u32 v123, v0, 2, 1
    v_mul_u32_u24 v124, 20, v123
    v_lshl_add_u32 v124, v122, 1, v124
    s_add_u32 s36, s37, 150528
    v_add_u32 v73, s36, v124
    v_mul_u32_u24 v125, 320, v120
    v_add_u32 v72, v73, v125
    s_waitcnt lgkmcnt(0)
    s_mov_b32 s8, s4
    s_and_b32 s9, s5, 0xffff
    s_add_u32 s92, s72, s30
    s_addc_u32 s93, s73, 0
    s_and_b32 s93, s93, 0xffff
    v_mov_b32 v2, s80
    s_cmp_lg_u32 s3, 2
    s_cbranch_scc1 pk_noar
    s_mov_b64 exec, 1
    buffer_store_dword v2, off, s[8:11], s39 sc1
    s_mov_b64 exec, -1
pk_noar:
    s_add_u32 s12, s64, s34
    s_addc_u32 s13, s65, 0
    s_and_b32 s13, s13, 0xffff
    s_add_u32 s16, s66, s35
    s_addc_u32 s17, s67, 0
    s_and_b32 s17, s17, 0xffff
    s_add_u32 s34, s3, 0
    s_mul_i32 s35, s34, 15360
    s_add_u32 s35, s35, s32
    s_lshl_b32 s34, s34, 10
    s_add_u32 m0, s34, 132096
    s_nop 0
    buffer_load_dwordx4 v245, s[92:95], s35 offen lds
    s_add_u32 s34, s3, 4
    s_mul_i32 s35, s34, 15360
    s_add_u32 s35, s35, s32
    s_lshl_b32 s34, s34, 10
    s_add_u32 m0, s34, 132096
    s_nop 0
    buffer_load_dwordx4 v245, s[92:95], s35 offen lds
    s_add_u32 s34, s3, 8
    s_min_u32 s34, s34, 9
    s_mul_i32 s35, s34, 15360
    s_add_u32 s35, s35, s32
    s_lshl_b32 s34, s34, 10
    s_add_u32 m0, s34, 132096
    s_nop 0
    buffer_load_dwordx4 v245, s[92:95], s35 offen lds
    s_mov_b32 s84, s74
    s_and_b32 s85, s75, 0xffff
    s_mov_b32 m0, s36
    s_cmp_ge_u32 s82, 16
    s_cselect_b32 s96, s76, s68
    s_cselect_b32 s97, s77, s69
    s_and_b32 s97, s97, 0xffff
    buffer_load_dwordx4 v1, s[84:87], s31 offen lds
    s_add_u32 m0, s25, 142336
    s_nop 0
    buffer_load_dwordx4 v74, s[96:99], s33 offen lds
    s_add_u32 m0, s25, 143360
    s_nop 0
    buffer_load_dwordx4 v75, s[96:99], s33 offen lds
    s_mov_b32 s92, s66
    s_and_b32 s93, s67, 0xffff
    s_mov_b32 s94, 2457600
    s_mul_i32 s30, s21, 10240
    s_mul_i32 s31, s3, 2560
    s_add_u32 s30, s30, s31
    buffer_load_dword v247, v243, s[12:15], s30 offen
    s_add_u32 s101, s7, 0
    s_add_u32 m0, s100, 0
    s_nop 0
    buffer_load_dwordx4 v245, s[16:19], s101 offen lds
    v_cmp_gt_u32 s[88:89], 10, v122
    s_cmp_lt_u32 s3, 2
    s_cselect_b32 s30, 6, 4
    s_cselect_b32 s32, 6, 4
    v_mul_u32_u24 v124, s30, v123
    v_add_u32 v124, v124, v122
    v_lshl_add_u32 v125, v120, 3, 6
    v_sub_u32 v124, v124, v125
    v_subrev_u32 v125, 10, v122
    v_cmp_gt_u32 vcc, s32, v125
    s_nop 1
    v_cndmask_b32 v124, 64, v124, vcc
    v_and_b32 v125, 1, v124
    v_lshlrev_b32 v125, 4, v125
    v_mov_b32 v126, 0x3f80
    v_lshlrev_b32 v125, v125, v126
    v_lshrrev_b32 v124, 1, v124
    v_cmp_eq_u32 vcc, 0, v124
    s_nop 1
    v_cndmask_b32 v80, 0, v125, vcc
    v_cmp_eq_u32 vcc, 1, v124
    s_nop 1
    v_cndmask_b32 v81, 0, v125, vcc
    v_cmp_eq_u32 vcc, 2, v124
    s_nop 1
    v_cndmask_b32 v82, 0, v125, vcc
    v_cmp_eq_u32 vcc, 3, v124
    s_nop 1
    v_cndmask_b32 v83, 0, v125, vcc
    v_bfe_u32 v124, v0, 4, 1
    v_lshl_add_u32 v124, v124, 1, v123
    v_bfe_u32 v125, v0, 3, 1
    v_lshl_add_u32 v124, v124, 1, v125
    v_and_b32 v125, 3, v0
    v_mul_u32_u24 v125, 240, v125
    v_lshl_add_u32 v124, v124, 10, v125
    v_lshl_add_u32 v125, v120, 4, v124
    s_and_b32 s33, s3, 1
    s_mul_i32 s33, s33, 40
    s_add_u32 s33, s33, 132096
    s_cmp_lt_u32 s3, 2
    s_cselect_b32 s30, 80, 0
    s_cselect_b32 s32, 0, 24
    s_add_u32 s32, s32, 160
    s_add_u32 s30, s30, s33
    s_add_u32 s32, s32, s33
    v_add_u32 v100, s30, v125
    v_add_u32 v102, s32, v125
    v_add_u32 v126, 32, v100
    v_subrev_u32 v127, 8, v102
    v_cmp_gt_u32 vcc, 32, v0
    s_nop 1
    v_cndmask_b32 v101, v127, v126, vcc
    v_lshrrev_b32 v120, 4, v0
    v_bfe_u32 v121, v0, 2, 2
    v_and_b32 v122, 3, v0
    v_mul_u32_u24 v124, 10, v120
    v_add_u32 v124, v124, v121
    v_mul_u32_u24 v124, 160, v124
    s_and_b32 s30, s3, 1
    s_lshl_b32 s30, s30, 3
    s_lshr_b32 s32, s3, 1
    s_lshl_b32 s32, s32, 6
    s_add_u32 s30, s30, s32
    s_add_u32 s30, s30, 142336
    v_lshl_add_u32 v125, v122, 4, s30
    v_add_u32 v104, v124, v125
    v_bfe_u32 v125, v0, 3, 1
    v_mul_u32_u24 v125, 18, v125
    v_add3_u32 v125, v125, v121, 8
    v_mul_u32_u24 v125, 160, v125
    s_cmp_eq_u32 s3, 1
    s_cselect_b64 vcc, -1, 0
    s_movk_i32 s32, 1600
    s_cselect_b32 s32, 640, s32
    v_cndmask_b32 v124, v125, v124, vcc
    v_cndmask_b32 v123, 4, v120, vcc
    v_and_b32 v125, 1, v120
    v_lshlrev_b32 v125, 3, v125
    v_lshl_add_u32 v125, v122, 4, v125
    v_lshrrev_b32 v126, 1, v120
    v_lshl_add_u32 v125, v126, 6, v125
    v_lshlrev_b32 v126, 3, v122
    v_add_u32 v126, 0x80, v126
    s_cmp_eq_u32 s3, 0
    s_cselect_b64 vcc, -1, 0
    v_cndmask_b32 v125, v126, v125, vcc
    v_cndmask_b32 v127, 4, v120, vcc
    s_mov_b32 s30, 142336
    v_add3_u32 v105, v124, v125, s30
    v_add_u32 v106, s32, v105
    s_and_b32 s30, s82, 15
    s_mul_i32 s30, s30, 5
    v_and_b32 v126, 0xf0, v1
    v_add_u32 v124, s30, v120
    v_lshrrev_b32 v125, 2, v124
    v_and_b32 v124, 3, v124
    v_mul_u32_u24 v125, 5, v125
    v_add_u32 v125, s3, v125
    v_lshl_add_u32 v124, v124, 8, v126
    v_lshl_add_u32 v107, v125, 10, v124
    v_add_u32 v124, s30, v123
    v_lshrrev_b32 v125, 2, v124
    v_and_b32 v124, 3, v124
    v_mul_u32_u24 v125, 5, v125
    v_add_u32 v125, v127, v125
    v_lshl_add_u32 v124, v124, 8, v126
    v_lshl_add_u32 v108, v125, 10, v124
    s_mul_i32 s35, s3, 40960
    s_mul_i32 s90, s21, 163840
    s_add_u32 s90, s90, s35
    s_mul_i32 s34, s91, 163840
    s_add_u32 s34, s34, s35
    s_mul_i32 s35, s20, 2560
    s_add_u32 s34, s34, s35
    s_add_u32 s34, s34, 2621440
    s_lshr_b32 s35, s82, 4
    s_mul_i32 s35, s35, 851968
    s_mul_i32 s30, s28, 102400
    s_add_u32 s35, s35, s30
    s_add_u32 s35, s35, 5373952
    v_and_b32 v132, 31, v0
    v_lshlrev_b32 v132, 7, v132
    v_and_b32 v133, 6, v0
    v_bfe_u32 v134, v0, 3, 1
    v_lshrrev_b32 v135, 5, v0
    v_xor_b32 v133, v133, v134
    v_xor_b32 v133, v133, v135
    v_lshl_add_u32 v112, v133, 4, v132
    v_xor_b32 v113, 32, v112
    v_xor_b32 v114, 64, v112
    v_xor_b32 v115, 96, v112
    v_and_b32 v132, 15, v0
    v_lshl_add_u32 v132, v132, 7, s100
    v_bfe_u32 v134, v0, 3, 2
    v_lshrrev_b32 v135, 5, v0
    v_and_b32 v133, 6, v0
    v_xor_b32 v133, v133, v134
    v_xor_b32 v133, v133, v135
    v_lshl_add_u32 v128, v133, 4, v132
    v_xor_b32 v129, 64, v128
    s_bitcmp1_b32 s3, 0
    s_mov_b32 s30, 353766925
    s_mov_b32 s33, 336333578
    s_cselect_b32 s30, s30, s33
    s_mov_b32 s33, 404227075
    s_mov_b32 s32, 386007296
    s_cselect_b32 s33, s33, s32
    s_bitcmp1_b32 s3, 1
    s_cselect_b32 s30, s33, s30
    v_bfe_u32 v132, v0, 4, 1
    v_bfe_u32 v133, v0, 1, 1
    v_lshl_add_u32 v132, v132, 1, v133
    v_lshlrev_b32 v132, 3, v132
    v_lshrrev_b32 v132, v132, s30
    v_and_b32 v132, 31, v132
    v_and_b32 v133, 1, v0
    v_mul_u32_u24 v133, 5, v133
    v_bfe_u32 v134, v0, 2, 2
    v_mul_u32_u24 v134, 30, v134
    v_add3_u32 v132, v132, v133, v134
    v_lshrrev_b32 v133, 5, v0
    v_lshlrev_b32 v133, 11, v133
    v_lshl_add_u32 v116, v132, 3, v133
    s_add_u32 s36, s83, 30429184
    s_add_u32 s39, s83, 30425088
    v_mov_b32 v235, s26
    v_mov_b32 v236, 131072
    v_lshrrev_b32 v132, 2, v0
    v_xor_b32 v132, v132, v0
    v_and_b32 v132, 4, v132
    v_cmp_eq_u32 vcc, 0, v132
    v_mov_b32 v132, 0x3f803f80
    s_nop 0
    v_cndmask_b32 v8, 0, v132, vcc
    v_cndmask_b32 v9, 0, v132, vcc
    v_cndmask_b32 v10, 0, v132, vcc
    v_cndmask_b32 v11, 0, v132, vcc
    v_bfe_u32 v6, v0, 4, 1
    v_lshrrev_b32 v7, 5, v0
    v_lshlrev_b32 v6, 10, v6
    v_lshl_add_u32 v6, v7, 9, v6
    v_and_b32 v7, 15, v0
    v_lshl_add_u32 v42, v7, 3, v6
    s_and_b32 s30, s3, 1
    s_lshl_b32 s30, s30, 8
    v_lshlrev_b32 v7, 4, v7
    v_add_u32 v7, s30, v7
    v_lshrrev_b32 v6, 4, v0
    v_lshl_add_u32 v43, v6, 9, v7
    v_lshrrev_b32 v2, 5, v0
    v_lshl_add_u32 v7, v2, 9, v7
    v_and_b32 v6, 1, v6
    v_lshl_add_u32 v7, v6, 3, v7
    v_add_u32 v44, 0x1000, v7
    v_add_u32 v30, 0x10000, v1
    v_add_u32 v31, 0x20000, v1
    v_and_b32 v6, 31, v0
    v_lshrrev_b32 v7, 5, v0
    v_lshlrev_b32 v41, 3, v6
    v_add_u32 v41, 162816, v41
    v_mul_u32_u24 v6, 296, v6
    v_lshl_add_u32 v6, v7, 6, v6
    s_and_b32 s30, s3, 1
    s_lshl_b32 s30, s30, 7
    v_add_u32 v32, s30, v6
    s_mul_i32 s30, s3, 9472
    s_add_u32 s30, s30, 18944
    v_add_u32 v47, s30, v6
    v_lshrrev_b32 v6, 2, v0
    v_mul_u32_u24 v6, 296, v6
    s_lshr_b32 s30, s3, 1
    s_lshl_b32 s30, s30, 7
    v_add_u32 v6, s30, v6
    v_and_b32 v7, 3, v0
    v_add_u32 v132, 0, v7
    v_min_u32 v132, 9, v132
    v_cmp_le_u32 vcc, 5, v132
    s_nop 1
    v_cndmask_b32 v133, 0, 24, vcc
    v_lshl_add_u32 v132, v132, 3, v133
    v_add_u32 v34, v132, v6
    v_add_u32 v132, 4, v7
    v_min_u32 v132, 9, v132
    v_cmp_le_u32 vcc, 5, v132
    s_nop 1
    v_cndmask_b32 v133, 0, 24, vcc
    v_lshl_add_u32 v132, v132, 3, v133
    v_add_u32 v35, v132, v6
    v_add_u32 v132, 8, v7
    v_min_u32 v132, 9, v132
    v_cmp_le_u32 vcc, 5, v132
    s_nop 1
    v_cndmask_b32 v133, 0, 24, vcc
    v_lshl_add_u32 v132, v132, 3, v133
    v_add_u32 v36, v132, v6
    v_add_u32 v132, 0, v7
    v_min_u32 v132, 5, v132
    v_cmp_le_u32 vcc, 3, v132
    s_nop 1
    v_cndmask_b32 v133, 0, 40, vcc
    v_lshl_add_u32 v132, v132, 3, v133
    v_add_u32 v37, v132, v6
    v_add_u32 v132, 4, v7
    v_min_u32 v132, 5, v132
    v_cmp_le_u32 vcc, 3, v132
    s_nop 1
    v_cndmask_b32 v133, 0, 40, vcc
    v_lshl_add_u32 v132, v132, 3, v133
    v_add_u32 v38, v132, v6
    v_lshrrev_b32 v132, 1, v7
    v_and_b32 v133, 1, v7
    v_lshlrev_b32 v132, 6, v132
    v_lshl_add_u32 v132, v133, 3, v132
    v_lshlrev_b32 v133, 6, v133
    s_bitcmp1_b32 s3, 0
    s_cselect_b64 vcc, -1, 0
    v_cndmask_b32 v132, v132, v133, vcc
    v_add3_u32 v39, v132, v6, 48
    v_bfe_u32 v132, v0, 3, 2
    v_and_b32 v133, 3, v0
    v_lshl_add_u32 v132, v132, 2, v133
    v_bfe_u32 v133, v0, 2, 1
    v_mul_u32_u24 v133, 10, v133
    v_add_u32 v133, v133, v132
    v_cmp_gt_u32 s[30:31], 10, v132
    v_lshrrev_b32 v132, 5, v0
    v_cmp_le_u32 vcc, 6, v133
    s_nop 1
    v_cndmask_b32 v134, 0, 2, vcc
    v_cmp_le_u32 vcc, 12, v133
    s_nop 1
    v_cndmask_b32 v135, 0, 2, vcc
    v_add3_u32 v134, v133, v134, v135
    v_cndmask_b32 v134, 6, v134, s[30:31]
    v_lshrrev_b32 v135, 3, v134
    v_lshl_add_u32 v135, v135, 1, v132
    v_and_b32 v134, 7, v134
    v_mul_u32_u24 v135, 320, v135
    v_lshl_add_u32 v46, v134, 3, v135
    v_cmp_le_u32 vcc, 4, v133
    s_nop 1
    v_cndmask_b32 v134, 0, 4, vcc
    v_add_u32 v134, v133, v134
    v_cndmask_b32 v134, 4, v134, s[30:31]
    v_lshrrev_b32 v135, 3, v134
    v_lshl_add_u32 v135, v135, 1, v132
    v_and_b32 v134, 7, v134
    v_mul_u32_u24 v135, 192, v135
    v_lshl_add_u32 v45, v134, 3, v135
    v_mov_b32 v184, -1
    v_mov_b32 v185, -1
    v_mov_b32 v186, -1
    v_mov_b32 v187, -1
    v_mov_b32 v151, 0x3f80
    v_lshrrev_b32 v133, 5, v0
    s_and_b32 s30, s3, 1
    v_subrev_u32 v133, s30, v133
    v_lshl_add_u32 v32, v133, 6, v32
    v_bfe_u32 v132, v0, 3, 1
    v_lshrrev_b32 v133, 4, v0
    s_lshr_b32 s30, s3, 1
    s_mul_i32 s30, s30, 3
    s_and_b32 s31, s3, 1
    s_lshl_b32 s31, s31, 1
    v_add_u32 v132, s31, v132
    v_cmp_gt_u32 s[32:33], 3, v132
    v_add_u32 v132, s30, v132
    v_mul_u32_u24 v132, 6, v132
    v_add_u32 v132, v132, v133
    v_mov_b32 v136, 1073741824
    v_and_b32 v134, 7, v0
    v_lshlrev_b32 v134, 4, v134
    v_lshl_add_u32 v132, v132, 11, v134
    v_cndmask_b32 v188, v136, v132, s[32:33]
    v_add_u32 v189, 8192, v188
    v_cmp_gt_u32 vcc, 2, v133
    s_nop 1
    v_cndmask_b32 v189, v136, v189, vcc
    s_cmp_lg_u32 s38, 2
    s_cbranch_scc1 pk_nm
    s_mov_b32 s101, 30412800
    s_mov_b32 s87, 30425088
    s_mov_b32 s84, 8
    v_lshlrev_b32 v220, 5, v0
    s_sub_u32 s85, 1000, s80
    s_movk_i32 s86, 0xfa0
    v_mov_b32 v225, s80
    v_mov_b32 v227, s80
    v_mov_b32 v229, s80
    v_mov_b32 v231, s80
pk_ml0:
    buffer_load_dwordx4 v[216:219], v1, s[8:11], s101 offen sc1
    s_waitcnt vmcnt(0)
    v_mov_b32 v224, v216
    v_mov_b32 v226, v217
    v_mov_b32 v228, v218
    v_mov_b32 v230, v219
    buffer_store_dwordx4 v[224:227], v220, s[8:11], s87 offen sc1
    buffer_store_dwordx4 v[228:231], v220, s[8:11], s87 offen offset:16 sc1
    v_add_u32 v216, s85, v216
    v_add_u32 v217, s85, v217
    v_add_u32 v218, s85, v218
    v_add_u32 v219, s85, v219
    v_max3_u32 v216, v216, v217, v218
    v_max_u32 v216, v216, v219
    v_cmp_lt_u32 s[96:97], s86, v216
    s_sub_u32 s84, s84, 1
    s_cbranch_scc1 pk_nm
    s_nop 4
    s_cmp_lg_u64 s[96:97], 0
    s_cbranch_scc1 pk_ml0
pk_nm:
    s_nop 4
    s_lshr_b32 s30, s21, 2
    s_xor_b32 s30, s30, s21
    s_bitcmp1_b32 s30, 0
    s_cbranch_scc1 pk_npl2
    s_lshl_b32 s30, s28, 3
    s_and_b32 s31, s20, 1
    s_lshl_b32 s31, s31, 2
    s_add_u32 s30, s30, s31
    s_add_u32 s30, s30, s3
    s_mul_i32 s30, s30, 38400
    v_mul_u32_u24 v253, 10, v242
    buffer_load_dword v253, v253, s[92:95], s30 offen offset:256
pk_npl2:
    s_add_u32 s101, s6, 0
    s_add_u32 m0, s37, 16384
    s_nop 0
    buffer_load_dwordx4 v244, s[12:15], s101 offen lds
    s_add_u32 s101, s7, 15360
    s_add_u32 m0, s100, 1024
    s_nop 0
    buffer_load_dwordx4 v245, s[16:19], s101 offen lds
    s_add_u32 s101, s6, 40960
    s_add_u32 m0, s37, 20480
    s_nop 0
    buffer_load_dwordx4 v244, s[12:15], s101 offen lds
    s_waitcnt vmcnt(5)
    s_barrier
    s_add_u32 s101, s7, 30720
    s_add_u32 m0, s100, 2048
    s_nop 0
    buffer_load_dwordx4 v245, s[16:19], s101 offen lds
    s_add_u32 s101, s6, 81920
    s_add_u32 m0, s37, 24576
    s_nop 0
    buffer_load_dwordx4 v244, s[12:15], s101 offen lds
    s_add_u32 s101, s7, 46080
    s_add_u32 m0, s100, 3072
    s_nop 0
    buffer_load_dwordx4 v245, s[16:19], s101 offen lds
    s_add_u32 s101, s6, 122880
    s_add_u32 m0, s37, 28672
    s_nop 0
    buffer_load_dwordx4 v244, s[12:15], s101 offen lds
    s_cmp_eq_u32 s29, 9
    s_cselect_b32 s101, -9, 1
    s_lshl_b32 s101, s101, 7
    s_add_u32 s6, s6, s101
    s_mul_i32 s101, s101, 1920
    s_add_u32 s7, s7, s101
    ds_read_u16 v60, v72 offset:0
    ds_read_u16 v61, v72 offset:40
    ds_read_u16 v62, v72 offset:80
    ds_read_u16 v63, v72 offset:120
    ds_read_u16 v64, v72 offset:160
    ds_read_u16 v65, v72 offset:200
    ds_read_u16 v66, v72 offset:240
    ds_read_u16 v67, v72 offset:280
    ds_read_u16 v68, v73 offset:640
    ds_read_u16 v69, v73 offset:680
    s_add_u32 s101, s7, 0
    s_add_u32 m0, s100, 32768
    s_nop 0
    buffer_load_dwordx4 v245, s[16:19], s101 offen lds
    ds_read_u16 v70, v73 offset:720
    ds_read_u16 v71, v73 offset:760
    ds_read_b64_tr_b16 v[48:49], v104
    ds_read_b64_tr_b16 v[50:51], v104 offset:640
    ds_read_b64_tr_b16 v[52:53], v105
    ds_read_b64_tr_b16 v[54:55], v106
    ds_read_b64 v[84:85], v100 offset:0
    ds_read_b64 v[86:87], v100 offset:8
    ds_read_b64 v[88:89], v101 offset:0
    ds_read_b64 v[90:91], v102 offset:0
    s_add_u32 s101, s6, 0
    s_add_u32 m0, s37, 49152
    s_nop 0
    buffer_load_dwordx4 v244, s[12:15], s101 offen lds
    ds_read_b64 v[92:93], v100 offset:8192
    ds_read_b64 v[94:95], v100 offset:8200
    ds_read_b64 v[96:97], v101 offset:8192
    ds_read_b64 v[98:99], v102 offset:8192
    s_waitcnt lgkmcnt(12)
    v_lshl_or_b32 v60, v61, 16, v60
    v_lshl_or_b32 v62, v63, 16, v62
    v_lshl_or_b32 v64, v65, 16, v64
    v_lshl_or_b32 v66, v67, 16, v66
    v_lshl_or_b32 v68, v69, 16, v68
    s_add_u32 s101, s7, 15360
    s_add_u32 m0, s100, 33792
    s_nop 0
    buffer_load_dwordx4 v245, s[16:19], s101 offen lds
    v_lshl_or_b32 v70, v71, 16, v70
    v_cndmask_b32 v76, 0, v60, s[88:89]
    v_cndmask_b32 v77, 0, v62, s[88:89]
    v_cndmask_b32 v78, 0, v64, s[88:89]
    v_cndmask_b32 v79, 0, v66, s[88:89]
    s_mov_b32 s89, 0
    v_cndmask_b32 v80, v80, v68, s[88:89]
    v_cndmask_b32 v81, v81, v70, s[88:89]
    s_waitcnt lgkmcnt(4)
    v_mfma_f32_32x32x16_bf16 v[192:207], v[84:87], v[76:79], 0
    s_add_u32 s101, s6, 40960
    s_add_u32 m0, s37, 53248
    s_nop 0
    buffer_load_dwordx4 v244, s[12:15], s101 offen lds
    v_mfma_f32_32x32x16_bf16 v[192:207], v[88:91], v[80:83], v[192:207]
    s_waitcnt lgkmcnt(0)
    v_mfma_f32_32x32x16_bf16 v[208:223], v[92:95], v[76:79], 0
    v_mfma_f32_32x32x16_bf16 v[208:223], v[96:99], v[80:83], v[208:223]
    buffer_store_dwordx4 v[48:51], v107, s[8:11], s35 offen sc1
    buffer_store_dwordx4 v[52:55], v108, s[8:11], s35 offen sc1
    s_nop 6
    v_cvt_pk_bf16_f32 v192, v192, v193
    v_cvt_pk_bf16_f32 v193, v194, v195
    v_cvt_pk_bf16_f32 v194, v196, v197
    v_cvt_pk_bf16_f32 v195, v198, v199
    s_add_u32 s101, s7, 30720
    s_add_u32 m0, s100, 34816
    s_nop 0
    buffer_load_dwordx4 v245, s[16:19], s101 offen lds
    v_cvt_pk_bf16_f32 v196, v200, v201
    v_cvt_pk_bf16_f32 v197, v202, v203
    v_cvt_pk_bf16_f32 v198, v204, v205
    v_cvt_pk_bf16_f32 v199, v206, v207
    v_cvt_pk_bf16_f32 v200, v208, v209
    v_cvt_pk_bf16_f32 v201, v210, v211
    v_cvt_pk_bf16_f32 v202, v212, v213
    v_cvt_pk_bf16_f32 v203, v214, v215
    buffer_store_dwordx4 v[192:195], v1, s[8:11], s34 offen sc1
    buffer_store_dwordx4 v[196:199], v1, s[8:11], s34 offen offset:1024 sc1
    s_mov_b32 exec_hi, 0
    buffer_store_dwordx4 v[200:203], v1, s[8:11], s34 offen offset:2048 sc1
    s_mov_b64 exec, -1
    s_bitcmp1_b32 s3, 0
    s_cselect_b32 s84, 0xff800000, 0
    s_cselect_b32 s85, 0, s24
    s_cselect_b32 s86, 0, 1.0
    s_cselect_b64 s[88:89], 0, -1
    s_lshr_b32 s82, s21, 2
    s_xor_b32 s82, s82, s21
    s_xor_b32 s62, s27, 4
    s_add_u32 s101, s6, 81920
    s_add_u32 m0, s37, 57344
    s_nop 0
    buffer_load_dwordx4 v244, s[12:15], s101 offen lds
    s_add_u32 s101, s7, 46080
    s_add_u32 m0, s100, 35840
    s_nop 0
    buffer_load_dwordx4 v245, s[16:19], s101 offen lds
    s_add_u32 s101, s6, 122880
    s_add_u32 m0, s37, 61440
    s_nop 0
    buffer_load_dwordx4 v244, s[12:15], s101 offen lds
    s_cmp_eq_u32 s29, 8
    s_cselect_b32 s101, -9, 1
    s_lshl_b32 s101, s101, 7
    s_add_u32 s6, s6, s101
    s_mul_i32 s101, s101, 1920
    s_add_u32 s7, s7, s101
    s_add_u32 s101, s7, 0
    s_add_u32 m0, s100, 65536
    s_nop 0
    buffer_load_dwordx4 v245, s[16:19], s101 offen lds
    s_add_u32 s101, s6, 0
    s_add_u32 m0, s37, 81920
    s_nop 0
    buffer_load_dwordx4 v244, s[12:15], s101 offen lds
    s_add_u32 s101, s7, 15360
    s_add_u32 m0, s100, 66560
    s_nop 0
    buffer_load_dwordx4 v245, s[16:19], s101 offen lds
    s_add_u32 s101, s6, 40960
    s_add_u32 m0, s37, 86016
    s_nop 0
    buffer_load_dwordx4 v244, s[12:15], s101 offen lds
    s_add_u32 s101, s7, 30720
    s_add_u32 m0, s100, 67584
    s_nop 0
    buffer_load_dwordx4 v245, s[16:19], s101 offen lds
    s_add_u32 s101, s6, 81920
    s_add_u32 m0, s37, 90112
    s_nop 0
    buffer_load_dwordx4 v244, s[12:15], s101 offen lds
    s_add_u32 s101, s7, 46080
    s_add_u32 m0, s100, 68608
    s_nop 0
    buffer_load_dwordx4 v245, s[16:19], s101 offen lds
    s_add_u32 s101, s6, 122880
    s_add_u32 m0, s37, 94208
    s_nop 0
    buffer_load_dwordx4 v244, s[12:15], s101 offen lds
    s_cmp_eq_u32 s29, 7
    s_cselect_b32 s101, -9, 1
    s_lshl_b32 s101, s101, 7
    s_add_u32 s6, s6, s101
    s_mul_i32 s101, s101, 1920
    s_add_u32 s7, s7, s101
    s_waitcnt vmcnt(21)
    s_waitcnt lgkmcnt(0)
    s_barrier
    ds_read_b64_tr_b16 a[0:1], v116 offset:0
    ds_read_b64_tr_b16 a[2:3], v116 offset:1024
    ds_read_b128 v[80:83], v112 offset:16384
    ds_read_b128 v[84:87], v112 offset:20480
    ds_read_b64_tr_b16 a[4:5], v116 offset:4096
    ds_read_b64_tr_b16 a[6:7], v116 offset:5120
    ds_read_b128 v[88:91], v112 offset:24576
    ds_read_b128 v[92:95], v112 offset:28672
    ds_read_b128 v[96:99], v113 offset:16384
    ds_read_b128 v[100:103], v113 offset:20480
    ds_read_b64_tr_b16 a[8:9], v116 offset:8192
    ds_read_b64_tr_b16 a[10:11], v116 offset:9216
    ds_read_b128 v[104:107], v113 offset:24576
    ds_read_b128 v[108:111], v113 offset:28672
    s_waitcnt lgkmcnt(12)
    s_waitcnt lgkmcnt(11)
    v_mfma_f32_32x32x16_bf16 v[48:63], a[0:3], v[80:83], 0
    ds_read_b128 v[80:83], v114 offset:16384
    ds_read_b128 v[12:15], v128 offset:16384
    ds_read_b128 v[16:19], v128 offset:18432
    ds_read_b128 v[138:141], v129 offset:16384
    ds_read_b128 v[142:145], v129 offset:18432
    s_add_u32 s101, s7, 0
    s_add_u32 m0, s100, 98304
    s_nop 0
    buffer_load_dwordx4 v245, s[16:19], s101 offen lds
    s_waitcnt lgkmcnt(15)
    v_mfma_f32_32x32x16_bf16 v[64:79], a[0:3], v[84:87], 0
    ds_read_b128 v[84:87], v114 offset:20480
    s_add_u32 s101, s6, 0
    s_add_u32 m0, s37, 114688
    s_nop 0
    buffer_load_dwordx4 v244, s[12:15], s101 offen lds
    v_mfma_f32_16x16x32_bf16 v[224:227], v[8:11], a[0:3], 0
    s_waitcnt lgkmcnt(13)
    v_mfma_f32_32x32x16_bf16 v[192:207], a[0:3], v[88:91], 0
    ds_read_b64_tr_b16 a[12:13], v116 offset:12288
    ds_read_b64_tr_b16 a[14:15], v116 offset:13312
    ds_read_b128 v[88:91], v114 offset:24576
    v_lshrrev_b32 v136, 3, v0
    v_and_b32 v137, 7, v0
    v_lshlrev_b32 v136, 11, v136
    v_lshl_add_u32 v136, v137, 4, v136
    s_mul_i32 s30, s21, 131072
    s_lshl_b32 s31, s20, 7
    s_add_u32 s30, s30, s31
    s_lshl_b32 s31, s3, 15
    s_add_u32 s30, s30, s31
    s_add_u32 s30, s30, 41943040
    buffer_store_dwordx4 v[184:187], v136, s[8:11], s30 offen sc1
    s_add_u32 s30, s30, 16384
    buffer_store_dwordx4 v[184:187], v136, s[8:11], s30 offen sc1
    s_waitcnt lgkmcnt(7)
    v_mfma_f32_16x16x32_bf16 v[160:163], v[8:11], v[12:15], 0
    v_mfma_f32_32x32x16_bf16 v[208:223], a[0:3], v[92:95], 0
    ds_read_b128 v[92:95], v114 offset:28672
    s_add_u32 s101, s7, 15360
    s_add_u32 m0, s100, 99328
    s_nop 0
    buffer_load_dwordx4 v245, s[16:19], s101 offen lds
    v_mfma_f32_16x16x32_bf16 v[152:155], v[12:15], v[12:15], 0
    v_mfma_f32_32x32x16_bf16 v[48:63], a[4:7], v[96:99], v[48:63]
    ds_read_b128 v[96:99], v115 offset:16384
    s_add_u32 s101, s6, 40960
    s_add_u32 m0, s37, 118784
    s_nop 0
    buffer_load_dwordx4 v244, s[12:15], s101 offen lds
    s_waitcnt lgkmcnt(8)
    v_mfma_f32_16x16x32_bf16 v[164:167], v[8:11], v[16:19], 0
    v_mfma_f32_16x16x32_bf16 v[156:159], v[16:19], v[16:19], 0
    v_mfma_f32_32x32x16_bf16 v[64:79], a[4:7], v[100:103], v[64:79]
    ds_read_b128 v[100:103], v115 offset:20480
    s_add_u32 s101, s7, 30720
    s_add_u32 m0, s100, 100352
    s_nop 0
    buffer_load_dwordx4 v245, s[16:19], s101 offen lds
    s_waitcnt lgkmcnt(8)
    v_mfma_f32_16x16x32_bf16 v[160:163], v[8:11], v[138:141], v[160:163]
    v_mfma_f32_16x16x32_bf16 v[224:227], v[8:11], a[4:7], v[224:227]
    v_mfma_f32_32x32x16_bf16 v[192:207], a[4:7], v[104:107], v[192:207]
    ds_read_b128 v[104:107], v115 offset:24576
    v_lshrrev_b32 v136, 3, v0
    v_lshlrev_b32 v136, 17, v136
    v_lshl_add_u32 v136, v137, 4, v136
    s_lshl_b32 s30, s21, 13
    s_lshl_b32 s31, s20, 7
    s_add_u32 s30, s30, s31
    s_add_u32 s30, s30, s25
    s_add_u32 s30, s30, 50331648
    buffer_store_dwordx4 v[184:187], v136, s[8:11], s30 offen sc1
    s_lshl_b32 s31, s20, 13
    s_add_u32 s31, s31, s25
    s_lshl_b32 s32, s21, 7
    s_add_u32 s31, s31, s32
    s_add_u32 s31, s31, 29491200
    s_lshl_b32 s32, s27, 10
    s_lshl_b32 s33, s28, 7
    s_add_u32 s32, s32, s33
    s_add_u32 s32, s32, 29360128
    s_mov_b64 exec, 0xff
    buffer_store_dwordx4 v[184:187], v1, s[8:11], s32 offen sc1
    s_mov_b64 exec, 0xf
    buffer_store_dwordx4 v[184:187], v1, s[8:11], s31 offen sc1
    s_mov_b64 exec, -1
    v_mfma_f32_16x16x32_bf16 v[152:155], v[138:141], v[138:141], v[152:155]
    s_waitcnt lgkmcnt(8)
    v_mfma_f32_16x16x32_bf16 v[164:167], v[8:11], v[142:145], v[164:167]
    v_mfma_f32_32x32x16_bf16 v[208:223], a[4:7], v[108:111], v[208:223]
    ds_read_b128 v[108:111], v115 offset:28672
    s_add_u32 s101, s6, 81920
    s_add_u32 m0, s37, 122880
    s_nop 0
    buffer_load_dwordx4 v244, s[12:15], s101 offen lds
    v_mfma_f32_16x16x32_bf16 v[156:159], v[142:145], v[142:145], v[156:159]
    v_mfma_f32_32x32x16_bf16 v[48:63], a[8:11], v[80:83], v[48:63]
    s_add_u32 s101, s7, 46080
    s_add_u32 m0, s100, 101376
    s_nop 0
    buffer_load_dwordx4 v245, s[16:19], s101 offen lds
    s_add_u32 s101, s6, 122880
    s_add_u32 m0, s37, 126976
    s_nop 0
    buffer_load_dwordx4 v244, s[12:15], s101 offen lds
    s_cmp_eq_u32 s29, 6
    s_cselect_b32 s101, -9, 1
    s_lshl_b32 s101, s101, 7
    s_add_u32 s6, s6, s101
    s_mul_i32 s101, s101, 1920
    s_add_u32 s7, s7, s101
    buffer_load_dwordx2 v[232:233], off, s[8:11], s39 sc1
    s_waitcnt vmcnt(22)
    s_waitcnt lgkmcnt(0)
    s_barrier
    ds_read_b64_tr_b16 a[16:17], v116 offset:32768
    ds_read_b64_tr_b16 a[18:19], v116 offset:33792
    ds_read_b128 v[80:83], v112 offset:49152
    ds_read_b128 v[12:15], v128 offset:49152
    s_add_u32 s101, s7, 0
    s_add_u32 m0, s100, 0
    s_nop 0
    buffer_load_dwordx4 v245, s[16:19], s101 offen lds
    v_mfma_f32_32x32x16_bf16 v[64:79], a[8:11], v[84:87], v[64:79]
    ds_read_b128 v[84:87], v112 offset:53248
    ds_read_b128 v[16:19], v128 offset:51200
    s_add_u32 s101, s6, 0
    s_add_u32 m0, s37, 16384
    s_nop 0
    buffer_load_dwordx4 v244, s[12:15], s101 offen lds
    v_mfma_f32_16x16x32_bf16 v[224:227], v[8:11], a[8:11], v[224:227]
    v_mfma_f32_32x32x16_bf16 v[192:207], a[8:11], v[88:91], v[192:207]
    ds_read_b64_tr_b16 a[20:21], v116 offset:36864
    ds_read_b64_tr_b16 a[22:23], v116 offset:37888
    ds_read_b128 v[88:91], v112 offset:57344
    ds_read_b128 v[138:141], v129 offset:49152
    s_add_u32 s101, s7, 15360
    s_add_u32 m0, s100, 1024
    s_nop 0
    buffer_load_dwordx4 v245, s[16:19], s101 offen lds
    v_mfma_f32_32x32x16_bf16 v[208:223], a[8:11], v[92:95], v[208:223]
    ds_read_b128 v[92:95], v112 offset:61440
    ds_read_b128 v[142:145], v129 offset:51200
    s_add_u32 s101, s6, 40960
    s_add_u32 m0, s37, 20480
    s_nop 0
    buffer_load_dwordx4 v244, s[12:15], s101 offen lds
    v_mfma_f32_32x32x16_bf16 v[48:63], a[12:15], v[96:99], v[48:63]
    ds_read_b128 v[96:99], v113 offset:49152
    s_add_u32 s101, s7, 30720
    s_add_u32 m0, s100, 2048
    s_nop 0
    buffer_load_dwordx4 v245, s[16:19], s101 offen lds
    v_mfma_f32_32x32x16_bf16 v[64:79], a[12:15], v[100:103], v[64:79]
    ds_read_b128 v[100:103], v113 offset:53248
    s_add_u32 s101, s6, 81920
    s_add_u32 m0, s37, 24576
    s_nop 0
    buffer_load_dwordx4 v244, s[12:15], s101 offen lds
    v_mfma_f32_16x16x32_bf16 v[224:227], v[8:11], a[12:15], v[224:227]
    v_mfma_f32_32x32x16_bf16 v[192:207], a[12:15], v[104:107], v[192:207]
    ds_read_b64_tr_b16 a[24:25], v116 offset:40960
    ds_read_b64_tr_b16 a[26:27], v116 offset:41984
    ds_read_b128 v[104:107], v113 offset:57344
    s_add_u32 s101, s7, 46080
    s_add_u32 m0, s100, 3072
    s_nop 0
    buffer_load_dwordx4 v245, s[16:19], s101 offen lds
    s_waitcnt lgkmcnt(13)
    v_mfma_f32_16x16x32_bf16 v[160:163], v[8:11], v[12:15], v[160:163]
    v_mfma_f32_32x32x16_bf16 v[208:223], a[12:15], v[108:111], v[208:223]
    ds_read_b128 v[108:111], v113 offset:61440
    s_add_u32 s101, s6, 122880
    s_add_u32 m0, s37, 28672
    s_nop 0
    buffer_load_dwordx4 v244, s[12:15], s101 offen lds
    s_cmp_eq_u32 s29, 5
    s_cselect_b32 s101, -9, 1
    s_lshl_b32 s101, s101, 7
    s_add_u32 s6, s6, s101
    s_mul_i32 s101, s101, 1920
    s_add_u32 s7, s7, s101
    v_mfma_f32_16x16x32_bf16 v[152:155], v[12:15], v[12:15], v[152:155]
    v_mfma_f32_32x32x16_bf16 v[48:63], a[16:19], v[80:83], v[48:63]
    ds_read_b128 v[80:83], v114 offset:49152
    s_waitcnt lgkmcnt(13)
    v_mfma_f32_16x16x32_bf16 v[164:167], v[8:11], v[16:19], v[164:167]
    v_mfma_f32_32x32x16_bf16 v[64:79], a[16:19], v[84:87], v[64:79]
    ds_read_b128 v[84:87], v114 offset:53248
    v_mfma_f32_16x16x32_bf16 v[224:227], v[8:11], a[16:19], v[224:227]
    s_waitcnt lgkmcnt(11)
    v_mfma_f32_32x32x16_bf16 v[192:207], a[16:19], v[88:91], v[192:207]
    ds_read_b64_tr_b16 a[28:29], v116 offset:45056
    ds_read_b64_tr_b16 a[30:31], v116 offset:46080
    ds_read_b128 v[88:91], v114 offset:57344
    v_mfma_f32_16x16x32_bf16 v[156:159], v[16:19], v[16:19], v[156:159]
    s_waitcnt lgkmcnt(12)
    v_mfma_f32_32x32x16_bf16 v[208:223], a[16:19], v[92:95], v[208:223]
    ds_read_b128 v[92:95], v114 offset:61440
    v_mfma_f32_16x16x32_bf16 v[160:163], v[8:11], v[138:141], v[160:163]
    s_waitcnt lgkmcnt(11)
    v_mfma_f32_32x32x16_bf16 v[48:63], a[20:23], v[96:99], v[48:63]
    ds_read_b128 v[96:99], v115 offset:49152
    v_mfma_f32_16x16x32_bf16 v[152:155], v[138:141], v[138:141], v[152:155]
    s_waitcnt lgkmcnt(11)
    v_mfma_f32_32x32x16_bf16 v[64:79], a[20:23], v[100:103], v[64:79]
    ds_read_b128 v[100:103], v115 offset:53248
    v_mfma_f32_16x16x32_bf16 v[224:227], v[8:11], a[20:23], v[224:227]
    s_waitcnt lgkmcnt(9)
    v_mfma_f32_32x32x16_bf16 v[192:207], a[20:23], v[104:107], v[192:207]
    ds_read_b128 v[104:107], v115 offset:57344
    v_mfma_f32_16x16x32_bf16 v[164:167], v[8:11], v[142:145], v[164:167]
    s_waitcnt lgkmcnt(9)
    v_mfma_f32_32x32x16_bf16 v[208:223], a[20:23], v[108:111], v[208:223]
    ds_read_b128 v[108:111], v115 offset:61440
    v_mfma_f32_16x16x32_bf16 v[156:159], v[142:145], v[142:145], v[156:159]
    s_waitcnt lgkmcnt(9)
    v_mfma_f32_32x32x16_bf16 v[48:63], a[24:27], v[80:83], v[48:63]
    s_waitcnt vmcnt(22)
    s_waitcnt vmcnt(8)
    s_waitcnt lgkmcnt(0)
    s_barrier
    v_xor_b32 v112, 0x10000, v112
    v_xor_b32 v113, 0x10000, v113
    v_xor_b32 v114, 0x10000, v114
    v_xor_b32 v115, 0x10000, v115
    v_xor_b32 v116, 0x10000, v116
    v_xor_b32 v128, 0x10000, v128
    v_xor_b32 v129, 0x10000, v129
    ds_read_b64_tr_b16 a[32:33], v116 offset:0
    ds_read_b64_tr_b16 a[34:35], v116 offset:1024
    s_cmp_lg_u32 s3, 2
    s_cbranch_scc1 pk_go
    v_mov_b32 v234, s80
    s_cmp_eq_u32 s38, 2
    s_cbranch_scc1 pk_ex
    s_branch pk_e1
pk_ec:
    buffer_load_dwordx2 v[232:233], off, s[8:11], s39 sc1
    s_waitcnt vmcnt(0)
pk_e1:
    v_readfirstlane_b32 s33, v232
    v_mov_b32 v234, v233
    s_sub_u32 s22, s22, 1
    s_cbranch_scc1 pk_ex
    s_cmp_lg_u32 s33, s80
    s_cbranch_scc1 pk_ec
pk_ex:
    s_max_i32 s22, s22, 0
    s_mov_b64 exec, 1
    buffer_store_dwordx2 v[234:235], off, s[8:11], s36 sc1
    ds_write_b32 v236, v234
    s_mov_b64 exec, -1
pk_go:
    s_nop 4
    ds_read_b128 v[80:83], v112 offset:16384
    ds_read_b128 v[12:15], v128 offset:16384
    s_add_u32 s101, s7, 0
    s_add_u32 m0, s100, 32768
    s_nop 0
    buffer_load_dwordx4 v245, s[16:19], s101 offen lds
    v_mfma_f32_32x32x16_bf16 v[64:79], a[24:27], v[84:87], v[64:79]
    ds_read_b128 v[84:87], v112 offset:20480
    ds_read_b128 v[16:19], v128 offset:18432
    s_add_u32 s101, s6, 0
    s_add_u32 m0, s37, 49152
    s_nop 0
    buffer_load_dwordx4 v244, s[12:15], s101 offen lds
    v_mfma_f32_16x16x32_bf16 v[224:227], v[8:11], a[24:27], v[224:227]
    v_mfma_f32_32x32x16_bf16 v[192:207], a[24:27], v[88:91], v[192:207]
    ds_read_b64_tr_b16 a[36:37], v116 offset:4096
    ds_read_b64_tr_b16 a[38:39], v116 offset:5120
    ds_read_b128 v[88:91], v112 offset:24576
    ds_read_b128 v[138:141], v129 offset:16384
    s_add_u32 s101, s7, 15360
    s_add_u32 m0, s100, 33792
    s_nop 0
    buffer_load_dwordx4 v245, s[16:19], s101 offen lds
    v_mfma_f32_32x32x16_bf16 v[208:223], a[24:27], v[92:95], v[208:223]
    ds_read_b128 v[92:95], v112 offset:28672
    ds_read_b128 v[142:145], v129 offset:18432
    s_add_u32 s101, s6, 40960
    s_add_u32 m0, s37, 53248
    s_nop 0
    buffer_load_dwordx4 v244, s[12:15], s101 offen lds
    v_mfma_f32_32x32x16_bf16 v[48:63], a[28:31], v[96:99], v[48:63]
    ds_read_b128 v[96:99], v113 offset:16384
    s_add_u32 s101, s7, 30720
    s_add_u32 m0, s100, 34816
    s_nop 0
    buffer_load_dwordx4 v245, s[16:19], s101 offen lds
    v_mfma_f32_32x32x16_bf16 v[64:79], a[28:31], v[100:103], v[64:79]
    ds_read_b128 v[100:103], v113 offset:20480
    s_add_u32 s101, s6, 81920
    s_add_u32 m0, s37, 57344
    s_nop 0
    buffer_load_dwordx4 v244, s[12:15], s101 offen lds
    v_mfma_f32_16x16x32_bf16 v[224:227], v[8:11], a[28:31], v[224:227]
    v_mfma_f32_32x32x16_bf16 v[192:207], a[28:31], v[104:107], v[192:207]
    ds_read_b64_tr_b16 a[40:41], v116 offset:8192
    ds_read_b64_tr_b16 a[42:43], v116 offset:9216
    ds_read_b128 v[104:107], v113 offset:24576
    s_add_u32 s101, s7, 46080
    s_add_u32 m0, s100, 35840
    s_nop 0
    buffer_load_dwordx4 v245, s[16:19], s101 offen lds
    s_waitcnt lgkmcnt(13)
    v_mfma_f32_16x16x32_bf16 v[160:163], v[8:11], v[12:15], v[160:163]
    v_mfma_f32_32x32x16_bf16 v[208:223], a[28:31], v[108:111], v[208:223]
    ds_read_b128 v[108:111], v113 offset:28672
    s_add_u32 s101, s6, 122880
    s_add_u32 m0, s37, 61440
    s_nop 0
    buffer_load_dwordx4 v244, s[12:15], s101 offen lds
    s_cmp_eq_u32 s29, 4
    s_cselect_b32 s101, -9, 1
    s_lshl_b32 s101, s101, 7
    s_add_u32 s6, s6, s101
    s_mul_i32 s101, s101, 1920
    s_add_u32 s7, s7, s101
    v_mfma_f32_16x16x32_bf16 v[152:155], v[12:15], v[12:15], v[152:155]
    v_mfma_f32_32x32x16_bf16 v[48:63], a[32:35], v[80:83], v[48:63]
    ds_read_b128 v[80:83], v114 offset:16384
    s_waitcnt lgkmcnt(13)
    v_mfma_f32_16x16x32_bf16 v[164:167], v[8:11], v[16:19], v[164:167]
    v_mfma_f32_32x32x16_bf16 v[64:79], a[32:35], v[84:87], v[64:79]
    ds_read_b128 v[84:87], v114 offset:20480
    v_mfma_f32_16x16x32_bf16 v[224:227], v[8:11], a[32:35], v[224:227]
    s_waitcnt lgkmcnt(11)
    v_mfma_f32_32x32x16_bf16 v[192:207], a[32:35], v[88:91], v[192:207]
    ds_read_b64_tr_b16 a[44:45], v116 offset:12288
    ds_read_b64_tr_b16 a[46:47], v116 offset:13312
    ds_read_b128 v[88:91], v114 offset:24576
    v_mfma_f32_16x16x32_bf16 v[156:159], v[16:19], v[16:19], v[156:159]
    s_waitcnt lgkmcnt(12)
    v_mfma_f32_32x32x16_bf16 v[208:223], a[32:35], v[92:95], v[208:223]
    ds_read_b128 v[92:95], v114 offset:28672
    v_mfma_f32_16x16x32_bf16 v[160:163], v[8:11], v[138:141], v[160:163]
    s_waitcnt lgkmcnt(11)
    v_mfma_f32_32x32x16_bf16 v[48:63], a[36:39], v[96:99], v[48:63]
    ds_read_b128 v[96:99], v115 offset:16384
    v_mfma_f32_16x16x32_bf16 v[152:155], v[138:141], v[138:141], v[152:155]
    s_waitcnt lgkmcnt(11)
    v_mfma_f32_32x32x16_bf16 v[64:79], a[36:39], v[100:103], v[64:79]
    ds_read_b128 v[100:103], v115 offset:20480
    v_mfma_f32_16x16x32_bf16 v[224:227], v[8:11], a[36:39], v[224:227]
    s_waitcnt lgkmcnt(9)
    v_mfma_f32_32x32x16_bf16 v[192:207], a[36:39], v[104:107], v[192:207]
    ds_read_b128 v[104:107], v115 offset:24576
    v_mfma_f32_16x16x32_bf16 v[164:167], v[8:11], v[142:145], v[164:167]
    s_waitcnt lgkmcnt(9)
    v_mfma_f32_32x32x16_bf16 v[208:223], a[36:39], v[108:111], v[208:223]
    ds_read_b128 v[108:111], v115 offset:28672
    v_mfma_f32_16x16x32_bf16 v[156:159], v[142:145], v[142:145], v[156:159]
    s_waitcnt lgkmcnt(9)
    v_mfma_f32_32x32x16_bf16 v[48:63], a[40:43], v[80:83], v[48:63]
    s_waitcnt lgkmcnt(0)
    s_barrier
    ds_read_b64_tr_b16 a[48:49], v116 offset:32768
    ds_read_b64_tr_b16 a[50:51], v116 offset:33792
    v_mov_b32 v177, 131072
    ds_read_b32 v177, v177
    ds_read_b128 v[80:83], v112 offset:49152
    ds_read_b128 v[12:15], v128 offset:49152
    s_add_u32 s101, s7, 0
    s_add_u32 m0, s100, 65536
    s_nop 0
    buffer_load_dwordx4 v245, s[16:19], s101 offen lds
    v_mfma_f32_32x32x16_bf16 v[64:79], a[40:43], v[84:87], v[64:79]
    ds_read_b128 v[84:87], v112 offset:53248
    ds_read_b128 v[16:19], v128 offset:51200
    s_add_u32 s101, s6, 0
    s_add_u32 m0, s37, 81920
    s_nop 0
    buffer_load_dwordx4 v244, s[12:15], s101 offen lds
    v_mfma_f32_16x16x32_bf16 v[224:227], v[8:11], a[40:43], v[224:227]
    v_mfma_f32_32x32x16_bf16 v[192:207], a[40:43], v[88:91], v[192:207]
    ds_read_b64_tr_b16 a[52:53], v116 offset:36864
    ds_read_b64_tr_b16 a[54:55], v116 offset:37888
    ds_read_b128 v[88:91], v112 offset:57344
    ds_read_b128 v[138:141], v129 offset:49152
    s_add_u32 s101, s7, 15360
    s_add_u32 m0, s100, 66560
    s_nop 0
    buffer_load_dwordx4 v245, s[16:19], s101 offen lds
    v_mfma_f32_32x32x16_bf16 v[208:223], a[40:43], v[92:95], v[208:223]
    ds_read_b128 v[92:95], v112 offset:61440
    ds_read_b128 v[142:145], v129 offset:51200
    s_add_u32 s101, s6, 40960
    s_add_u32 m0, s37, 86016
    s_nop 0
    buffer_load_dwordx4 v244, s[12:15], s101 offen lds
    v_mfma_f32_32x32x16_bf16 v[48:63], a[44:47], v[96:99], v[48:63]
    ds_read_b128 v[96:99], v113 offset:49152
    s_add_u32 s101, s7, 30720
    s_add_u32 m0, s100, 67584
    s_nop 0
    buffer_load_dwordx4 v245, s[16:19], s101 offen lds
    v_mfma_f32_32x32x16_bf16 v[64:79], a[44:47], v[100:103], v[64:79]
    ds_read_b128 v[100:103], v113 offset:53248
    s_add_u32 s101, s6, 81920
    s_add_u32 m0, s37, 90112
    s_nop 0
    buffer_load_dwordx4 v244, s[12:15], s101 offen lds
    v_mfma_f32_16x16x32_bf16 v[224:227], v[8:11], a[44:47], v[224:227]
    v_mfma_f32_32x32x16_bf16 v[192:207], a[44:47], v[104:107], v[192:207]
    ds_read_b64_tr_b16 a[56:57], v116 offset:40960
    ds_read_b64_tr_b16 a[58:59], v116 offset:41984
    ds_read_b128 v[104:107], v113 offset:57344
    s_add_u32 s101, s7, 46080
    s_add_u32 m0, s100, 68608
    s_nop 0
    buffer_load_dwordx4 v245, s[16:19], s101 offen lds
    s_waitcnt lgkmcnt(13)
    v_mfma_f32_16x16x32_bf16 v[160:163], v[8:11], v[12:15], v[160:163]
    v_mfma_f32_32x32x16_bf16 v[208:223], a[44:47], v[108:111], v[208:223]
    ds_read_b128 v[108:111], v113 offset:61440
    s_add_u32 s101, s6, 122880
    s_add_u32 m0, s37, 94208
    s_nop 0
    buffer_load_dwordx4 v244, s[12:15], s101 offen lds
    s_cmp_eq_u32 s29, 3
    s_cselect_b32 s101, -9, 1
    s_lshl_b32 s101, s101, 7
    s_add_u32 s6, s6, s101
    s_mul_i32 s101, s101, 1920
    s_add_u32 s7, s7, s101
    v_mfma_f32_16x16x32_bf16 v[152:155], v[12:15], v[12:15], v[152:155]
    v_mfma_f32_32x32x16_bf16 v[48:63], a[48:51], v[80:83], v[48:63]
    ds_read_b128 v[80:83], v114 offset:49152
    s_waitcnt lgkmcnt(13)
    v_mfma_f32_16x16x32_bf16 v[164:167], v[8:11], v[16:19], v[164:167]
    v_mfma_f32_32x32x16_bf16 v[64:79], a[48:51], v[84:87], v[64:79]
    ds_read_b128 v[84:87], v114 offset:53248
    v_mfma_f32_16x16x32_bf16 v[224:227], v[8:11], a[48:51], v[224:227]
    s_waitcnt lgkmcnt(11)
    v_mfma_f32_32x32x16_bf16 v[192:207], a[48:51], v[88:91], v[192:207]
    ds_read_b64_tr_b16 a[60:61], v116 offset:45056
    ds_read_b64_tr_b16 a[62:63], v116 offset:46080
    ds_read_b128 v[88:91], v114 offset:57344
    v_mfma_f32_16x16x32_bf16 v[156:159], v[16:19], v[16:19], v[156:159]
    s_waitcnt lgkmcnt(12)
    v_mfma_f32_32x32x16_bf16 v[208:223], a[48:51], v[92:95], v[208:223]
    ds_read_b128 v[92:95], v114 offset:61440
    v_mfma_f32_16x16x32_bf16 v[160:163], v[8:11], v[138:141], v[160:163]
    s_waitcnt lgkmcnt(11)
    v_mfma_f32_32x32x16_bf16 v[48:63], a[52:55], v[96:99], v[48:63]
    ds_read_b128 v[96:99], v115 offset:49152
    v_mfma_f32_16x16x32_bf16 v[152:155], v[138:141], v[138:141], v[152:155]
    s_waitcnt lgkmcnt(11)
    v_mfma_f32_32x32x16_bf16 v[64:79], a[52:55], v[100:103], v[64:79]
    ds_read_b128 v[100:103], v115 offset:53248
    v_mfma_f32_16x16x32_bf16 v[224:227], v[8:11], a[52:55], v[224:227]
    s_waitcnt lgkmcnt(9)
    v_mfma_f32_32x32x16_bf16 v[192:207], a[52:55], v[104:107], v[192:207]
    ds_read_b128 v[104:107], v115 offset:57344
    v_mfma_f32_16x16x32_bf16 v[164:167], v[8:11], v[142:145], v[164:167]
    s_waitcnt lgkmcnt(9)
    v_mfma_f32_32x32x16_bf16 v[208:223], a[52:55], v[108:111], v[208:223]
    ds_read_b128 v[108:111], v115 offset:61440
    v_mfma_f32_16x16x32_bf16 v[156:159], v[142:145], v[142:145], v[156:159]
    s_waitcnt lgkmcnt(9)
    v_mfma_f32_32x32x16_bf16 v[48:63], a[56:59], v[80:83], v[48:63]
    s_waitcnt vmcnt(16)
    s_waitcnt lgkmcnt(0)
    s_barrier
    v_xor_b32 v112, 0x10000, v112
    v_xor_b32 v113, 0x10000, v113
    v_xor_b32 v114, 0x10000, v114
    v_xor_b32 v115, 0x10000, v115
    v_xor_b32 v116, 0x10000, v116
    v_xor_b32 v128, 0x10000, v128
    v_xor_b32 v129, 0x10000, v129
    ds_read_b64_tr_b16 a[64:65], v116 offset:0
    ds_read_b64_tr_b16 a[66:67], v116 offset:1024
    v_readfirstlane_b32 s81, v177
    ds_read_b128 v[80:83], v112 offset:16384
    ds_read_b128 v[12:15], v128 offset:16384
    s_add_u32 s101, s7, 0
    s_add_u32 m0, s100, 98304
    s_nop 0
    buffer_load_dwordx4 v245, s[16:19], s101 offen lds
    v_mfma_f32_32x32x16_bf16 v[64:79], a[56:59], v[84:87], v[64:79]
    ds_read_b128 v[84:87], v112 offset:20480
    ds_read_b128 v[16:19], v128 offset:18432
    s_add_u32 s101, s6, 0
    s_add_u32 m0, s37, 114688
    s_nop 0
    buffer_load_dwordx4 v244, s[12:15], s101 offen lds
    v_mfma_f32_16x16x32_bf16 v[224:227], v[8:11], a[56:59], v[224:227]
    v_mfma_f32_32x32x16_bf16 v[192:207], a[56:59], v[88:91], v[192:207]
    ds_read_b64_tr_b16 a[68:69], v116 offset:4096
    ds_read_b64_tr_b16 a[70:71], v116 offset:5120
    ds_read_b128 v[88:91], v112 offset:24576
    ds_read_b128 v[138:141], v129 offset:16384
    s_add_u32 s101, s7, 15360
    s_add_u32 m0, s100, 99328
    s_nop 0
    buffer_load_dwordx4 v245, s[16:19], s101 offen lds
    v_mfma_f32_32x32x16_bf16 v[208:223], a[56:59], v[92:95], v[208:223]
    ds_read_b128 v[92:95], v112 offset:28672
    ds_read_b128 v[142:145], v129 offset:18432
    s_add_u32 s101, s6, 40960
    s_add_u32 m0, s37, 118784
    s_nop 0
    buffer_load_dwordx4 v244, s[12:15], s101 offen lds
    v_mfma_f32_32x32x16_bf16 v[48:63], a[60:63], v[96:99], v[48:63]
    ds_read_b128 v[96:99], v113 offset:16384
    s_add_u32 s101, s7, 30720
    s_add_u32 m0, s100, 100352
    s_nop 0
    buffer_load_dwordx4 v245, s[16:19], s101 offen lds
    v_mfma_f32_32x32x16_bf16 v[64:79], a[60:63], v[100:103], v[64:79]
    ds_read_b128 v[100:103], v113 offset:20480
    s_add_u32 s101, s6, 81920
    s_add_u32 m0, s37, 122880
    s_nop 0
    buffer_load_dwordx4 v244, s[12:15], s101 offen lds
    v_mfma_f32_16x16x32_bf16 v[224:227], v[8:11], a[60:63], v[224:227]
    v_mfma_f32_32x32x16_bf16 v[192:207], a[60:63], v[104:107], v[192:207]
    ds_read_b64_tr_b16 a[72:73], v116 offset:8192
    ds_read_b64_tr_b16 a[74:75], v116 offset:9216
    ds_read_b128 v[104:107], v113 offset:24576
    s_add_u32 s101, s7, 46080
    s_add_u32 m0, s100, 101376
    s_nop 0
    buffer_load_dwordx4 v245, s[16:19], s101 offen lds
    s_waitcnt lgkmcnt(13)
    v_mfma_f32_16x16x32_bf16 v[160:163], v[8:11], v[12:15], v[160:163]
    v_mfma_f32_32x32x16_bf16 v[208:223], a[60:63], v[108:111], v[208:223]
    ds_read_b128 v[108:111], v113 offset:28672
    s_add_u32 s101, s6, 122880
    s_add_u32 m0, s37, 126976
    s_nop 0
    buffer_load_dwordx4 v244, s[12:15], s101 offen lds
    s_cmp_eq_u32 s29, 2
    s_cselect_b32 s101, -9, 1
    s_lshl_b32 s101, s101, 7
    s_add_u32 s6, s6, s101
    s_mul_i32 s101, s101, 1920
    s_add_u32 s7, s7, s101
    v_mfma_f32_16x16x32_bf16 v[152:155], v[12:15], v[12:15], v[152:155]
    v_mfma_f32_32x32x16_bf16 v[48:63], a[64:67], v[80:83], v[48:63]
    ds_read_b128 v[80:83], v114 offset:16384
    s_bitcmp1_b32 s82, 0
    s_cbranch_scc1 pk_pt1
    v_lshlrev_b32 v132, 1, v243
    s_mul_i32 s30, s20, 163840
    s_mul_i32 s31, s28, 20480
    s_add_u32 s30, s30, s31
    s_mul_i32 s31, s3, 5120
    s_add_u32 s30, s30, s31
    s_add_u32 s31, s30, 17825792
    buffer_load_dword v180, v132, s[8:11], s31 offen
pk_pt1:
    s_waitcnt lgkmcnt(13)
    v_mfma_f32_16x16x32_bf16 v[164:167], v[8:11], v[16:19], v[164:167]
    v_mfma_f32_32x32x16_bf16 v[64:79], a[64:67], v[84:87], v[64:79]
    ds_read_b128 v[84:87], v114 offset:20480
    v_mfma_f32_16x16x32_bf16 v[224:227], v[8:11], a[64:67], v[224:227]
    s_waitcnt lgkmcnt(11)
    v_mfma_f32_32x32x16_bf16 v[192:207], a[64:67], v[88:91], v[192:207]
    ds_read_b64_tr_b16 a[76:77], v116 offset:12288
    ds_read_b64_tr_b16 a[78:79], v116 offset:13312
    ds_read_b128 v[88:91], v114 offset:24576
    v_mfma_f32_16x16x32_bf16 v[156:159], v[16:19], v[16:19], v[156:159]
    s_waitcnt lgkmcnt(12)
    v_mfma_f32_32x32x16_bf16 v[208:223], a[64:67], v[92:95], v[208:223]
    ds_read_b128 v[92:95], v114 offset:28672
    v_mfma_f32_16x16x32_bf16 v[160:163], v[8:11], v[138:141], v[160:163]
    s_waitcnt lgkmcnt(11)
    v_mfma_f32_32x32x16_bf16 v[48:63], a[68:71], v[96:99], v[48:63]
    ds_read_b128 v[96:99], v115 offset:16384
    v_mfma_f32_16x16x32_bf16 v[152:155], v[138:141], v[138:141], v[152:155]
    s_waitcnt lgkmcnt(11)
    v_mfma_f32_32x32x16_bf16 v[64:79], a[68:71], v[100:103], v[64:79]
    ds_read_b128 v[100:103], v115 offset:20480
    v_mfma_f32_16x16x32_bf16 v[224:227], v[8:11], a[68:71], v[224:227]
    s_waitcnt lgkmcnt(9)
    v_mfma_f32_32x32x16_bf16 v[192:207], a[68:71], v[104:107], v[192:207]
    ds_read_b128 v[104:107], v115 offset:24576
    v_mfma_f32_16x16x32_bf16 v[164:167], v[8:11], v[142:145], v[164:167]
    s_waitcnt lgkmcnt(9)
    v_mfma_f32_32x32x16_bf16 v[208:223], a[68:71], v[108:111], v[208:223]
    ds_read_b128 v[108:111], v115 offset:28672
    v_mfma_f32_16x16x32_bf16 v[156:159], v[142:145], v[142:145], v[156:159]
    s_waitcnt lgkmcnt(9)
    v_mfma_f32_32x32x16_bf16 v[48:63], a[72:75], v[80:83], v[48:63]
    s_waitcnt vmcnt(16)
    s_waitcnt lgkmcnt(0)
    s_barrier
    ds_read_b64_tr_b16 a[80:81], v116 offset:32768
    ds_read_b64_tr_b16 a[82:83], v116 offset:33792
    ds_read_b128 v[80:83], v112 offset:49152
    ds_read_b128 v[12:15], v128 offset:49152
    s_add_u32 s101, s7, 0
    s_add_u32 m0, s100, 0
    s_nop 0
    buffer_load_dwordx4 v245, s[16:19], s101 offen lds
    v_mfma_f32_32x32x16_bf16 v[64:79], a[72:75], v[84:87], v[64:79]
    ds_read_b128 v[84:87], v112 offset:53248
    ds_read_b128 v[16:19], v128 offset:51200
    s_add_u32 s101, s6, 0
    s_add_u32 m0, s37, 16384
    s_nop 0
    buffer_load_dwordx4 v244, s[12:15], s101 offen lds
    v_mfma_f32_16x16x32_bf16 v[224:227], v[8:11], a[72:75], v[224:227]
    v_mfma_f32_32x32x16_bf16 v[192:207], a[72:75], v[88:91], v[192:207]
    ds_read_b64_tr_b16 a[84:85], v116 offset:36864
    ds_read_b64_tr_b16 a[86:87], v116 offset:37888
    ds_read_b128 v[88:91], v112 offset:57344
    ds_read_b128 v[138:141], v129 offset:49152
    s_add_u32 s101, s7, 15360
    s_add_u32 m0, s100, 1024
    s_nop 0
    buffer_load_dwordx4 v245, s[16:19], s101 offen lds
    v_mfma_f32_32x32x16_bf16 v[208:223], a[72:75], v[92:95], v[208:223]
    ds_read_b128 v[92:95], v112 offset:61440
    ds_read_b128 v[142:145], v129 offset:51200
    s_add_u32 s101, s6, 40960
    s_add_u32 m0, s37, 20480
    s_nop 0
    buffer_load_dwordx4 v244, s[12:15], s101 offen lds
    v_mfma_f32_32x32x16_bf16 v[48:63], a[76:79], v[96:99], v[48:63]
    ds_read_b128 v[96:99], v113 offset:49152
    s_add_u32 s101, s7, 30720
    s_add_u32 m0, s100, 2048
    s_nop 0
    buffer_load_dwordx4 v245, s[16:19], s101 offen lds
    v_mfma_f32_32x32x16_bf16 v[64:79], a[76:79], v[100:103], v[64:79]
    ds_read_b128 v[100:103], v113 offset:53248
    s_add_u32 s101, s6, 81920
    s_add_u32 m0, s37, 24576
    s_nop 0
    buffer_load_dwordx4 v244, s[12:15], s101 offen lds
    v_mfma_f32_16x16x32_bf16 v[224:227], v[8:11], a[76:79], v[224:227]
    v_mfma_f32_32x32x16_bf16 v[192:207], a[76:79], v[104:107], v[192:207]
    ds_read_b64_tr_b16 a[88:89], v116 offset:40960
    ds_read_b64_tr_b16 a[90:91], v116 offset:41984
    ds_read_b128 v[104:107], v113 offset:57344
    s_add_u32 s101, s7, 46080
    s_add_u32 m0, s100, 3072
    s_nop 0
    buffer_load_dwordx4 v245, s[16:19], s101 offen lds
    s_waitcnt lgkmcnt(13)
    v_mfma_f32_16x16x32_bf16 v[160:163], v[8:11], v[12:15], v[160:163]
    v_mfma_f32_32x32x16_bf16 v[208:223], a[76:79], v[108:111], v[208:223]
    ds_read_b128 v[108:111], v113 offset:61440
    s_add_u32 s101, s6, 122880
    s_add_u32 m0, s37, 28672
    s_nop 0
    buffer_load_dwordx4 v244, s[12:15], s101 offen lds
    s_cmp_eq_u32 s29, 1
    s_cselect_b32 s101, -9, 1
    s_lshl_b32 s101, s101, 7
    s_add_u32 s6, s6, s101
    s_mul_i32 s101, s101, 1920
    s_add_u32 s7, s7, s101
    v_mfma_f32_16x16x32_bf16 v[152:155], v[12:15], v[12:15], v[152:155]
    v_mfma_f32_32x32x16_bf16 v[48:63], a[80:83], v[80:83], v[48:63]
    ds_read_b128 v[80:83], v114 offset:49152
    s_waitcnt lgkmcnt(13)
    v_mfma_f32_16x16x32_bf16 v[164:167], v[8:11], v[16:19], v[164:167]
    v_mfma_f32_32x32x16_bf16 v[64:79], a[80:83], v[84:87], v[64:79]
    ds_read_b128 v[84:87], v114 offset:53248
    v_mfma_f32_16x16x32_bf16 v[224:227], v[8:11], a[80:83], v[224:227]
    s_waitcnt lgkmcnt(11)
    v_mfma_f32_32x32x16_bf16 v[192:207], a[80:83], v[88:91], v[192:207]
    ds_read_b64_tr_b16 a[92:93], v116 offset:45056
    ds_read_b64_tr_b16 a[94:95], v116 offset:46080
    ds_read_b128 v[88:91], v114 offset:57344
    v_mfma_f32_16x16x32_bf16 v[156:159], v[16:19], v[16:19], v[156:159]
    s_waitcnt lgkmcnt(12)
    v_mfma_f32_32x32x16_bf16 v[208:223], a[80:83], v[92:95], v[208:223]
    ds_read_b128 v[92:95], v114 offset:61440
    v_mfma_f32_16x16x32_bf16 v[160:163], v[8:11], v[138:141], v[160:163]
    s_waitcnt lgkmcnt(11)
    v_mfma_f32_32x32x16_bf16 v[48:63], a[84:87], v[96:99], v[48:63]
    ds_read_b128 v[96:99], v115 offset:49152
    v_mfma_f32_16x16x32_bf16 v[152:155], v[138:141], v[138:141], v[152:155]
    s_waitcnt lgkmcnt(11)
    v_mfma_f32_32x32x16_bf16 v[64:79], a[84:87], v[100:103], v[64:79]
    ds_read_b128 v[100:103], v115 offset:53248
    v_mfma_f32_16x16x32_bf16 v[224:227], v[8:11], a[84:87], v[224:227]
    s_waitcnt lgkmcnt(9)
    v_mfma_f32_32x32x16_bf16 v[192:207], a[84:87], v[104:107], v[192:207]
    ds_read_b128 v[104:107], v115 offset:57344
    v_mfma_f32_16x16x32_bf16 v[164:167], v[8:11], v[142:145], v[164:167]
    s_waitcnt lgkmcnt(9)
    v_mfma_f32_32x32x16_bf16 v[208:223], a[84:87], v[108:111], v[208:223]
    ds_read_b128 v[108:111], v115 offset:61440
    v_mfma_f32_16x16x32_bf16 v[156:159], v[142:145], v[142:145], v[156:159]
    s_waitcnt lgkmcnt(9)
    v_mfma_f32_32x32x16_bf16 v[48:63], a[88:91], v[80:83], v[48:63]
    s_waitcnt vmcnt(16)
    s_waitcnt lgkmcnt(0)
    s_barrier
    v_xor_b32 v112, 0x10000, v112
    v_xor_b32 v113, 0x10000, v113
    v_xor_b32 v114, 0x10000, v114
    v_xor_b32 v115, 0x10000, v115
    v_xor_b32 v116, 0x10000, v116
    v_xor_b32 v128, 0x10000, v128
    v_xor_b32 v129, 0x10000, v129
    ds_read_b64_tr_b16 a[96:97], v116 offset:0
    ds_read_b64_tr_b16 a[98:99], v116 offset:1024
    ds_read_b128 v[80:83], v112 offset:16384
    ds_read_b128 v[12:15], v128 offset:16384
    s_add_u32 s101, s7, 0
    s_add_u32 m0, s100, 32768
    s_nop 0
    buffer_load_dwordx4 v245, s[16:19], s101 offen lds
    v_mfma_f32_32x32x16_bf16 v[64:79], a[88:91], v[84:87], v[64:79]
    ds_read_b128 v[84:87], v112 offset:20480
    ds_read_b128 v[16:19], v128 offset:18432
    s_add_u32 s101, s6, 0
    s_add_u32 m0, s37, 49152
    s_nop 0
    buffer_load_dwordx4 v244, s[12:15], s101 offen lds
    v_mfma_f32_16x16x32_bf16 v[224:227], v[8:11], a[88:91], v[224:227]
    v_mfma_f32_32x32x16_bf16 v[192:207], a[88:91], v[88:91], v[192:207]
    ds_read_b64_tr_b16 a[100:101], v116 offset:4096
    ds_read_b64_tr_b16 a[102:103], v116 offset:5120
    ds_read_b128 v[88:91], v112 offset:24576
    ds_read_b128 v[138:141], v129 offset:16384
    s_add_u32 s101, s7, 15360
    s_add_u32 m0, s100, 33792
    s_nop 0
    buffer_load_dwordx4 v245, s[16:19], s101 offen lds
    v_mfma_f32_32x32x16_bf16 v[208:223], a[88:91], v[92:95], v[208:223]
    ds_read_b128 v[92:95], v112 offset:28672
    ds_read_b128 v[142:145], v129 offset:18432
    s_add_u32 s101, s6, 40960
    s_add_u32 m0, s37, 53248
    s_nop 0
    buffer_load_dwordx4 v244, s[12:15], s101 offen lds
    v_mfma_f32_32x32x16_bf16 v[48:63], a[92:95], v[96:99], v[48:63]
    ds_read_b128 v[96:99], v113 offset:16384
    s_add_u32 s101, s7, 30720
    s_add_u32 m0, s100, 34816
    s_nop 0
    buffer_load_dwordx4 v245, s[16:19], s101 offen lds
    v_mfma_f32_32x32x16_bf16 v[64:79], a[92:95], v[100:103], v[64:79]
    ds_read_b128 v[100:103], v113 offset:20480
    s_add_u32 s101, s6, 81920
    s_add_u32 m0, s37, 57344
    s_nop 0
    buffer_load_dwordx4 v244, s[12:15], s101 offen lds
    v_mfma_f32_16x16x32_bf16 v[224:227], v[8:11], a[92:95], v[224:227]
    v_mfma_f32_32x32x16_bf16 v[192:207], a[92:95], v[104:107], v[192:207]
    ds_read_b64_tr_b16 a[104:105], v116 offset:8192
    ds_read_b64_tr_b16 a[106:107], v116 offset:9216
    ds_read_b128 v[104:107], v113 offset:24576
    s_add_u32 s101, s7, 46080
    s_add_u32 m0, s100, 35840
    s_nop 0
    buffer_load_dwordx4 v245, s[16:19], s101 offen lds
    s_waitcnt lgkmcnt(13)
    v_mfma_f32_16x16x32_bf16 v[160:163], v[8:11], v[12:15], v[160:163]
    v_mfma_f32_32x32x16_bf16 v[208:223], a[92:95], v[108:111], v[208:223]
    ds_read_b128 v[108:111], v113 offset:28672
    s_add_u32 s101, s6, 122880
    s_add_u32 m0, s37, 61440
    s_nop 0
    buffer_load_dwordx4 v244, s[12:15], s101 offen lds
    s_cmp_eq_u32 s29, 0
    s_cselect_b32 s101, -9, 1
    s_lshl_b32 s101, s101, 7
    s_add_u32 s6, s6, s101
    s_mul_i32 s101, s101, 1920
    s_add_u32 s7, s7, s101
    v_mfma_f32_16x16x32_bf16 v[152:155], v[12:15], v[12:15], v[152:155]
    v_mfma_f32_32x32x16_bf16 v[48:63], a[96:99], v[80:83], v[48:63]
    ds_read_b128 v[80:83], v114 offset:16384
    s_waitcnt lgkmcnt(13)
    v_mfma_f32_16x16x32_bf16 v[164:167], v[8:11], v[16:19], v[164:167]
    v_mfma_f32_32x32x16_bf16 v[64:79], a[96:99], v[84:87], v[64:79]
    ds_read_b128 v[84:87], v114 offset:20480
    v_mfma_f32_16x16x32_bf16 v[224:227], v[8:11], a[96:99], v[224:227]
    s_waitcnt lgkmcnt(11)
    v_mfma_f32_32x32x16_bf16 v[192:207], a[96:99], v[88:91], v[192:207]
    ds_read_b64_tr_b16 a[108:109], v116 offset:12288
    ds_read_b64_tr_b16 a[110:111], v116 offset:13312
    ds_read_b128 v[88:91], v114 offset:24576
    v_mfma_f32_16x16x32_bf16 v[156:159], v[16:19], v[16:19], v[156:159]
    s_waitcnt lgkmcnt(12)
    v_mfma_f32_32x32x16_bf16 v[208:223], a[96:99], v[92:95], v[208:223]
    ds_read_b128 v[92:95], v114 offset:28672
    v_mfma_f32_16x16x32_bf16 v[160:163], v[8:11], v[138:141], v[160:163]
    s_waitcnt lgkmcnt(11)
    v_mfma_f32_32x32x16_bf16 v[48:63], a[100:103], v[96:99], v[48:63]
    ds_read_b128 v[96:99], v115 offset:16384
    v_mfma_f32_16x16x32_bf16 v[152:155], v[138:141], v[138:141], v[152:155]
    s_waitcnt lgkmcnt(11)
    v_mfma_f32_32x32x16_bf16 v[64:79], a[100:103], v[100:103], v[64:79]
    ds_read_b128 v[100:103], v115 offset:20480
    v_mfma_f32_16x16x32_bf16 v[224:227], v[8:11], a[100:103], v[224:227]
    s_waitcnt lgkmcnt(9)
    v_mfma_f32_32x32x16_bf16 v[192:207], a[100:103], v[104:107], v[192:207]
    ds_read_b128 v[104:107], v115 offset:24576
    v_mfma_f32_16x16x32_bf16 v[164:167], v[8:11], v[142:145], v[164:167]
    s_waitcnt lgkmcnt(9)
    v_mfma_f32_32x32x16_bf16 v[208:223], a[100:103], v[108:111], v[208:223]
    ds_read_b128 v[108:111], v115 offset:28672
    v_mfma_f32_16x16x32_bf16 v[156:159], v[142:145], v[142:145], v[156:159]
    s_waitcnt lgkmcnt(9)
    v_mfma_f32_32x32x16_bf16 v[48:63], a[104:107], v[80:83], v[48:63]
    s_waitcnt vmcnt(16)
    s_barrier
    ds_read_b64_tr_b16 a[112:113], v116 offset:32768
    ds_read_b64_tr_b16 a[114:115], v116 offset:33792
    v_lshlrev_b32 v176, 5, v0
    s_mov_b32 s32, 30429184
    buffer_load_dwordx4 v[168:171], v176, s[8:11], s32 offen sc1
    buffer_load_dwordx4 v[172:175], v176, s[8:11], s32 offen offset:16 sc1
    ds_read_b128 v[80:83], v112 offset:49152
    ds_read_b128 v[12:15], v128 offset:49152
    v_lshrrev_b32 v136, 3, v0
    v_and_b32 v137, 7, v0
    v_lshlrev_b32 v136, 11, v136
    v_lshl_add_u32 v136, v137, 4, v136
    s_mul_i32 s30, s21, 131072
    s_lshl_b32 s31, s20, 7
    s_add_u32 s30, s30, s31
    s_lshl_b32 s31, s3, 15
    s_add_u32 s30, s30, s31
    s_add_u32 s30, s30, 44040192
    buffer_store_dwordx4 v[184:187], v136, s[8:11], s30 offen sc1
    s_add_u32 s30, s30, 16384
    buffer_store_dwordx4 v[184:187], v136, s[8:11], s30 offen sc1
    s_waitcnt lgkmcnt(12)
    v_mfma_f32_32x32x16_bf16 v[64:79], a[104:107], v[84:87], v[64:79]
    ds_read_b128 v[84:87], v112 offset:53248
    ds_read_b128 v[16:19], v128 offset:51200
    v_lshrrev_b32 v136, 3, v0
    v_lshlrev_b32 v136, 17, v136
    v_lshl_add_u32 v136, v137, 4, v136
    s_lshl_b32 s30, s21, 13
    s_lshl_b32 s31, s20, 7
    s_add_u32 s30, s30, s31
    s_add_u32 s30, s30, s25
    s_add_u32 s30, s30, 51380224
    buffer_store_dwordx4 v[184:187], v136, s[8:11], s30 offen sc1
    v_mfma_f32_16x16x32_bf16 v[224:227], v[8:11], a[104:107], v[224:227]
    s_waitcnt lgkmcnt(11)
    v_mfma_f32_32x32x16_bf16 v[192:207], a[104:107], v[88:91], v[192:207]
    ds_read_b64_tr_b16 a[116:117], v116 offset:36864
    ds_read_b64_tr_b16 a[118:119], v116 offset:37888
    ds_read_b128 v[88:91], v112 offset:57344
    ds_read_b128 v[138:141], v129 offset:49152
    v_and_b32 v132, 15, v0
    v_mul_u32_u24 v132, 1280, v132
    v_lshrrev_b32 v133, 4, v0
    v_lshl_add_u32 v134, v133, 4, v132
    v_lshl_add_u32 v135, v133, 3, v132
    s_and_b32 s30, s27, 7
    s_mul_i32 s30, s30, 20480
    s_mul_i32 s31, s28, 160
    s_add_u32 s30, s30, s31
    buffer_load_dwordx4 v[20:23], v134, s[12:15], s30 offen
    buffer_load_dwordx4 v[24:27], v134, s[12:15], s30 offen offset:64
    buffer_load_dwordx2 v[28:29], v135, s[12:15], s30 offen offset:128
    s_waitcnt lgkmcnt(14)
    v_mfma_f32_32x32x16_bf16 v[208:223], a[104:107], v[92:95], v[208:223]
    ds_read_b128 v[92:95], v112 offset:61440
    ds_read_b128 v[142:145], v129 offset:51200
    s_bitcmp1_b32 s82, 0
    s_cbranch_scc1 pk_pt2
    v_lshlrev_b32 v132, 1, v243
    s_mul_i32 s30, s20, 163840
    s_mul_i32 s31, s28, 20480
    s_add_u32 s30, s30, s31
    s_mul_i32 s31, s3, 5120
    s_add_u32 s30, s30, s31
    s_add_u32 s31, s30, 7340032
    buffer_load_dword v181, v132, s[8:11], s31 offen
pk_pt2:
    s_waitcnt lgkmcnt(15)
    v_mfma_f32_32x32x16_bf16 v[48:63], a[108:111], v[96:99], v[48:63]
    ds_read_b128 v[96:99], v113 offset:49152
    s_waitcnt lgkmcnt(15)
    v_mfma_f32_32x32x16_bf16 v[64:79], a[108:111], v[100:103], v[64:79]
    ds_read_b128 v[100:103], v113 offset:53248
    v_mfma_f32_16x16x32_bf16 v[224:227], v[8:11], a[108:111], v[224:227]
    s_waitcnt lgkmcnt(15)
    v_mfma_f32_32x32x16_bf16 v[192:207], a[108:111], v[104:107], v[192:207]
    ds_read_b64_tr_b16 a[120:121], v116 offset:40960
    ds_read_b64_tr_b16 a[122:123], v116 offset:41984
    ds_read_b128 v[104:107], v113 offset:57344
    s_waitcnt lgkmcnt(13)
    v_mfma_f32_16x16x32_bf16 v[160:163], v[8:11], v[12:15], v[160:163]
    v_mfma_f32_32x32x16_bf16 v[208:223], a[108:111], v[108:111], v[208:223]
    ds_read_b128 v[108:111], v113 offset:61440
    v_mfma_f32_16x16x32_bf16 v[152:155], v[12:15], v[12:15], v[152:155]
    v_mfma_f32_32x32x16_bf16 v[48:63], a[112:115], v[80:83], v[48:63]
    ds_read_b128 v[80:83], v114 offset:49152
    s_waitcnt lgkmcnt(13)
    v_mfma_f32_16x16x32_bf16 v[164:167], v[8:11], v[16:19], v[164:167]
    v_mfma_f32_32x32x16_bf16 v[64:79], a[112:115], v[84:87], v[64:79]
    ds_read_b128 v[84:87], v114 offset:53248
    v_mfma_f32_16x16x32_bf16 v[224:227], v[8:11], a[112:115], v[224:227]
    s_waitcnt lgkmcnt(11)
    v_mfma_f32_32x32x16_bf16 v[192:207], a[112:115], v[88:91], v[192:207]
    ds_read_b64_tr_b16 a[124:125], v116 offset:45056
    ds_read_b64_tr_b16 a[126:127], v116 offset:46080
    ds_read_b128 v[88:91], v114 offset:57344
    v_mfma_f32_16x16x32_bf16 v[156:159], v[16:19], v[16:19], v[156:159]
    s_waitcnt lgkmcnt(12)
    v_mfma_f32_32x32x16_bf16 v[208:223], a[112:115], v[92:95], v[208:223]
    ds_read_b128 v[92:95], v114 offset:61440
    v_mfma_f32_16x16x32_bf16 v[160:163], v[8:11], v[138:141], v[160:163]
    s_waitcnt lgkmcnt(11)
    v_mfma_f32_32x32x16_bf16 v[48:63], a[116:119], v[96:99], v[48:63]
    ds_read_b128 v[96:99], v115 offset:49152
    v_mfma_f32_16x16x32_bf16 v[152:155], v[138:141], v[138:141], v[152:155]
    s_waitcnt lgkmcnt(11)
    v_mfma_f32_32x32x16_bf16 v[64:79], a[116:119], v[100:103], v[64:79]
    ds_read_b128 v[100:103], v115 offset:53248
    v_mfma_f32_16x16x32_bf16 v[224:227], v[8:11], a[116:119], v[224:227]
    s_waitcnt lgkmcnt(9)
    v_mfma_f32_32x32x16_bf16 v[192:207], a[116:119], v[104:107], v[192:207]
    ds_read_b128 v[104:107], v115 offset:57344
    v_mfma_f32_16x16x32_bf16 v[164:167], v[8:11], v[142:145], v[164:167]
    s_waitcnt lgkmcnt(9)
    v_mfma_f32_32x32x16_bf16 v[208:223], a[116:119], v[108:111], v[208:223]
    ds_read_b128 v[108:111], v115 offset:61440
    v_mfma_f32_16x16x32_bf16 v[156:159], v[142:145], v[142:145], v[156:159]
    s_waitcnt lgkmcnt(9)
    v_mfma_f32_32x32x16_bf16 v[48:63], a[120:123], v[80:83], v[48:63]
    s_waitcnt vmcnt(16)
    s_waitcnt lgkmcnt(0)
    s_barrier
    v_xor_b32 v112, 0x10000, v112
    v_xor_b32 v113, 0x10000, v113
    v_xor_b32 v114, 0x10000, v114
    v_xor_b32 v115, 0x10000, v115
    v_xor_b32 v116, 0x10000, v116
    v_xor_b32 v128, 0x10000, v128
    v_xor_b32 v129, 0x10000, v129
    ds_read_b64_tr_b16 a[128:129], v116 offset:0
    ds_read_b64_tr_b16 a[130:131], v116 offset:1024
    s_waitcnt vmcnt(6)
    s_branch pk_c1
pk_c0:
    s_mov_b32 s32, 30429184
    s_cmp_lg_u32 s38, 2
    s_cbranch_scc1 pk_c2
    s_mov_b32 s30, 30412800
    s_mov_b32 s31, 30425088
    buffer_load_dwordx4 v[168:171], v1, s[8:11], s30 offen sc1
    s_waitcnt vmcnt(0)
    v_mov_b32 v174, v171
    v_mov_b32 v172, v170
    v_mov_b32 v170, v169
    v_mov_b32 v169, s81
    v_mov_b32 v171, s81
    v_mov_b32 v173, s81
    v_mov_b32 v175, s81
    buffer_store_dwordx4 v[168:171], v176, s[8:11], s31 offen sc1
    buffer_store_dwordx4 v[172:175], v176, s[8:11], s31 offen offset:16 sc1
    s_waitcnt vmcnt(0)
pk_c2:
    buffer_load_dwordx4 v[168:171], v176, s[8:11], s32 offen sc1
    buffer_load_dwordx4 v[172:175], v176, s[8:11], s32 offen offset:16 sc1
    s_waitcnt vmcnt(0)
pk_c1:
    v_xor_b32 v168, s81, v168
    v_xor_b32 v170, s81, v170
    v_xor_b32 v172, s81, v172
    v_xor_b32 v174, s81, v174
    v_or3_b32 v168, v168, v170, v172
    v_or_b32 v168, v168, v174
    v_cmp_ne_u32 vcc, 0, v168
    s_sub_u32 s22, s22, 1
    s_cbranch_scc1 pk_c3
    s_nop 4
    s_cbranch_vccnz pk_c0
pk_c3:
    s_max_i32 s22, s22, 0
    v_xor_b32 v169, s26, v169
    v_xor_b32 v171, s26, v171
    v_xor_b32 v173, s26, v173
    v_xor_b32 v175, s26, v175
    v_or3_b32 v168, v169, v171, v173
    v_or_b32 v168, v168, v175
    v_cmp_ne_u32 vcc, 0, v168
    s_lshl_b32 s30, s20, 2
    s_lshr_b64 s[30:31], vcc, s30
    s_and_b32 s30, s30, 15
    s_cselect_b32 s23, 0, 1
    ds_read_b128 v[80:83], v112 offset:16384
    ds_read_b128 v[12:15], v128 offset:16384
    s_mul_i32 s30, s28, 102400
    s_add_u32 s30, s30, 5317120
    s_add_u32 s16, s4, s30
    s_addc_u32 s17, s5, 0
    s_and_b32 s17, s17, 0xffff
    s_mov_b32 s18, 159232
    v_mfma_f32_32x32x16_bf16 v[64:79], a[120:123], v[84:87], v[64:79]
    ds_read_b128 v[84:87], v112 offset:20480
    ds_read_b128 v[16:19], v128 offset:18432
    s_add_u32 m0, s37, 69120
    s_nop 0
    buffer_load_dwordx4 v1, s[16:19], m0 offen lds
    v_mfma_f32_16x16x32_bf16 v[224:227], v[8:11], a[120:123], v[224:227]
    v_mfma_f32_32x32x16_bf16 v[192:207], a[120:123], v[88:91], v[192:207]
    ds_read_b64_tr_b16 a[132:133], v116 offset:4096
    ds_read_b64_tr_b16 a[134:135], v116 offset:5120
    ds_read_b128 v[88:91], v112 offset:24576
    ds_read_b128 v[138:141], v129 offset:16384
    s_add_u32 m0, s37, 73216
    s_nop 0
    buffer_load_dwordx4 v1, s[16:19], m0 offen lds
    v_mfma_f32_32x32x16_bf16 v[208:223], a[120:123], v[92:95], v[208:223]
    ds_read_b128 v[92:95], v112 offset:28672
    ds_read_b128 v[142:145], v129 offset:18432
    s_add_u32 m0, s37, 77312
    s_nop 0
    buffer_load_dwordx4 v1, s[16:19], m0 offen lds
    v_mfma_f32_32x32x16_bf16 v[48:63], a[124:127], v[96:99], v[48:63]
    ds_read_b128 v[96:99], v113 offset:16384
    s_add_u32 m0, s37, 81408
    s_nop 0
    buffer_load_dwordx4 v1, s[16:19], m0 offen lds
    v_mfma_f32_32x32x16_bf16 v[64:79], a[124:127], v[100:103], v[64:79]
    ds_read_b128 v[100:103], v113 offset:20480
    s_add_u32 m0, s37, 85504
    s_nop 0
    buffer_load_dwordx4 v1, s[16:19], m0 offen lds
    v_mfma_f32_16x16x32_bf16 v[224:227], v[8:11], a[124:127], v[224:227]
    v_mfma_f32_32x32x16_bf16 v[192:207], a[124:127], v[104:107], v[192:207]
    ds_read_b64_tr_b16 a[136:137], v116 offset:8192
    ds_read_b64_tr_b16 a[138:139], v116 offset:9216
    ds_read_b128 v[104:107], v113 offset:24576
    s_add_u32 m0, s37, 89600
    s_nop 0
    buffer_load_dwordx4 v1, s[16:19], m0 offen lds
    s_waitcnt lgkmcnt(13)
    v_mfma_f32_16x16x32_bf16 v[160:163], v[8:11], v[12:15], v[160:163]
    v_mfma_f32_32x32x16_bf16 v[208:223], a[124:127], v[108:111], v[208:223]
    ds_read_b128 v[108:111], v113 offset:28672
    s_add_u32 m0, s37, 93696
    s_nop 0
    buffer_load_dwordx4 v1, s[16:19], m0 offen lds
    v_mfma_f32_16x16x32_bf16 v[152:155], v[12:15], v[12:15], v[152:155]
    v_mfma_f32_32x32x16_bf16 v[48:63], a[128:131], v[80:83], v[48:63]
    ds_read_b128 v[80:83], v114 offset:16384
    s_add_u32 s101, s90, 2621440
    buffer_load_dwordx4 a[160:163], v1, s[8:11], s101 offen offset:0
    s_waitcnt lgkmcnt(13)
    v_mfma_f32_16x16x32_bf16 v[164:167], v[8:11], v[16:19], v[164:167]
    v_mfma_f32_32x32x16_bf16 v[64:79], a[128:131], v[84:87], v[64:79]
    ds_read_b128 v[84:87], v114 offset:20480
    s_add_u32 s101, s90, 2622464
    buffer_load_dwordx4 a[164:167], v1, s[8:11], s101 offen offset:0
    v_mfma_f32_16x16x32_bf16 v[224:227], v[8:11], a[128:131], v[224:227]
    s_waitcnt lgkmcnt(11)
    v_mfma_f32_32x32x16_bf16 v[192:207], a[128:131], v[88:91], v[192:207]
    ds_read_b64_tr_b16 a[140:141], v116 offset:12288
    ds_read_b64_tr_b16 a[142:143], v116 offset:13312
    ds_read_b128 v[88:91], v114 offset:24576
    s_add_u32 s101, s90, 2623488
    buffer_load_dwordx4 a[168:171], v1, s[8:11], s101 offen offset:0
    v_mfma_f32_16x16x32_bf16 v[156:159], v[16:19], v[16:19], v[156:159]
    s_waitcnt lgkmcnt(12)
    v_mfma_f32_32x32x16_bf16 v[208:223], a[128:131], v[92:95], v[208:223]
    ds_read_b128 v[92:95], v114 offset:28672
    s_add_u32 s101, s90, 2624512
    buffer_load_dwordx4 a[172:175], v1, s[8:11], s101 offen offset:0
    v_mfma_f32_16x16x32_bf16 v[160:163], v[8:11], v[138:141], v[160:163]
    s_waitcnt lgkmcnt(11)
    v_mfma_f32_32x32x16_bf16 v[48:63], a[132:135], v[96:99], v[48:63]
    ds_read_b128 v[96:99], v115 offset:16384
    s_add_u32 s101, s90, 2625536
    buffer_load_dwordx4 a[176:179], v1, s[8:11], s101 offen offset:0
    v_mfma_f32_16x16x32_bf16 v[152:155], v[138:141], v[138:141], v[152:155]
    s_waitcnt lgkmcnt(11)
    v_mfma_f32_32x32x16_bf16 v[64:79], a[132:135], v[100:103], v[64:79]
    ds_read_b128 v[100:103], v115 offset:20480
    s_add_u32 s101, s90, 2626560
    buffer_load_dwordx4 a[180:183], v1, s[8:11], s101 offen offset:0
    v_mfma_f32_16x16x32_bf16 v[224:227], v[8:11], a[132:135], v[224:227]
    s_waitcnt lgkmcnt(9)
    v_mfma_f32_32x32x16_bf16 v[192:207], a[132:135], v[104:107], v[192:207]
    ds_read_b128 v[104:107], v115 offset:24576
    v_mfma_f32_16x16x32_bf16 v[164:167], v[8:11], v[142:145], v[164:167]
    s_waitcnt lgkmcnt(9)
    v_mfma_f32_32x32x16_bf16 v[208:223], a[132:135], v[108:111], v[208:223]
    ds_read_b128 v[108:111], v115 offset:28672
    v_mfma_f32_16x16x32_bf16 v[156:159], v[142:145], v[142:145], v[156:159]
    s_waitcnt lgkmcnt(9)
    v_mfma_f32_32x32x16_bf16 v[48:63], a[136:139], v[80:83], v[48:63]
    s_waitcnt lgkmcnt(0)
    s_barrier
    ds_read_b64_tr_b16 a[144:145], v116 offset:32768
    ds_read_b64_tr_b16 a[146:147], v116 offset:33792
    ds_read_b128 v[80:83], v112 offset:49152
    ds_read_b128 v[12:15], v128 offset:49152
    s_add_u32 m0, s37, 97792
    s_nop 0
    buffer_load_dwordx4 v1, s[16:19], m0 offen lds
    v_mfma_f32_32x32x16_bf16 v[64:79], a[136:139], v[84:87], v[64:79]
    ds_read_b128 v[84:87], v112 offset:53248
    ds_read_b128 v[16:19], v128 offset:51200
    s_add_u32 m0, s37, 101888
    s_nop 0
    buffer_load_dwordx4 v1, s[16:19], m0 offen lds
    v_mfma_f32_16x16x32_bf16 v[224:227], v[8:11], a[136:139], v[224:227]
    v_mfma_f32_32x32x16_bf16 v[192:207], a[136:139], v[88:91], v[192:207]
    ds_read_b64_tr_b16 a[148:149], v116 offset:36864
    ds_read_b64_tr_b16 a[150:151], v116 offset:37888
    ds_read_b128 v[88:91], v112 offset:57344
    ds_read_b128 v[138:141], v129 offset:49152
    s_add_u32 m0, s37, 105984
    s_nop 0
    buffer_load_dwordx4 v1, s[16:19], m0 offen lds
    v_mfma_f32_32x32x16_bf16 v[208:223], a[136:139], v[92:95], v[208:223]
    ds_read_b128 v[92:95], v112 offset:61440
    ds_read_b128 v[142:145], v129 offset:51200
    s_add_u32 m0, s37, 110080
    s_nop 0
    buffer_load_dwordx4 v1, s[16:19], m0 offen lds
    v_mfma_f32_32x32x16_bf16 v[48:63], a[140:143], v[96:99], v[48:63]
    ds_read_b128 v[96:99], v113 offset:49152
    s_add_u32 m0, s37, 114176
    s_nop 0
    buffer_load_dwordx4 v1, s[16:19], m0 offen lds
    v_mfma_f32_32x32x16_bf16 v[64:79], a[140:143], v[100:103], v[64:79]
    ds_read_b128 v[100:103], v113 offset:53248
    s_add_u32 m0, s37, 118272
    s_nop 0
    buffer_load_dwordx4 v1, s[16:19], m0 offen lds
    v_mfma_f32_16x16x32_bf16 v[224:227], v[8:11], a[140:143], v[224:227]
    v_mfma_f32_32x32x16_bf16 v[192:207], a[140:143], v[104:107], v[192:207]
    ds_read_b64_tr_b16 a[152:153], v116 offset:40960
    ds_read_b64_tr_b16 a[154:155], v116 offset:41984
    ds_read_b128 v[104:107], v113 offset:57344
    s_add_u32 m0, s37, 122368
    s_nop 0
    buffer_load_dwordx4 v1, s[16:19], m0 offen lds
    s_waitcnt lgkmcnt(13)
    v_mfma_f32_16x16x32_bf16 v[160:163], v[8:11], v[12:15], v[160:163]
    v_mfma_f32_32x32x16_bf16 v[208:223], a[140:143], v[108:111], v[208:223]
    ds_read_b128 v[108:111], v113 offset:61440
    s_add_u32 m0, s37, 126464
    s_nop 0
    buffer_load_dwordx4 v1, s[16:19], m0 offen lds
    v_mfma_f32_16x16x32_bf16 v[152:155], v[12:15], v[12:15], v[152:155]
    v_mfma_f32_32x32x16_bf16 v[48:63], a[144:147], v[80:83], v[48:63]
    ds_read_b128 v[80:83], v114 offset:49152
    s_add_u32 m0, s37, 130560
    s_nop 0
    buffer_load_dwordx4 v1, s[16:19], m0 offen lds
    s_waitcnt lgkmcnt(13)
    v_mfma_f32_16x16x32_bf16 v[164:167], v[8:11], v[16:19], v[164:167]
    v_mfma_f32_32x32x16_bf16 v[64:79], a[144:147], v[84:87], v[64:79]
    ds_read_b128 v[84:87], v114 offset:53248
    s_add_u32 m0, s37, 134656
    s_nop 0
    buffer_load_dwordx4 v1, s[16:19], m0 offen lds
    v_mfma_f32_16x16x32_bf16 v[224:227], v[8:11], a[144:147], v[224:227]
    s_waitcnt lgkmcnt(11)
    v_mfma_f32_32x32x16_bf16 v[192:207], a[144:147], v[88:91], v[192:207]
    ds_read_b64_tr_b16 a[156:157], v116 offset:45056
    ds_read_b64_tr_b16 a[158:159], v116 offset:46080
    ds_read_b128 v[88:91], v114 offset:57344
    s_add_u32 s101, s90, 2627584
    buffer_load_dwordx4 a[184:187], v1, s[8:11], s101 offen offset:0
    v_mfma_f32_16x16x32_bf16 v[156:159], v[16:19], v[16:19], v[156:159]
    s_waitcnt lgkmcnt(12)
    v_mfma_f32_32x32x16_bf16 v[208:223], a[144:147], v[92:95], v[208:223]
    ds_read_b128 v[92:95], v114 offset:61440
    s_add_u32 s101, s90, 2628608
    buffer_load_dwordx4 a[188:191], v1, s[8:11], s101 offen offset:0
    v_mfma_f32_16x16x32_bf16 v[160:163], v[8:11], v[138:141], v[160:163]
    s_waitcnt lgkmcnt(11)
    v_mfma_f32_32x32x16_bf16 v[48:63], a[148:151], v[96:99], v[48:63]
    ds_read_b128 v[96:99], v115 offset:49152
    s_add_u32 s101, s90, 2629632
    buffer_load_dwordx4 a[192:195], v1, s[8:11], s101 offen offset:0
    v_mfma_f32_16x16x32_bf16 v[152:155], v[138:141], v[138:141], v[152:155]
    s_waitcnt lgkmcnt(11)
    v_mfma_f32_32x32x16_bf16 v[64:79], a[148:151], v[100:103], v[64:79]
    ds_read_b128 v[100:103], v115 offset:53248
    s_add_u32 s101, s90, 2630656
    buffer_load_dwordx4 a[196:199], v1, s[8:11], s101 offen offset:0
    v_mfma_f32_16x16x32_bf16 v[224:227], v[8:11], a[148:151], v[224:227]
    s_waitcnt lgkmcnt(9)
    v_mfma_f32_32x32x16_bf16 v[192:207], a[148:151], v[104:107], v[192:207]
    ds_read_b128 v[104:107], v115 offset:57344
    s_add_u32 s101, s90, 2631680
    buffer_load_dwordx4 a[200:203], v1, s[8:11], s101 offen offset:0
    v_mfma_f32_16x16x32_bf16 v[164:167], v[8:11], v[142:145], v[164:167]
    s_waitcnt lgkmcnt(9)
    v_mfma_f32_32x32x16_bf16 v[208:223], a[148:151], v[108:111], v[208:223]
    ds_read_b128 v[108:111], v115 offset:61440
    s_add_u32 s101, s90, 2632704
    buffer_load_dwordx4 a[204:207], v1, s[8:11], s101 offen offset:0
    v_mfma_f32_16x16x32_bf16 v[156:159], v[142:145], v[142:145], v[156:159]
    s_waitcnt lgkmcnt(9)
    v_mfma_f32_32x32x16_bf16 v[48:63], a[152:155], v[80:83], v[48:63]
    s_add_u32 s101, s90, 2633728
    buffer_load_dwordx4 a[208:211], v1, s[8:11], s101 offen offset:0
    s_mov_b32 s96, 0xaaaaaaaa
    s_mov_b32 s97, 0xaaaaaaaa
    s_mov_b32 vcc_lo, 0xcccccccc
    s_mov_b32 vcc_hi, 0xcccccccc
    s_waitcnt lgkmcnt(8)
    v_mfma_f32_32x32x16_bf16 v[64:79], a[152:155], v[84:87], v[64:79]
    s_add_u32 s101, s90, 2634752
    buffer_load_dwordx4 a[212:215], v1, s[8:11], s101 offen offset:0
    v_permlane16_swap_b32 v160, v164
    v_cndmask_b32 v152, v152, v153, s[96:97]
    v_cndmask_b32 v154, v154, v155, s[96:97]
    v_cndmask_b32 v156, v156, v157, s[96:97]
    v_mfma_f32_16x16x32_bf16 v[224:227], v[8:11], a[152:155], v[224:227]
    s_waitcnt lgkmcnt(5)
    v_mfma_f32_32x32x16_bf16 v[192:207], a[152:155], v[88:91], v[192:207]
    v_cndmask_b32 v158, v158, v159, s[96:97]
    v_cndmask_b32 v152, v152, v154, vcc
    v_cndmask_b32 v156, v156, v158, vcc
    s_mov_b32 vcc_lo, 0xf0f0f0f0
    s_waitcnt lgkmcnt(4)
    v_mfma_f32_32x32x16_bf16 v[208:223], a[152:155], v[92:95], v[208:223]
    s_mov_b32 vcc_hi, 0xf0f0f0f0
    v_add_f32 v133, v160, v164
    v_permlane16_swap_b32 v152, v156
    v_mul_f32 v135, 0x3acccccd, v133
    s_waitcnt lgkmcnt(3)
    v_mfma_f32_32x32x16_bf16 v[48:63], a[156:159], v[96:99], v[48:63]
    v_lshl_add_u32 v132, s3, 8, v41
    v_cndmask_b32 v134, v152, v156, vcc
    v_fma_f32 v134, -v135, v133, v134
    v_cvt_pk_bf16_f32 v136, -v135, -v135
    s_waitcnt lgkmcnt(2)
    v_mfma_f32_32x32x16_bf16 v[64:79], a[156:159], v[100:103], v[64:79]
    v_max_f32 v134, 0, v134
    v_mul_f32 v134, 0x3acccccd, v134
    v_cvt_pk_bf16_f32 v134, v134, v134
    v_lshlrev_b32 v134, 16, v134
    v_mfma_f32_16x16x32_bf16 v[224:227], v[8:11], a[156:159], v[224:227]
    s_waitcnt lgkmcnt(1)
    v_mfma_f32_32x32x16_bf16 v[192:207], a[156:159], v[104:107], v[192:207]
    v_add_f32 v134, 0x3727c5ac, v134
    v_cvt_pk_bf16_f32 v134, v134, v134
    v_lshlrev_b32 v134, 16, v134
    v_sqrt_f32 v134, v134
    s_waitcnt lgkmcnt(0)
    v_mfma_f32_32x32x16_bf16 v[208:223], a[156:159], v[108:111], v[208:223]
    v_cvt_pk_bf16_f32 v134, v134, v134
    v_lshlrev_b32 v134, 16, v134
    v_rcp_f32 v137, v134
    s_nop 0
    v_and_b32 v137, 0xffffff7f, v137
    s_mov_b32 exec_lo, 0x00ff00ff
    s_mov_b32 exec_hi, 0xff00ff00
    ds_write_b64 v132, v[136:137]
    s_mov_b64 exec, -1
    v_cvt_pk_bf16_f32 v12, v224, v224
    v_lshlrev_b32 v13, 16, v12
    v_sub_f32 v224, v224, v13
    v_cvt_pk_bf16_f32 v13, v224, v224
    v_and_b32 v13, 0xffff0000, v13
    v_sub_f32 v224, v224, v13
    v_and_b32 v12, 0xffff, v12
    v_or_b32 v12, v12, v13
    v_mov_b32 v14, 0
    v_cvt_pk_bf16_f32 v13, v224, v14
    v_mov_b32 v15, 0
    v_cmp_gt_u32 vcc, 32, v0
    s_nop 1
    v_cndmask_b32 v12, v13, v12, vcc
    v_mov_b32 v13, 0
    s_waitcnt lgkmcnt(0)
    s_barrier
    ds_read_b32 v124, v41 offset:0
    ds_read_b32 v125, v41 offset:256
    ds_read_b32 v126, v41 offset:512
    ds_read_b32 v127, v41 offset:768
    ds_read_b32 v2, v41 offset:4
    ds_read_b32 v3, v41 offset:260
    s_waitcnt lgkmcnt(0)
    v_mul_f32 v5, 0x3fb8aa3b, v3
    v_mul_f32 v4, 0x3fb8aa3b, v2
    v_mov_b32 v8, v124
    v_mov_b32 v9, v124
    v_mov_b32 v10, v124
    v_mov_b32 v11, v124
    s_nop 1
    v_mfma_f32_32x32x16_bf16 v[48:63], v[12:15], v[8:11], v[48:63]
    v_mov_b32 v152, v125
    v_mov_b32 v153, v125
    v_mov_b32 v154, v125
    v_mov_b32 v155, v125
    s_nop 1
    v_mfma_f32_32x32x16_bf16 v[64:79], v[12:15], v[152:155], v[64:79]
    v_mov_b32 v8, v126
    v_mov_b32 v9, v126
    v_mov_b32 v10, v126
    v_mov_b32 v11, v126
    s_nop 1
    v_mfma_f32_32x32x16_bf16 v[192:207], v[12:15], v[8:11], v[192:207]
    v_mov_b32 v152, v127
    v_mov_b32 v153, v127
    v_mov_b32 v154, v127
    v_mov_b32 v155, v127
    s_nop 1
    v_mfma_f32_32x32x16_bf16 v[208:223], v[12:15], v[152:155], v[208:223]
    s_cmp_ge_u32 s3, 2
    s_cselect_b32 s30, 18944, 0
    v_add_u32 v33, s30, v32
    v_pk_mul_f32 v[60:61], v[60:61], v[2:3] op_sel:[0,0] op_sel_hi:[1,0]
    v_pk_mul_f32 v[62:63], v[62:63], v[2:3] op_sel:[0,0] op_sel_hi:[1,0]
    v_cvt_pk_bf16_f32 v144, v60, v61
    s_add_u32 m0, s37, 56832
    s_nop 0
    buffer_load_dwordx4 v1, s[16:19], m0 offen lds
    v_cvt_pk_bf16_f32 v145, v62, v63
    ds_write_b64 v33, v[144:145] offset:48
    v_pk_mul_f32 v[112:113], v[56:57], v[4:5] op_sel:[0,0] op_sel_hi:[1,0]
    v_pk_mul_f32 v[114:115], v[58:59], v[4:5] op_sel:[0,0] op_sel_hi:[1,0]
    v_max_f32 v116, s84, v56
    v_max_f32 v117, s84, v57
    v_max_f32 v118, s84, v58
    v_max_f32 v119, s84, v59
    v_exp_f32_e64 v112, v112 clamp
    v_exp_f32_e64 v113, v113 clamp
    v_exp_f32_e64 v114, v114 clamp
    v_exp_f32_e64 v115, v115 clamp
    s_add_u32 m0, s37, 60928
    s_nop 0
    buffer_load_dwordx4 v1, s[16:19], m0 offen lds
    v_pk_fma_f32 v[116:117], v[116:117], v[2:3], s[84:85] op_sel:[0,0,1] op_sel_hi:[1,0,1]
    v_pk_fma_f32 v[118:119], v[118:119], v[2:3], s[84:85] op_sel:[0,0,1] op_sel_hi:[1,0,1]
    v_pk_fma_f32 v[112:113], v[112:113], s[86:87], v[116:117] op_sel:[0,0,0] op_sel_hi:[1,0,1]
    v_pk_fma_f32 v[114:115], v[114:115], s[86:87], v[118:119] op_sel:[0,0,0] op_sel_hi:[1,0,1]
    v_cvt_pk_bf16_f32 v142, v112, v113
    v_cvt_pk_bf16_f32 v143, v114, v115
    v_cndmask_b32 v146, v142, v151, s[88:89]
    v_cndmask_b32 v147, v143, 0, s[88:89]
    ds_write_b64 v33, v[146:147] offset:56
    v_cndmask_b32 v142, 0, v142, s[88:89]
    v_cndmask_b32 v143, 0, v143, s[88:89]
    ds_write_b64 v33, v[142:143] offset:16
    s_add_u32 m0, s37, 65024
    s_nop 0
    buffer_load_dwordx4 v1, s[16:19], m0 offen lds
    v_pk_mul_f32 v[112:113], v[48:49], v[4:5] op_sel:[0,0] op_sel_hi:[1,0]
    v_pk_mul_f32 v[114:115], v[50:51], v[4:5] op_sel:[0,0] op_sel_hi:[1,0]
    v_max_f32 v116, 0, v48
    v_max_f32 v117, 0, v49
    v_max_f32 v118, 0, v50
    v_max_f32 v119, 0, v51
    v_exp_f32_e64 v112, v112 clamp
    v_exp_f32_e64 v113, v113 clamp
    v_exp_f32_e64 v114, v114 clamp
    v_exp_f32_e64 v115, v115 clamp
    v_pk_fma_f32 v[116:117], v[116:117], v[2:3], s[24:25] op_sel:[0,0,0] op_sel_hi:[1,0,0]
    v_pk_fma_f32 v[118:119], v[118:119], v[2:3], s[24:25] op_sel:[0,0,0] op_sel_hi:[1,0,0]
    s_add_u32 m0, s37, 138752
    s_min_u32 m0, m0, 139776
    s_nop 0
    buffer_load_dwordx4 v1, s[16:19], m0 offen lds
    v_pk_add_f32 v[112:113], v[112:113], v[116:117]
    v_pk_add_f32 v[114:115], v[114:115], v[118:119]
    v_cvt_pk_bf16_f32 v138, v112, v113
    v_cvt_pk_bf16_f32 v139, v114, v115
    ds_write_b64 v33, v[138:139] offset:0
    v_pk_mul_f32 v[112:113], v[52:53], v[4:5] op_sel:[0,0] op_sel_hi:[1,0]
    v_pk_mul_f32 v[114:115], v[54:55], v[4:5] op_sel:[0,0] op_sel_hi:[1,0]
    v_max_f32 v116, 0, v52
    v_max_f32 v117, 0, v53
    v_max_f32 v118, 0, v54
    v_max_f32 v119, 0, v55
    v_exp_f32_e64 v112, v112 clamp
    s_add_u32 s101, s90, 2635776
    buffer_load_dwordx4 a[216:219], v1, s[8:11], s101 offen offset:0
    v_exp_f32_e64 v113, v113 clamp
    v_exp_f32_e64 v114, v114 clamp
    v_exp_f32_e64 v115, v115 clamp
    v_pk_fma_f32 v[116:117], v[116:117], v[2:3], s[24:25] op_sel:[0,0,0] op_sel_hi:[1,0,0]
    v_pk_fma_f32 v[118:119], v[118:119], v[2:3], s[24:25] op_sel:[0,0,0] op_sel_hi:[1,0,0]
    v_pk_add_f32 v[112:113], v[112:113], v[116:117]
    v_pk_add_f32 v[114:115], v[114:115], v[118:119]
    v_cvt_pk_bf16_f32 v140, v112, v113
    v_cvt_pk_bf16_f32 v141, v114, v115
    ds_write_b64 v33, v[140:141] offset:8
    ds_read_b32 v2, v41 offset:516
    s_waitcnt lgkmcnt(0)
    s_add_u32 s101, s90, 2636800
    buffer_load_dwordx4 a[220:223], v1, s[8:11], s101 offen offset:0
    v_mul_f32 v4, 0x3fb8aa3b, v2
    v_pk_mul_f32 v[76:77], v[76:77], v[2:3] op_sel:[0,1] op_sel_hi:[1,1]
    v_pk_mul_f32 v[78:79], v[78:79], v[2:3] op_sel:[0,1] op_sel_hi:[1,1]
    v_cvt_pk_bf16_f32 v144, v76, v77
    v_cvt_pk_bf16_f32 v145, v78, v79
    s_add_u32 s101, s90, 2637824
    buffer_load_dwordx4 a[224:227], v1, s[8:11], s101 offen offset:0
    ds_write_b64 v33, v[144:145] offset:9520
    v_pk_mul_f32 v[112:113], v[72:73], v[4:5] op_sel:[0,1] op_sel_hi:[1,1]
    v_pk_mul_f32 v[114:115], v[74:75], v[4:5] op_sel:[0,1] op_sel_hi:[1,1]
    v_max_f32 v116, s84, v72
    v_max_f32 v117, s84, v73
    v_max_f32 v118, s84, v74
    v_max_f32 v119, s84, v75
    v_exp_f32_e64 v112, v112 clamp
    v_exp_f32_e64 v113, v113 clamp
    v_exp_f32_e64 v114, v114 clamp
    v_exp_f32_e64 v115, v115 clamp
    v_pk_fma_f32 v[116:117], v[116:117], v[2:3], s[84:85] op_sel:[0,1,1] op_sel_hi:[1,1,1]
    s_add_u32 s101, s90, 2638848
    buffer_load_dwordx4 a[228:231], v1, s[8:11], s101 offen offset:0
    v_pk_fma_f32 v[118:119], v[118:119], v[2:3], s[84:85] op_sel:[0,1,1] op_sel_hi:[1,1,1]
    v_pk_fma_f32 v[112:113], v[112:113], s[86:87], v[116:117] op_sel:[0,0,0] op_sel_hi:[1,0,1]
    v_pk_fma_f32 v[114:115], v[114:115], s[86:87], v[118:119] op_sel:[0,0,0] op_sel_hi:[1,0,1]
    v_cvt_pk_bf16_f32 v142, v112, v113
    v_cvt_pk_bf16_f32 v143, v114, v115
    v_cndmask_b32 v146, v142, v151, s[88:89]
    v_cndmask_b32 v147, v143, 0, s[88:89]
    ds_write_b64 v33, v[146:147] offset:9528
    v_cndmask_b32 v142, 0, v142, s[88:89]
    v_cndmask_b32 v143, 0, v143, s[88:89]
    ds_write_b64 v33, v[142:143] offset:9488
    v_pk_mul_f32 v[112:113], v[64:65], v[4:5] op_sel:[0,1] op_sel_hi:[1,1]
    s_add_u32 s101, s90, 2639872
    buffer_load_dwordx4 a[232:235], v1, s[8:11], s101 offen offset:0
    v_pk_mul_f32 v[114:115], v[66:67], v[4:5] op_sel:[0,1] op_sel_hi:[1,1]
    v_max_f32 v116, 0, v64
    v_max_f32 v117, 0, v65
    v_max_f32 v118, 0, v66
    v_max_f32 v119, 0, v67
    v_exp_f32_e64 v112, v112 clamp
    v_exp_f32_e64 v113, v113 clamp
    v_exp_f32_e64 v114, v114 clamp
    v_exp_f32_e64 v115, v115 clamp
    v_pk_fma_f32 v[116:117], v[116:117], v[2:3], s[24:25] op_sel:[0,1,0] op_sel_hi:[1,1,0]
    v_pk_fma_f32 v[118:119], v[118:119], v[2:3], s[24:25] op_sel:[0,1,0] op_sel_hi:[1,1,0]
    v_pk_add_f32 v[112:113], v[112:113], v[116:117]
    s_add_u32 s101, s90, 2640896
    buffer_load_dwordx4 a[236:239], v1, s[8:11], s101 offen offset:0
    v_pk_add_f32 v[114:115], v[114:115], v[118:119]
    v_cvt_pk_bf16_f32 v138, v112, v113
    v_cvt_pk_bf16_f32 v139, v114, v115
    ds_write_b64 v33, v[138:139] offset:9472
    v_pk_mul_f32 v[112:113], v[68:69], v[4:5] op_sel:[0,1] op_sel_hi:[1,1]
    v_pk_mul_f32 v[114:115], v[70:71], v[4:5] op_sel:[0,1] op_sel_hi:[1,1]
    v_max_f32 v116, 0, v68
    v_max_f32 v117, 0, v69
    v_max_f32 v118, 0, v70
    v_max_f32 v119, 0, v71
    v_exp_f32_e64 v112, v112 clamp
    v_exp_f32_e64 v113, v113 clamp
    v_exp_f32_e64 v114, v114 clamp
    v_exp_f32_e64 v115, v115 clamp
    v_pk_fma_f32 v[116:117], v[116:117], v[2:3], s[24:25] op_sel:[0,1,0] op_sel_hi:[1,1,0]
    v_pk_fma_f32 v[118:119], v[118:119], v[2:3], s[24:25] op_sel:[0,1,0] op_sel_hi:[1,1,0]
    v_pk_add_f32 v[112:113], v[112:113], v[116:117]
    v_pk_add_f32 v[114:115], v[114:115], v[118:119]
    v_cvt_pk_bf16_f32 v140, v112, v113
    v_cvt_pk_bf16_f32 v141, v114, v115
    ds_write_b64 v33, v[140:141] offset:9480
    ds_read_b32 v3, v41 offset:772
    s_waitcnt lgkmcnt(0)
    v_mul_f32 v5, 0x3fb8aa3b, v3
    s_mov_b32 s31, 140800
    s_cmp_ge_u32 s3, 2
    s_cselect_b32 s30, 37888, s31
    v_add_u32 v33, s30, v32
    v_pk_mul_f32 v[204:205], v[204:205], v[2:3] op_sel:[0,0] op_sel_hi:[1,0]
    v_pk_mul_f32 v[206:207], v[206:207], v[2:3] op_sel:[0,0] op_sel_hi:[1,0]
    v_cvt_pk_bf16_f32 v144, v204, v205
    v_cvt_pk_bf16_f32 v145, v206, v207
    ds_write_b64 v33, v[144:145] offset:48
    v_pk_mul_f32 v[112:113], v[200:201], v[4:5] op_sel:[0,0] op_sel_hi:[1,0]
    v_pk_mul_f32 v[114:115], v[202:203], v[4:5] op_sel:[0,0] op_sel_hi:[1,0]
    v_max_f32 v116, s84, v200
    v_max_f32 v117, s84, v201
    v_max_f32 v118, s84, v202
    v_max_f32 v119, s84, v203
    v_exp_f32_e64 v112, v112 clamp
    v_exp_f32_e64 v113, v113 clamp
    v_exp_f32_e64 v114, v114 clamp
    v_exp_f32_e64 v115, v115 clamp
    v_pk_fma_f32 v[116:117], v[116:117], v[2:3], s[84:85] op_sel:[0,0,1] op_sel_hi:[1,0,1]
    v_pk_fma_f32 v[118:119], v[118:119], v[2:3], s[84:85] op_sel:[0,0,1] op_sel_hi:[1,0,1]
    v_pk_fma_f32 v[112:113], v[112:113], s[86:87], v[116:117] op_sel:[0,0,0] op_sel_hi:[1,0,1]
    v_pk_fma_f32 v[114:115], v[114:115], s[86:87], v[118:119] op_sel:[0,0,0] op_sel_hi:[1,0,1]
    v_cvt_pk_bf16_f32 v142, v112, v113
    v_cvt_pk_bf16_f32 v143, v114, v115
    v_cndmask_b32 v146, v142, v151, s[88:89]
    v_cndmask_b32 v147, v143, 0, s[88:89]
    ds_write_b64 v33, v[146:147] offset:56
    v_cndmask_b32 v142, 0, v142, s[88:89]
    v_cndmask_b32 v143, 0, v143, s[88:89]
    ds_write_b64 v33, v[142:143] offset:16
    v_pk_mul_f32 v[112:113], v[192:193], v[4:5] op_sel:[0,0] op_sel_hi:[1,0]
    v_pk_mul_f32 v[114:115], v[194:195], v[4:5] op_sel:[0,0] op_sel_hi:[1,0]
    v_max_f32 v116, 0, v192
    v_max_f32 v117, 0, v193
    v_max_f32 v118, 0, v194
    v_max_f32 v119, 0, v195
    v_exp_f32_e64 v112, v112 clamp
    v_exp_f32_e64 v113, v113 clamp
    v_exp_f32_e64 v114, v114 clamp
    v_exp_f32_e64 v115, v115 clamp
    v_pk_fma_f32 v[116:117], v[116:117], v[2:3], s[24:25] op_sel:[0,0,0] op_sel_hi:[1,0,0]
    v_pk_fma_f32 v[118:119], v[118:119], v[2:3], s[24:25] op_sel:[0,0,0] op_sel_hi:[1,0,0]
    v_pk_add_f32 v[112:113], v[112:113], v[116:117]
    v_pk_add_f32 v[114:115], v[114:115], v[118:119]
    v_cvt_pk_bf16_f32 v138, v112, v113
    v_cvt_pk_bf16_f32 v139, v114, v115
    ds_write_b64 v33, v[138:139] offset:0
    v_pk_mul_f32 v[112:113], v[196:197], v[4:5] op_sel:[0,0] op_sel_hi:[1,0]
    v_pk_mul_f32 v[114:115], v[198:199], v[4:5] op_sel:[0,0] op_sel_hi:[1,0]
    v_max_f32 v116, 0, v196
    v_max_f32 v117, 0, v197
    v_max_f32 v118, 0, v198
    v_max_f32 v119, 0, v199
    v_exp_f32_e64 v112, v112 clamp
    v_exp_f32_e64 v113, v113 clamp
    v_exp_f32_e64 v114, v114 clamp
    v_exp_f32_e64 v115, v115 clamp
    v_pk_fma_f32 v[116:117], v[116:117], v[2:3], s[24:25] op_sel:[0,0,0] op_sel_hi:[1,0,0]
    v_pk_fma_f32 v[118:119], v[118:119], v[2:3], s[24:25] op_sel:[0,0,0] op_sel_hi:[1,0,0]
    v_pk_add_f32 v[112:113], v[112:113], v[116:117]
    v_pk_add_f32 v[114:115], v[114:115], v[118:119]
    v_cvt_pk_bf16_f32 v140, v112, v113
    v_cvt_pk_bf16_f32 v141, v114, v115
    ds_write_b64 v33, v[140:141] offset:8
    v_pk_mul_f32 v[220:221], v[220:221], v[2:3] op_sel:[0,1] op_sel_hi:[1,1]
    v_pk_mul_f32 v[222:223], v[222:223], v[2:3] op_sel:[0,1] op_sel_hi:[1,1]
    v_cvt_pk_bf16_f32 v144, v220, v221
    v_cvt_pk_bf16_f32 v145, v222, v223
    ds_write_b64 v33, v[144:145] offset:9520
    v_pk_mul_f32 v[112:113], v[216:217], v[4:5] op_sel:[0,1] op_sel_hi:[1,1]
    v_pk_mul_f32 v[114:115], v[218:219], v[4:5] op_sel:[0,1] op_sel_hi:[1,1]
    v_max_f32 v116, s84, v216
    v_max_f32 v117, s84, v217
    v_max_f32 v118, s84, v218
    v_max_f32 v119, s84, v219
    v_exp_f32_e64 v112, v112 clamp
    v_exp_f32_e64 v113, v113 clamp
    v_exp_f32_e64 v114, v114 clamp
    v_exp_f32_e64 v115, v115 clamp
    v_pk_fma_f32 v[116:117], v[116:117], v[2:3], s[84:85] op_sel:[0,1,1] op_sel_hi:[1,1,1]
    v_pk_fma_f32 v[118:119], v[118:119], v[2:3], s[84:85] op_sel:[0,1,1] op_sel_hi:[1,1,1]
    v_pk_fma_f32 v[112:113], v[112:113], s[86:87], v[116:117] op_sel:[0,0,0] op_sel_hi:[1,0,1]
    v_pk_fma_f32 v[114:115], v[114:115], s[86:87], v[118:119] op_sel:[0,0,0] op_sel_hi:[1,0,1]
    v_cvt_pk_bf16_f32 v142, v112, v113
    v_cvt_pk_bf16_f32 v143, v114, v115
    v_cndmask_b32 v146, v142, v151, s[88:89]
    v_cndmask_b32 v147, v143, 0, s[88:89]
    ds_write_b64 v33, v[146:147] offset:9528
    v_cndmask_b32 v142, 0, v142, s[88:89]
    v_cndmask_b32 v143, 0, v143, s[88:89]
    ds_write_b64 v33, v[142:143] offset:9488
    v_pk_mul_f32 v[112:113], v[208:209], v[4:5] op_sel:[0,1] op_sel_hi:[1,1]
    v_pk_mul_f32 v[114:115], v[210:211], v[4:5] op_sel:[0,1] op_sel_hi:[1,1]
    v_max_f32 v116, 0, v208
    v_max_f32 v117, 0, v209
    v_max_f32 v118, 0, v210
    v_max_f32 v119, 0, v211
    v_exp_f32_e64 v112, v112 clamp
    v_exp_f32_e64 v113, v113 clamp
    v_exp_f32_e64 v114, v114 clamp
    v_exp_f32_e64 v115, v115 clamp
    v_pk_fma_f32 v[116:117], v[116:117], v[2:3], s[24:25] op_sel:[0,1,0] op_sel_hi:[1,1,0]
    v_pk_fma_f32 v[118:119], v[118:119], v[2:3], s[24:25] op_sel:[0,1,0] op_sel_hi:[1,1,0]
    v_pk_add_f32 v[112:113], v[112:113], v[116:117]
    v_pk_add_f32 v[114:115], v[114:115], v[118:119]
    v_cvt_pk_bf16_f32 v138, v112, v113
    v_cvt_pk_bf16_f32 v139, v114, v115
    ds_write_b64 v33, v[138:139] offset:9472
    v_pk_mul_f32 v[112:113], v[212:213], v[4:5] op_sel:[0,1] op_sel_hi:[1,1]
    v_pk_mul_f32 v[114:115], v[214:215], v[4:5] op_sel:[0,1] op_sel_hi:[1,1]
    v_max_f32 v116, 0, v212
    v_max_f32 v117, 0, v213
    v_max_f32 v118, 0, v214
    v_max_f32 v119, 0, v215
    v_exp_f32_e64 v112, v112 clamp
    v_exp_f32_e64 v113, v113 clamp
    v_exp_f32_e64 v114, v114 clamp
    v_exp_f32_e64 v115, v115 clamp
    v_pk_fma_f32 v[116:117], v[116:117], v[2:3], s[24:25] op_sel:[0,1,0] op_sel_hi:[1,1,0]
    v_pk_fma_f32 v[118:119], v[118:119], v[2:3], s[24:25] op_sel:[0,1,0] op_sel_hi:[1,1,0]
    v_pk_add_f32 v[112:113], v[112:113], v[116:117]
    v_pk_add_f32 v[114:115], v[114:115], v[118:119]
    v_cvt_pk_bf16_f32 v140, v112, v113
    v_cvt_pk_bf16_f32 v141, v114, v115
    ds_write_b64 v33, v[140:141] offset:9480
    s_mul_i32 s34, s21, 131072
    s_add_u32 s34, s34, 41943040
    s_lshl_b32 s31, s20, 7
    s_add_u32 s35, s34, s31
    v_mov_b32 v136, 1073741824
    s_mov_b32 s31, 140800
    s_bitcmp1_b32 s3, 0
    s_cselect_b32 s30, 18944, 0
    v_add_u32 v112, s30, v39
    s_cselect_b32 s30, 18944, 0
    v_add_u32 v113, s30, v39
    s_cselect_b32 s30, 37888, s31
    v_add_u32 v114, s30, v39
    s_cselect_b32 s30, 37888, s31
    v_add_u32 v115, s30, v39
    v_add_u32 v116, s31, v37
    v_add_u32 v117, s31, v38
    s_waitcnt vmcnt(44)
    s_waitcnt vmcnt(41)
    s_waitcnt lgkmcnt(0)
    s_barrier
    ds_read_b64_tr_b16 v[48:49], v112 offset:0
    ds_read_b64_tr_b16 v[50:51], v112 offset:4736
    ds_read_b64_tr_b16 v[52:53], v37 offset:0
    ds_read_b64_tr_b16 v[54:55], v37 offset:4736
    ds_read_b64_tr_b16 v[56:57], v38 offset:0
    ds_read_b64_tr_b16 v[58:59], v38 offset:4736
    ds_read_b64_tr_b16 v[60:61], v113 offset:9472
    ds_read_b64_tr_b16 v[62:63], v113 offset:14208
    ds_read_b64_tr_b16 v[64:65], v37 offset:9472
    ds_read_b64_tr_b16 v[66:67], v37 offset:14208
    ds_read_b64_tr_b16 v[68:69], v38 offset:9472
    ds_read_b64_tr_b16 v[70:71], v38 offset:14208
    ds_read_b64_tr_b16 v[72:73], v114 offset:0
    ds_read_b64_tr_b16 v[74:75], v114 offset:4736
    ds_read_b64_tr_b16 v[76:77], v116 offset:0
    ds_read_b64_tr_b16 v[78:79], v116 offset:4736
    ds_read_b64_tr_b16 v[80:81], v117 offset:0
    ds_read_b64_tr_b16 v[82:83], v117 offset:4736
    ds_read_b64_tr_b16 v[84:85], v115 offset:9472
    ds_read_b64_tr_b16 v[86:87], v115 offset:14208
    ds_read_b64_tr_b16 v[88:89], v116 offset:9472
    ds_read_b64_tr_b16 v[90:91], v116 offset:14208
    ds_read_b64_tr_b16 v[92:93], v117 offset:9472
    ds_read_b64_tr_b16 v[94:95], v117 offset:14208
    s_waitcnt lgkmcnt(15)
    v_mfma_f32_16x16x32_bf16 v[168:171], v[52:55], v[48:51], 0
    v_mfma_f32_16x16x32_bf16 v[172:175], v[56:59], v[48:51], 0
    s_waitcnt lgkmcnt(12)
    v_mfma_f32_16x16x32_bf16 v[168:171], v[64:67], v[60:63], v[168:171]
    v_mfma_f32_16x16x32_bf16 v[172:175], v[68:71], v[60:63], v[172:175]
    s_waitcnt lgkmcnt(6)
    v_mfma_f32_16x16x32_bf16 v[168:171], v[76:79], v[72:75], v[168:171]
    v_mfma_f32_16x16x32_bf16 v[172:175], v[80:83], v[72:75], v[172:175]
    s_waitcnt lgkmcnt(0)
    v_mfma_f32_16x16x32_bf16 v[168:171], v[88:91], v[84:87], v[168:171]
    v_mfma_f32_16x16x32_bf16 v[172:175], v[92:95], v[84:87], v[172:175]
    s_nop 6
    buffer_store_dwordx4 v[168:171], v188, s[8:11], s35 offen sc1
    buffer_store_dwordx4 v[172:175], v189, s[8:11], s35 offen sc1
    s_add_u32 s101, s90, 2641920
    buffer_load_dwordx4 a[240:243], v1, s[8:11], s101 offen offset:0
    s_add_u32 s101, s90, 2642944
    buffer_load_dwordx4 a[244:247], v1, s[8:11], s101 offen offset:0
    s_add_u32 s101, s90, 2643968
    buffer_load_dwordx4 a[248:251], v1, s[8:11], s101 offen offset:0
    s_add_u32 s101, s90, 2644992
    buffer_load_dwordx4 a[252:255], v1, s[8:11], s101 offen offset:0
    ds_read_b64 v[80:81], v47 offset:0
    ds_read_b64 v[82:83], v47 offset:8
    ds_read_b64 v[84:85], v47 offset:16
    v_mov_b32 v86, 0
    v_mov_b32 v87, 0
    ds_read_b64 v[92:93], v47 offset:128
    ds_read_b64 v[94:95], v47 offset:136
    ds_read_b64 v[96:97], v47 offset:144
    v_mov_b32 v98, 0
    v_mov_b32 v99, 0
    s_lshl_b32 s30, s3, 4
    s_add_u32 s30, s30, s20
    s_lshl_b32 s31, s30, 11
    s_add_u32 s34, s34, s31
    s_lshl_b32 s35, s21, 13
    s_add_u32 s35, s35, 50331648
    s_lshl_b32 s31, s30, 7
    s_add_u32 s36, s35, s31
    v_and_b32 v132, 7, v0
    v_lshrrev_b32 v133, 5, v0
    v_lshlrev_b32 v132, 3, v132
    v_lshl_add_u32 v132, v133, 2, v132
    v_bfe_u32 v133, v0, 3, 2
    v_lshl_add_u32 v138, v133, 17, v132
    v_add_u32 v141, 524288, v138
    v_lshrrev_b32 v132, 2, v0
    v_and_b32 v133, 3, v0
    v_lshlrev_b32 v133, 4, v133
    v_lshl_add_u32 v132, v132, 7, v133
    v_cmp_gt_u32 vcc, 36, v0
    s_nop 1
    v_cndmask_b32 v139, v136, v132, vcc
    s_mul_i32 s31, s3, 576
    s_add_u32 s35, s35, s31
    s_add_u32 s35, s35, s31
    s_lshr_b32 s32, s20, 1
    s_lshl_b32 s32, s32, 17
    s_add_u32 s35, s35, s32
    v_add_u32 v132, s31, v1
    v_add_u32 v133, 0x1000, v1
    v_cndmask_b32 v140, v133, v132, vcc
    v_mov_b32 v118, 0
    v_mov_b32 v119, 0
    v_mov_b32 v130, 0
    v_mov_b32 v131, 0
    s_cmp_ge_u32 s30, 36
    s_cbranch_scc1 pk_nored3
    s_nop 4
    s_sleep 12
pk_poll4:
    buffer_load_dwordx4 v[56:59], v1, s[8:11], s34 offen sc1
    buffer_load_dwordx4 v[60:63], v1, s[8:11], s34 offen offset:1024 sc1
    s_waitcnt vmcnt(0)
    v_max3_u32 v132, v56, v57, v58
    v_max3_u32 v132, v132, v59, v60
    v_max3_u32 v132, v132, v61, v62
    v_max_u32 v132, v132, v63
    v_cmp_eq_u32 vcc, -1, v132
    s_sub_u32 s22, s22, 1
    s_cbranch_scc1 pk_go5
    s_mov_b64 exec, vcc
    s_cbranch_vccnz pk_poll4
pk_go5:
    s_mov_b64 exec, -1
    s_max_i32 s22, s22, 0
    v_add_f32 v48, v56, v60
    v_add_f32 v49, v57, v61
    v_add_f32 v50, v58, v62
    v_add_f32 v51, v59, v63
    s_nop 0
    v_permlane32_swap_b32 v48, v50
    v_permlane32_swap_b32 v49, v51
    v_add_f32 v48, v48, v50
    v_add_f32 v49, v49, v51
    s_nop 0
    v_add_f32_dpp v50, v48, v48 row_ror:8 row_mask:0xf bank_mask:0xf
    v_add_f32_dpp v51, v49, v49 row_ror:8 row_mask:0xf bank_mask:0xf
    v_mov_b32 v48, v50
    v_mov_b32 v49, v51
    s_nop 0
    v_permlane16_swap_b32 v48, v50
    v_permlane16_swap_b32 v49, v51
    v_add_f32 v48, v48, v50
    v_add_f32 v49, v49, v51
    v_cvt_pk_bf16_f32 v48, v48, v49
    buffer_store_dword v48, v138, s[8:11], s36 offen sc1
    buffer_store_dword v48, v141, s[8:11], s36 offen sc1
pk_nored3:
    s_barrier
    v_lshrrev_b32 v132, 2, v0
    v_xor_b32 v132, v132, v0
    v_and_b32 v132, 4, v132
    v_cmp_eq_u32 vcc, 0, v132
    v_mov_b32 v132, 0x3f803f80
    s_nop 0
    v_cndmask_b32 v8, 0, v132, vcc
    v_cndmask_b32 v9, 0, v132, vcc
    v_cndmask_b32 v10, 0, v132, vcc
    v_cndmask_b32 v11, 0, v132, vcc
    s_waitcnt vmcnt(6)
    v_lshrrev_b32 v136, 3, v0
    v_and_b32 v137, 7, v0
    v_lshlrev_b32 v136, 11, v136
    v_lshl_add_u32 v136, v137, 4, v136
    s_mul_i32 s30, s21, 131072
    s_lshl_b32 s31, s20, 7
    s_add_u32 s30, s30, s31
    s_lshl_b32 s31, s3, 15
    s_add_u32 s30, s30, s31
    s_add_u32 s30, s30, 46137344
    buffer_store_dwordx4 v[184:187], v136, s[8:11], s30 offen sc1
    s_add_u32 s30, s30, 16384
    buffer_store_dwordx4 v[184:187], v136, s[8:11], s30 offen sc1
    v_lshrrev_b32 v136, 3, v0
    v_lshlrev_b32 v136, 17, v136
    v_lshl_add_u32 v136, v137, 4, v136
    s_lshl_b32 s30, s21, 13
    s_lshl_b32 s31, s20, 7
    s_add_u32 s30, s30, s31
    s_add_u32 s30, s30, s25
    s_add_u32 s30, s30, 52428800
    buffer_store_dwordx4 v[184:187], v136, s[8:11], s30 offen sc1
    s_add_u32 m0, s37, 140800
    s_nop 0
    buffer_load_dwordx4 v1, s[16:19], m0 offen lds
    s_add_u32 m0, s37, 144896
    s_nop 0
    buffer_load_dwordx4 v1, s[16:19], m0 offen lds
    s_add_u32 m0, s37, 148992
    s_nop 0
    buffer_load_dwordx4 v1, s[16:19], m0 offen lds
    s_add_u32 m0, s37, 153088
    s_nop 0
    buffer_load_dwordx4 v1, s[16:19], m0 offen lds
    s_add_u32 m0, s37, 157184
    s_min_u32 m0, m0, 158208
    s_nop 0
    buffer_load_dwordx4 v1, s[16:19], m0 offen lds
    s_add_u32 s101, s90, 2654208
    buffer_load_dwordx4 v[224:227], v1, s[8:11], s101 offen offset:0
    s_add_u32 s101, s90, 2655232
    buffer_load_dwordx4 v[228:231], v1, s[8:11], s101 offen offset:0
    s_add_u32 s101, s90, 2656256
    buffer_load_dwordx4 v[232:235], v1, s[8:11], s101 offen offset:0
    s_add_u32 s101, s90, 2657280
    buffer_load_dwordx4 v[236:239], v1, s[8:11], s101 offen offset:0
    v_mfma_f32_16x16x32_bf16 v[48:51], v[8:11], a[160:163], 0
    v_mfma_f32_16x16x32_bf16 v[52:55], v[8:11], a[164:167], 0
    v_mfma_f32_16x16x32_bf16 v[48:51], v[8:11], a[168:171], v[48:51]
    v_mfma_f32_16x16x32_bf16 v[52:55], v[8:11], a[172:175], v[52:55]
    v_mfma_f32_16x16x32_bf16 v[48:51], v[8:11], a[176:179], v[48:51]
    v_mfma_f32_16x16x32_bf16 v[52:55], v[8:11], a[180:183], v[52:55]
    v_mfma_f32_16x16x32_bf16 v[48:51], v[8:11], a[184:187], v[48:51]
    v_mfma_f32_16x16x32_bf16 v[52:55], v[8:11], a[188:191], v[52:55]
    v_mfma_f32_16x16x32_bf16 v[48:51], v[8:11], a[192:195], v[48:51]
    v_mfma_f32_16x16x32_bf16 v[52:55], v[8:11], a[196:199], v[52:55]
    v_mfma_f32_16x16x32_bf16 v[48:51], v[8:11], a[200:203], v[48:51]
    v_mfma_f32_16x16x32_bf16 v[52:55], v[8:11], a[204:207], v[52:55]
    v_mfma_f32_16x16x32_bf16 v[48:51], v[8:11], a[208:211], v[48:51]
    v_mfma_f32_16x16x32_bf16 v[52:55], v[8:11], a[212:215], v[52:55]
    v_mfma_f32_16x16x32_bf16 v[48:51], v[8:11], a[216:219], v[48:51]
    v_mfma_f32_16x16x32_bf16 v[52:55], v[8:11], a[220:223], v[52:55]
    v_mfma_f32_16x16x32_bf16 v[48:51], v[8:11], a[224:227], v[48:51]
    v_mfma_f32_16x16x32_bf16 v[52:55], v[8:11], a[228:231], v[52:55]
    v_mfma_f32_16x16x32_bf16 v[48:51], v[8:11], a[232:235], v[48:51]
    v_mfma_f32_16x16x32_bf16 v[52:55], v[8:11], a[236:239], v[52:55]
    s_nop 7
    v_add_f32 v16, v48, v52
    s_nop 4
    s_sleep 10
pk_poll6:
    buffer_load_dwordx4 v[108:111], v139, s[8:11], s35 offen sc1
    s_waitcnt vmcnt(0)
    v_max3_u32 v132, v108, v109, v110
    v_max_u32 v132, v132, v111
    v_cmp_eq_u32 vcc, -1, v132
    s_sub_u32 s22, s22, 1
    s_cbranch_scc1 pk_go7
    s_mov_b64 exec, vcc
    s_cbranch_vccnz pk_poll6
pk_go7:
    s_mov_b64 exec, -1
    s_max_i32 s22, s22, 0
    ds_write_b128 v140, v[108:111]
    v_bfe_u32 v132, v0, 4, 1
    v_mul_u32_u24 v132, 20480, v132
    v_and_b32 v133, 15, v0
    v_lshl_add_u32 v132, v133, 4, v132
    v_lshrrev_b32 v133, 5, v0
    v_lshl_add_u32 v138, v133, 8, v132
    v_lshl_add_u32 v139, v133, 3, v132
    s_waitcnt lgkmcnt(0)
    s_barrier
    ds_read_b64 v[112:113], v45 offset:0
    ds_read_b64 v[114:115], v45 offset:64
    ds_read_b64 v[116:117], v45 offset:128
    ds_read_b64 v[124:125], v45 offset:1152
    ds_read_b64 v[126:127], v45 offset:1216
    ds_read_b64 v[128:129], v45 offset:1280
    s_lshl_b32 s30, s20, 2
    s_add_u32 s30, s30, s3
    s_mul_i32 s31, s30, 40960
    s_mul_i32 s32, s21, 1280
    s_add_u32 s31, s31, s32
    s_add_u32 s31, s31, 17825792
    s_lshl_b32 s30, s30, 11
    s_lshl_b32 s32, s21, 7
    s_add_u32 s30, s30, s32
    s_add_u32 s30, s30, 29491200
    s_waitcnt lgkmcnt(4)
    v_mfma_f32_32x32x16_bf16 v[48:63], v[112:115], v[80:83], 0
    s_waitcnt lgkmcnt(1)
    v_mfma_f32_32x32x16_bf16 v[64:79], v[124:127], v[92:95], 0
    v_mfma_f32_32x32x16_bf16 v[48:63], v[116:119], v[84:87], v[48:63]
    s_waitcnt lgkmcnt(0)
    v_mfma_f32_32x32x16_bf16 v[64:79], v[128:131], v[96:99], v[64:79]
    s_nop 7
    s_nop 1
    v_add_f32 v58, s24, v58
    v_rcp_f32 v58, v58
    s_nop 0
    v_mov_b32 v59, v58
    v_pk_mul_f32 v[48:49], v[48:49], v[58:59]
    v_pk_mul_f32 v[50:51], v[50:51], v[58:59]
    v_pk_mul_f32 v[52:53], v[52:53], v[58:59]
    v_pk_mul_f32 v[54:55], v[54:55], v[58:59]
    v_pk_mul_f32 v[56:57], v[56:57], v[58:59]
    v_cvt_pk_bf16_f32 v140, v48, v49
    v_cvt_pk_bf16_f32 v141, v50, v51
    v_cvt_pk_bf16_f32 v142, v52, v53
    v_cvt_pk_bf16_f32 v143, v54, v55
    v_cvt_pk_bf16_f32 v148, v56, v57
    v_add_f32 v74, s24, v74
    v_rcp_f32 v74, v74
    s_nop 0
    v_mov_b32 v75, v74
    v_pk_mul_f32 v[64:65], v[64:65], v[74:75]
    v_pk_mul_f32 v[66:67], v[66:67], v[74:75]
    v_pk_mul_f32 v[68:69], v[68:69], v[74:75]
    v_pk_mul_f32 v[70:71], v[70:71], v[74:75]
    v_pk_mul_f32 v[72:73], v[72:73], v[74:75]
    v_cvt_pk_bf16_f32 v144, v64, v65
    v_cvt_pk_bf16_f32 v145, v66, v67
    v_cvt_pk_bf16_f32 v146, v68, v69
    v_cvt_pk_bf16_f32 v147, v70, v71
    v_cvt_pk_bf16_f32 v149, v72, v73
    s_cmp_eq_u32 s23, 0
    s_cbranch_scc1 pk_slow8
    buffer_store_dwordx4 v[140:143], v138, s[8:11], s31 offen
    buffer_store_dwordx4 v[144:147], v138, s[8:11], s31 offen offset:512
    buffer_store_dwordx2 v[148:149], v139, s[8:11], s31 offen offset:1024
    s_branch pk_join9
pk_slow8:
    buffer_store_dwordx4 v[140:143], v138, s[8:11], s31 offen sc1
    buffer_store_dwordx4 v[144:147], v138, s[8:11], s31 offen offset:512 sc1
    buffer_store_dwordx2 v[148:149], v139, s[8:11], s31 offen offset:1024 sc1
    s_nop 0
pk_join9:
    v_lshlrev_b32 v168, 16, v20
    v_and_b32 v169, 0xffff0000, v20
    v_lshlrev_b32 v170, 16, v21
    v_and_b32 v171, 0xffff0000, v21
    v_lshlrev_b32 v172, 16, v22
    v_and_b32 v173, 0xffff0000, v22
    v_lshlrev_b32 v174, 16, v23
    v_and_b32 v175, 0xffff0000, v23
    v_lshlrev_b32 v176, 16, v24
    v_and_b32 v177, 0xffff0000, v24
    v_lshlrev_b32 v178, 16, v25
    v_and_b32 v179, 0xffff0000, v25
    v_lshlrev_b32 v180, 16, v26
    v_and_b32 v181, 0xffff0000, v26
    v_lshlrev_b32 v182, 16, v27
    v_and_b32 v183, 0xffff0000, v27
    v_lshlrev_b32 v184, 16, v28
    v_and_b32 v185, 0xffff0000, v28
    v_lshlrev_b32 v186, 16, v29
    v_and_b32 v187, 0xffff0000, v29
    v_and_b32 v6, 15, v0
    v_lshlrev_b32 v6, 7, v6
    s_lshr_b32 s32, s27, 1
    s_lshl_b32 s32, s32, 11
    s_add_u32 s32, s32, 29491200
    s_mul_i32 s33, s27, 20480
    s_add_u32 s33, s33, 17825792
    s_waitcnt vmcnt(0)
    s_mov_b64 exec, 1
    s_cmp_eq_u32 s23, 0
    s_cbranch_scc1 pk_slow11
    buffer_store_dword v1, off, s[8:11], s30
    s_branch pk_join12
pk_slow11:
    buffer_store_dword v1, off, s[8:11], s30 sc1
    s_nop 0
pk_join12:
    s_mov_b64 exec, -1
    s_add_u32 s101, s90, 2658304
    buffer_load_dwordx4 v[240:243], v1, s[8:11], s101 offen offset:0
    s_add_u32 s101, s90, 2659328
    buffer_load_dwordx4 v[244:247], v1, s[8:11], s101 offen offset:0
    ds_read_b128 v[128:131], v1 offset:56832
    ds_read_b128 v[132:135], v1 offset:57856
    ds_read_b128 v[136:139], v1 offset:58880
    ds_read_b128 v[140:143], v1 offset:59904
    ds_read_b128 v[144:147], v1 offset:60928
    ds_read_b128 v[148:151], v1 offset:61952
    ds_read_b128 v[152:155], v1 offset:62976
    ds_read_b128 v[156:159], v1 offset:64000
    ds_read_b128 v[160:163], v1 offset:65024
    s_nop 4
pk_poll13:
    buffer_load_dword v189, v6, s[8:11], s32 offen sc1
    s_waitcnt vmcnt(0)
    v_cmp_ne_u32 vcc, 0, v189
    s_sub_u32 s22, s22, 1
    s_cbranch_scc1 pk_go14
    s_mov_b64 exec, vcc
    s_cbranch_vccnz pk_poll13
pk_go14:
    s_mov_b64 exec, -1
    s_max_i32 s22, s22, 0
    buffer_load_dwordx4 v[48:51], v1, s[8:11], s33 offen offset:0 sc1
    buffer_load_dwordx4 v[52:55], v1, s[8:11], s33 offen offset:1024 sc1
    buffer_load_dwordx4 v[56:59], v1, s[8:11], s33 offen offset:2048 sc1
    buffer_load_dwordx4 v[60:63], v1, s[8:11], s33 offen offset:3072 sc1
    s_add_u32 s33, s33, 4096
    buffer_load_dwordx4 v[64:67], v1, s[8:11], s33 offen offset:0 sc1
    buffer_load_dwordx4 v[68:71], v1, s[8:11], s33 offen offset:1024 sc1
    buffer_load_dwordx4 v[72:75], v1, s[8:11], s33 offen offset:2048 sc1
    buffer_load_dwordx4 v[76:79], v1, s[8:11], s33 offen offset:3072 sc1
    s_add_u32 s33, s33, 4096
    buffer_load_dwordx4 v[80:83], v1, s[8:11], s33 offen offset:0 sc1
    buffer_load_dwordx4 v[84:87], v1, s[8:11], s33 offen offset:1024 sc1
    buffer_load_dwordx4 v[88:91], v1, s[8:11], s33 offen offset:2048 sc1
    buffer_load_dwordx4 v[92:95], v1, s[8:11], s33 offen offset:3072 sc1
    s_add_u32 s33, s33, 4096
    buffer_load_dwordx4 v[96:99], v1, s[8:11], s33 offen offset:0 sc1
    buffer_load_dwordx4 v[100:103], v1, s[8:11], s33 offen offset:1024 sc1
    buffer_load_dwordx4 v[104:107], v1, s[8:11], s33 offen offset:2048 sc1
    buffer_load_dwordx4 v[108:111], v1, s[8:11], s33 offen offset:3072 sc1
    s_add_u32 s33, s33, 4096
    buffer_load_dwordx4 v[112:115], v1, s[8:11], s33 offen offset:0 sc1
    buffer_load_dwordx4 v[116:119], v1, s[8:11], s33 offen offset:1024 sc1
    buffer_load_dwordx4 v[120:123], v1, s[8:11], s33 offen offset:2048 sc1
    buffer_load_dwordx4 v[124:127], v1, s[8:11], s33 offen offset:3072 sc1
    s_mul_i32 s30, s20, 163840
    s_add_u32 s30, s30, 7340032
    s_add_u32 s12, s4, s30
    s_addc_u32 s13, s5, 0
    s_and_b32 s13, s13, 0xffff
    s_bfe_u32 s30, s27, 0x20001
    s_mul_i32 s30, s30, 40960
    s_mul_i32 s31, s28, 5120
    s_add_u32 s30, s30, s31
    s_lshl_b32 s31, s27, 10
    s_lshl_b32 s32, s28, 7
    s_add_u32 s31, s31, s32
    s_add_u32 s31, s31, 29360128
    v_lshlrev_b32 v6, 3, v0
    s_waitcnt vmcnt(19)
    ds_read_b128 v[164:167], v30 offset:512
    s_waitcnt lgkmcnt(9)
    v_mfma_f32_16x16x32_bf16 v[168:171], v[128:131], v[48:51], v[168:171]
    ds_read_b128 v[128:131], v30 offset:1536
    s_waitcnt lgkmcnt(9)
    v_mfma_f32_16x16x32_bf16 v[172:175], v[132:135], v[48:51], v[172:175]
    ds_read_b128 v[132:135], v30 offset:2560
    s_waitcnt lgkmcnt(9)
    v_mfma_f32_16x16x32_bf16 v[176:179], v[136:139], v[48:51], v[176:179]
    ds_read_b128 v[136:139], v30 offset:3584
    s_waitcnt lgkmcnt(9)
    v_mfma_f32_16x16x32_bf16 v[180:183], v[140:143], v[48:51], v[180:183]
    ds_read_b128 v[140:143], v30 offset:4608
    s_waitcnt lgkmcnt(9)
    v_mfma_f32_16x16x32_bf16 v[184:187], v[144:147], v[48:51], v[184:187]
    s_waitcnt vmcnt(18)
    ds_read_b128 v[144:147], v30 offset:5632
    s_waitcnt lgkmcnt(9)
    v_mfma_f32_16x16x32_bf16 v[168:171], v[148:151], v[52:55], v[168:171]
    ds_read_b128 v[148:151], v30 offset:6656
    s_waitcnt lgkmcnt(9)
    v_mfma_f32_16x16x32_bf16 v[172:175], v[152:155], v[52:55], v[172:175]
    ds_read_b128 v[152:155], v30 offset:7680
    s_waitcnt lgkmcnt(9)
    v_mfma_f32_16x16x32_bf16 v[176:179], v[156:159], v[52:55], v[176:179]
    ds_read_b128 v[156:159], v30 offset:8704
    s_waitcnt lgkmcnt(9)
    v_mfma_f32_16x16x32_bf16 v[180:183], v[160:163], v[52:55], v[180:183]
    ds_read_b128 v[160:163], v30 offset:9728
    s_waitcnt lgkmcnt(9)
    v_mfma_f32_16x16x32_bf16 v[184:187], v[164:167], v[52:55], v[184:187]
    s_waitcnt vmcnt(17)
    s_add_u32 s101, s90, 2660352
    buffer_load_dwordx4 v[248:251], v1, s[8:11], s101 offen offset:0
    ds_read_b128 v[164:167], v30 offset:10752
    s_waitcnt lgkmcnt(9)
    v_mfma_f32_16x16x32_bf16 v[168:171], v[128:131], v[56:59], v[168:171]
    ds_read_b128 v[128:131], v30 offset:11776
    s_waitcnt lgkmcnt(9)
    v_mfma_f32_16x16x32_bf16 v[172:175], v[132:135], v[56:59], v[172:175]
    ds_read_b128 v[132:135], v30 offset:12800
    s_waitcnt lgkmcnt(9)
    v_mfma_f32_16x16x32_bf16 v[176:179], v[136:139], v[56:59], v[176:179]
    ds_read_b128 v[136:139], v30 offset:13824
    s_waitcnt lgkmcnt(9)
    v_mfma_f32_16x16x32_bf16 v[180:183], v[140:143], v[56:59], v[180:183]
    ds_read_b128 v[140:143], v30 offset:14848
    s_waitcnt lgkmcnt(9)
    v_mfma_f32_16x16x32_bf16 v[184:187], v[144:147], v[56:59], v[184:187]
    s_waitcnt vmcnt(17)
    s_add_u32 s101, s90, 2661376
    buffer_load_dwordx4 v[252:255], v1, s[8:11], s101 offen offset:0
    ds_read_b128 v[144:147], v30 offset:15872
    s_waitcnt lgkmcnt(9)
    v_mfma_f32_16x16x32_bf16 v[168:171], v[148:151], v[60:63], v[168:171]
    ds_read_b128 v[148:151], v30 offset:16896
    s_waitcnt lgkmcnt(9)
    v_mfma_f32_16x16x32_bf16 v[172:175], v[152:155], v[60:63], v[172:175]
    ds_read_b128 v[152:155], v30 offset:17920
    s_waitcnt lgkmcnt(9)
    v_mfma_f32_16x16x32_bf16 v[176:179], v[156:159], v[60:63], v[176:179]
    ds_read_b128 v[156:159], v30 offset:18944
    s_waitcnt lgkmcnt(9)
    v_mfma_f32_16x16x32_bf16 v[180:183], v[160:163], v[60:63], v[180:183]
    ds_read_b128 v[160:163], v30 offset:19968
    s_waitcnt lgkmcnt(9)
    v_mfma_f32_16x16x32_bf16 v[184:187], v[164:167], v[60:63], v[184:187]
    s_waitcnt vmcnt(17)
    s_add_u32 s101, s90, 2646016
    buffer_load_dwordx4 v[192:195], v1, s[8:11], s101 offen offset:0
    ds_read_b128 v[164:167], v30 offset:20992
    s_waitcnt lgkmcnt(9)
    v_mfma_f32_16x16x32_bf16 v[168:171], v[128:131], v[64:67], v[168:171]
    ds_read_b128 v[128:131], v30 offset:22016
    s_waitcnt lgkmcnt(9)
    v_mfma_f32_16x16x32_bf16 v[172:175], v[132:135], v[64:67], v[172:175]
    ds_read_b128 v[132:135], v30 offset:23040
    s_waitcnt lgkmcnt(9)
    v_mfma_f32_16x16x32_bf16 v[176:179], v[136:139], v[64:67], v[176:179]
    ds_read_b128 v[136:139], v30 offset:24064
    s_waitcnt lgkmcnt(9)
    v_mfma_f32_16x16x32_bf16 v[180:183], v[140:143], v[64:67], v[180:183]
    ds_read_b128 v[140:143], v30 offset:25088
    s_waitcnt lgkmcnt(9)
    v_mfma_f32_16x16x32_bf16 v[184:187], v[144:147], v[64:67], v[184:187]
    s_waitcnt vmcnt(17)
    s_add_u32 s101, s90, 2647040
    buffer_load_dwordx4 v[196:199], v1, s[8:11], s101 offen offset:0
    ds_read_b128 v[144:147], v30 offset:26112
    s_waitcnt lgkmcnt(9)
    v_mfma_f32_16x16x32_bf16 v[168:171], v[148:151], v[68:71], v[168:171]
    ds_read_b128 v[148:151], v30 offset:27136
    s_waitcnt lgkmcnt(9)
    v_mfma_f32_16x16x32_bf16 v[172:175], v[152:155], v[68:71], v[172:175]
    ds_read_b128 v[152:155], v30 offset:28160
    s_waitcnt lgkmcnt(9)
    v_mfma_f32_16x16x32_bf16 v[176:179], v[156:159], v[68:71], v[176:179]
    ds_read_b128 v[156:159], v30 offset:29184
    s_waitcnt lgkmcnt(9)
    v_mfma_f32_16x16x32_bf16 v[180:183], v[160:163], v[68:71], v[180:183]
    ds_read_b128 v[160:163], v30 offset:30208
    s_waitcnt lgkmcnt(9)
    v_mfma_f32_16x16x32_bf16 v[184:187], v[164:167], v[68:71], v[184:187]
    s_waitcnt vmcnt(17)
    s_add_u32 s101, s90, 2648064
    buffer_load_dwordx4 v[200:203], v1, s[8:11], s101 offen offset:0
    ds_read_b128 v[164:167], v30 offset:31232
    s_waitcnt lgkmcnt(9)
    v_mfma_f32_16x16x32_bf16 v[168:171], v[128:131], v[72:75], v[168:171]
    ds_read_b128 v[128:131], v30 offset:32256
    s_waitcnt lgkmcnt(9)
    v_mfma_f32_16x16x32_bf16 v[172:175], v[132:135], v[72:75], v[172:175]
    ds_read_b128 v[132:135], v30 offset:33280
    s_waitcnt lgkmcnt(9)
    v_mfma_f32_16x16x32_bf16 v[176:179], v[136:139], v[72:75], v[176:179]
    ds_read_b128 v[136:139], v30 offset:34304
    s_waitcnt lgkmcnt(9)
    v_mfma_f32_16x16x32_bf16 v[180:183], v[140:143], v[72:75], v[180:183]
    ds_read_b128 v[140:143], v30 offset:35328
    s_waitcnt lgkmcnt(9)
    v_mfma_f32_16x16x32_bf16 v[184:187], v[144:147], v[72:75], v[184:187]
    s_waitcnt vmcnt(17)
    s_add_u32 s101, s90, 2649088
    buffer_load_dwordx4 v[204:207], v1, s[8:11], s101 offen offset:0
    ds_read_b128 v[144:147], v30 offset:36352
    s_waitcnt lgkmcnt(9)
    v_mfma_f32_16x16x32_bf16 v[168:171], v[148:151], v[76:79], v[168:171]
    ds_read_b128 v[148:151], v30 offset:37376
    s_waitcnt lgkmcnt(9)
    v_mfma_f32_16x16x32_bf16 v[172:175], v[152:155], v[76:79], v[172:175]
    ds_read_b128 v[152:155], v30 offset:38400
    s_waitcnt lgkmcnt(9)
    v_mfma_f32_16x16x32_bf16 v[176:179], v[156:159], v[76:79], v[176:179]
    ds_read_b128 v[156:159], v30 offset:39424
    s_waitcnt lgkmcnt(9)
    v_mfma_f32_16x16x32_bf16 v[180:183], v[160:163], v[76:79], v[180:183]
    ds_read_b128 v[160:163], v30 offset:40448
    s_waitcnt lgkmcnt(9)
    v_mfma_f32_16x16x32_bf16 v[184:187], v[164:167], v[76:79], v[184:187]
    s_waitcnt vmcnt(17)
    s_add_u32 s101, s90, 2650112
    buffer_load_dwordx4 v[208:211], v1, s[8:11], s101 offen offset:0
    ds_read_b128 v[164:167], v30 offset:41472
    s_waitcnt lgkmcnt(9)
    v_mfma_f32_16x16x32_bf16 v[168:171], v[128:131], v[80:83], v[168:171]
    ds_read_b128 v[128:131], v30 offset:42496
    s_waitcnt lgkmcnt(9)
    v_mfma_f32_16x16x32_bf16 v[172:175], v[132:135], v[80:83], v[172:175]
    ds_read_b128 v[132:135], v30 offset:43520
    s_waitcnt lgkmcnt(9)
    v_mfma_f32_16x16x32_bf16 v[176:179], v[136:139], v[80:83], v[176:179]
    ds_read_b128 v[136:139], v30 offset:44544
    s_waitcnt lgkmcnt(9)
    v_mfma_f32_16x16x32_bf16 v[180:183], v[140:143], v[80:83], v[180:183]
    ds_read_b128 v[140:143], v30 offset:45568
    s_waitcnt lgkmcnt(9)
    v_mfma_f32_16x16x32_bf16 v[184:187], v[144:147], v[80:83], v[184:187]
    s_waitcnt vmcnt(17)
    s_add_u32 s101, s90, 2651136
    buffer_load_dwordx4 v[212:215], v1, s[8:11], s101 offen offset:0
    ds_read_b128 v[144:147], v30 offset:46592
    s_waitcnt lgkmcnt(9)
    v_mfma_f32_16x16x32_bf16 v[168:171], v[148:151], v[84:87], v[168:171]
    ds_read_b128 v[148:151], v30 offset:47616
    s_waitcnt lgkmcnt(9)
    v_mfma_f32_16x16x32_bf16 v[172:175], v[152:155], v[84:87], v[172:175]
    ds_read_b128 v[152:155], v30 offset:48640
    s_waitcnt lgkmcnt(9)
    v_mfma_f32_16x16x32_bf16 v[176:179], v[156:159], v[84:87], v[176:179]
    ds_read_b128 v[156:159], v30 offset:49664
    s_waitcnt lgkmcnt(9)
    v_mfma_f32_16x16x32_bf16 v[180:183], v[160:163], v[84:87], v[180:183]
    ds_read_b128 v[160:163], v30 offset:50688
    s_waitcnt lgkmcnt(9)
    v_mfma_f32_16x16x32_bf16 v[184:187], v[164:167], v[84:87], v[184:187]
    s_waitcnt vmcnt(17)
    s_add_u32 s101, s90, 2652160
    buffer_load_dwordx4 v[216:219], v1, s[8:11], s101 offen offset:0
    ds_read_b128 v[164:167], v30 offset:51712
    s_waitcnt lgkmcnt(9)
    v_mfma_f32_16x16x32_bf16 v[168:171], v[128:131], v[88:91], v[168:171]
    ds_read_b128 v[128:131], v30 offset:52736
    s_waitcnt lgkmcnt(9)
    v_mfma_f32_16x16x32_bf16 v[172:175], v[132:135], v[88:91], v[172:175]
    ds_read_b128 v[132:135], v30 offset:53760
    s_waitcnt lgkmcnt(9)
    v_mfma_f32_16x16x32_bf16 v[176:179], v[136:139], v[88:91], v[176:179]
    ds_read_b128 v[136:139], v30 offset:54784
    s_waitcnt lgkmcnt(9)
    v_mfma_f32_16x16x32_bf16 v[180:183], v[140:143], v[88:91], v[180:183]
    ds_read_b128 v[140:143], v30 offset:55808
    s_waitcnt lgkmcnt(9)
    v_mfma_f32_16x16x32_bf16 v[184:187], v[144:147], v[88:91], v[184:187]
    s_waitcnt vmcnt(17)
    s_add_u32 s101, s90, 2653184
    buffer_load_dwordx4 v[220:223], v1, s[8:11], s101 offen offset:0
    ds_read_b128 v[144:147], v30 offset:56832
    s_waitcnt lgkmcnt(9)
    v_mfma_f32_16x16x32_bf16 v[168:171], v[148:151], v[92:95], v[168:171]
    ds_read_b128 v[148:151], v30 offset:57856
    s_waitcnt lgkmcnt(9)
    v_mfma_f32_16x16x32_bf16 v[172:175], v[152:155], v[92:95], v[172:175]
    ds_read_b128 v[152:155], v30 offset:58880
    s_waitcnt lgkmcnt(9)
    v_mfma_f32_16x16x32_bf16 v[176:179], v[156:159], v[92:95], v[176:179]
    ds_read_b128 v[156:159], v30 offset:59904
    s_waitcnt lgkmcnt(9)
    v_mfma_f32_16x16x32_bf16 v[180:183], v[160:163], v[92:95], v[180:183]
    ds_read_b128 v[160:163], v30 offset:60928
    s_waitcnt lgkmcnt(9)
    v_mfma_f32_16x16x32_bf16 v[184:187], v[164:167], v[92:95], v[184:187]
    s_waitcnt vmcnt(17)
    ds_read_b128 v[164:167], v30 offset:61952
    s_waitcnt lgkmcnt(9)
    v_mfma_f32_16x16x32_bf16 v[168:171], v[128:131], v[96:99], v[168:171]
    ds_read_b128 v[128:131], v30 offset:62976
    s_waitcnt lgkmcnt(9)
    v_mfma_f32_16x16x32_bf16 v[172:175], v[132:135], v[96:99], v[172:175]
    ds_read_b128 v[132:135], v30 offset:64000
    s_waitcnt lgkmcnt(9)
    v_mfma_f32_16x16x32_bf16 v[176:179], v[136:139], v[96:99], v[176:179]
    ds_read_b128 v[136:139], v30 offset:65024
    s_waitcnt lgkmcnt(9)
    v_mfma_f32_16x16x32_bf16 v[180:183], v[140:143], v[96:99], v[180:183]
    ds_read_b128 v[140:143], v31 offset:512
    s_waitcnt lgkmcnt(9)
    v_mfma_f32_16x16x32_bf16 v[184:187], v[144:147], v[96:99], v[184:187]
    s_waitcnt vmcnt(16)
    ds_read_b128 v[144:147], v31 offset:1536
    s_waitcnt lgkmcnt(9)
    v_mfma_f32_16x16x32_bf16 v[168:171], v[148:151], v[100:103], v[168:171]
    ds_read_b128 v[148:151], v31 offset:2560
    s_waitcnt lgkmcnt(9)
    v_mfma_f32_16x16x32_bf16 v[172:175], v[152:155], v[100:103], v[172:175]
    ds_read_b128 v[152:155], v31 offset:3584
    s_waitcnt lgkmcnt(9)
    v_mfma_f32_16x16x32_bf16 v[176:179], v[156:159], v[100:103], v[176:179]
    ds_read_b128 v[156:159], v31 offset:4608
    s_waitcnt lgkmcnt(9)
    v_mfma_f32_16x16x32_bf16 v[180:183], v[160:163], v[100:103], v[180:183]
    ds_read_b128 v[160:163], v31 offset:5632
    s_waitcnt lgkmcnt(9)
    v_mfma_f32_16x16x32_bf16 v[184:187], v[164:167], v[100:103], v[184:187]
    s_waitcnt vmcnt(15)
    ds_read_b128 v[164:167], v31 offset:6656
    s_waitcnt lgkmcnt(9)
    v_mfma_f32_16x16x32_bf16 v[168:171], v[128:131], v[104:107], v[168:171]
    ds_read_b128 v[128:131], v31 offset:7680
    s_waitcnt lgkmcnt(9)
    v_mfma_f32_16x16x32_bf16 v[172:175], v[132:135], v[104:107], v[172:175]
    ds_read_b128 v[132:135], v31 offset:8704
    s_waitcnt lgkmcnt(9)
    v_mfma_f32_16x16x32_bf16 v[176:179], v[136:139], v[104:107], v[176:179]
    ds_read_b128 v[136:139], v31 offset:9728
    s_waitcnt lgkmcnt(9)
    v_mfma_f32_16x16x32_bf16 v[180:183], v[140:143], v[104:107], v[180:183]
    ds_read_b128 v[140:143], v31 offset:10752
    s_waitcnt lgkmcnt(9)
    v_mfma_f32_16x16x32_bf16 v[184:187], v[144:147], v[104:107], v[184:187]
    s_waitcnt vmcnt(14)
    ds_read_b128 v[144:147], v31 offset:11776
    s_waitcnt lgkmcnt(9)
    v_mfma_f32_16x16x32_bf16 v[168:171], v[148:151], v[108:111], v[168:171]
    ds_read_b128 v[148:151], v31 offset:12800
    s_waitcnt lgkmcnt(9)
    v_mfma_f32_16x16x32_bf16 v[172:175], v[152:155], v[108:111], v[172:175]
    ds_read_b128 v[152:155], v31 offset:13824
    s_waitcnt lgkmcnt(9)
    v_mfma_f32_16x16x32_bf16 v[176:179], v[156:159], v[108:111], v[176:179]
    ds_read_b128 v[156:159], v31 offset:14848
    s_waitcnt lgkmcnt(9)
    v_mfma_f32_16x16x32_bf16 v[180:183], v[160:163], v[108:111], v[180:183]
    ds_read_b128 v[160:163], v31 offset:15872
    s_waitcnt lgkmcnt(9)
    v_mfma_f32_16x16x32_bf16 v[184:187], v[164:167], v[108:111], v[184:187]
    s_waitcnt vmcnt(13)
    ds_read_b128 v[164:167], v31 offset:16896
    s_waitcnt lgkmcnt(9)
    v_mfma_f32_16x16x32_bf16 v[168:171], v[128:131], v[112:115], v[168:171]
    ds_read_b128 v[128:131], v31 offset:17920
    s_waitcnt lgkmcnt(9)
    v_mfma_f32_16x16x32_bf16 v[172:175], v[132:135], v[112:115], v[172:175]
    ds_read_b128 v[132:135], v31 offset:18944
    s_waitcnt lgkmcnt(9)
    v_mfma_f32_16x16x32_bf16 v[176:179], v[136:139], v[112:115], v[176:179]
    ds_read_b128 v[136:139], v31 offset:19968
    s_waitcnt lgkmcnt(9)
    v_mfma_f32_16x16x32_bf16 v[180:183], v[140:143], v[112:115], v[180:183]
    ds_read_b128 v[140:143], v31 offset:20992
    s_waitcnt lgkmcnt(9)
    v_mfma_f32_16x16x32_bf16 v[184:187], v[144:147], v[112:115], v[184:187]
    s_waitcnt vmcnt(12)
    ds_read_b128 v[144:147], v31 offset:22016
    s_waitcnt lgkmcnt(9)
    v_mfma_f32_16x16x32_bf16 v[168:171], v[148:151], v[116:119], v[168:171]
    ds_read_b128 v[148:151], v31 offset:23040
    s_waitcnt lgkmcnt(9)
    v_mfma_f32_16x16x32_bf16 v[172:175], v[152:155], v[116:119], v[172:175]
    ds_read_b128 v[152:155], v31 offset:24064
    s_waitcnt lgkmcnt(9)
    v_mfma_f32_16x16x32_bf16 v[176:179], v[156:159], v[116:119], v[176:179]
    ds_read_b128 v[156:159], v31 offset:25088
    s_waitcnt lgkmcnt(9)
    v_mfma_f32_16x16x32_bf16 v[180:183], v[160:163], v[116:119], v[180:183]
    ds_read_b128 v[160:163], v31 offset:26112
    s_waitcnt lgkmcnt(9)
    v_mfma_f32_16x16x32_bf16 v[184:187], v[164:167], v[116:119], v[184:187]
    s_waitcnt vmcnt(11)
    ds_read_b128 v[164:167], v31 offset:27136
    s_waitcnt lgkmcnt(9)
    v_mfma_f32_16x16x32_bf16 v[168:171], v[128:131], v[120:123], v[168:171]
    s_waitcnt lgkmcnt(8)
    v_mfma_f32_16x16x32_bf16 v[172:175], v[132:135], v[120:123], v[172:175]
    s_waitcnt lgkmcnt(7)
    v_mfma_f32_16x16x32_bf16 v[176:179], v[136:139], v[120:123], v[176:179]
    s_waitcnt lgkmcnt(6)
    v_mfma_f32_16x16x32_bf16 v[180:183], v[140:143], v[120:123], v[180:183]
    s_waitcnt lgkmcnt(5)
    v_mfma_f32_16x16x32_bf16 v[184:187], v[144:147], v[120:123], v[184:187]
    s_waitcnt vmcnt(10)
    s_waitcnt lgkmcnt(4)
    v_mfma_f32_16x16x32_bf16 v[168:171], v[148:151], v[124:127], v[168:171]
    s_waitcnt lgkmcnt(3)
    v_mfma_f32_16x16x32_bf16 v[172:175], v[152:155], v[124:127], v[172:175]
    s_waitcnt lgkmcnt(2)
    v_mfma_f32_16x16x32_bf16 v[176:179], v[156:159], v[124:127], v[176:179]
    s_waitcnt lgkmcnt(1)
    v_mfma_f32_16x16x32_bf16 v[180:183], v[160:163], v[124:127], v[180:183]
    s_waitcnt lgkmcnt(0)
    v_mfma_f32_16x16x32_bf16 v[184:187], v[164:167], v[124:127], v[184:187]
    v_cvt_pk_bf16_f32 v20, v168, v169
    v_cvt_pk_bf16_f32 v21, v170, v171
    v_cvt_pk_bf16_f32 v22, v172, v173
    v_cvt_pk_bf16_f32 v23, v174, v175
    v_cvt_pk_bf16_f32 v24, v176, v177
    v_cvt_pk_bf16_f32 v25, v178, v179
    v_cvt_pk_bf16_f32 v26, v180, v181
    v_cvt_pk_bf16_f32 v27, v182, v183
    v_cvt_pk_bf16_f32 v28, v184, v185
    v_cvt_pk_bf16_f32 v29, v186, v187
    s_cmp_eq_u32 s23, 0
    s_cbranch_scc1 pk_slow15
    buffer_store_dwordx4 v[20:23], v43, s[12:15], s30 offen
    buffer_store_dwordx4 v[24:27], v43, s[12:15], s30 offen offset:2048
    buffer_store_dwordx2 v[28:29], v44, s[12:15], s30 offen
    s_branch pk_join16
pk_slow15:
    buffer_store_dwordx4 v[20:23], v43, s[12:15], s30 offen sc1
    buffer_store_dwordx4 v[24:27], v43, s[12:15], s30 offen offset:2048 sc1
    buffer_store_dwordx2 v[28:29], v44, s[12:15], s30 offen sc1
    s_nop 0
pk_join16:
    v_lshlrev_b32 v48, 16, v20
    v_and_b32 v49, 0xffff0000, v20
    v_lshlrev_b32 v50, 16, v21
    v_and_b32 v51, 0xffff0000, v21
    v_lshlrev_b32 v52, 16, v22
    v_and_b32 v53, 0xffff0000, v22
    v_lshlrev_b32 v54, 16, v23
    v_and_b32 v55, 0xffff0000, v23
    v_lshlrev_b32 v56, 16, v24
    v_and_b32 v57, 0xffff0000, v24
    v_lshlrev_b32 v58, 16, v25
    v_and_b32 v59, 0xffff0000, v25
    v_lshlrev_b32 v60, 16, v26
    v_and_b32 v61, 0xffff0000, v26
    v_lshlrev_b32 v62, 16, v27
    v_and_b32 v63, 0xffff0000, v27
    v_lshlrev_b32 v64, 16, v28
    v_and_b32 v65, 0xffff0000, v28
    v_lshlrev_b32 v66, 16, v29
    v_and_b32 v67, 0xffff0000, v29
    v_pk_add_f32 v[68:69], v[48:49], v[50:51]
    v_pk_add_f32 v[70:71], v[52:53], v[54:55]
    v_pk_add_f32 v[68:69], v[68:69], v[56:57]
    v_pk_add_f32 v[70:71], v[70:71], v[58:59]
    v_pk_add_f32 v[68:69], v[68:69], v[60:61]
    v_pk_add_f32 v[70:71], v[70:71], v[62:63]
    v_pk_add_f32 v[68:69], v[68:69], v[64:65]
    v_pk_add_f32 v[70:71], v[70:71], v[66:67]
    v_pk_add_f32 v[68:69], v[68:69], v[70:71]
    v_add_f32 v68, v68, v69
    v_mov_b32 v69, v68
    s_nop 1
    v_permlane16_swap_b32 v68, v69
    v_add_f32 v68, v68, v69
    v_mov_b32 v69, v68
    s_nop 1
    v_permlane32_swap_b32 v68, v69
    v_add_f32 v68, v68, v69
    v_mul_f32 v68, 0x3c4ccccd, v68
    v_mul_f32 v70, -1.0, v68
    v_mul_f32 v71, -1.0, v68
    v_pk_add_f32 v[48:49], v[48:49], v[70:71]
    v_pk_add_f32 v[50:51], v[50:51], v[70:71]
    v_pk_add_f32 v[52:53], v[52:53], v[70:71]
    v_pk_add_f32 v[54:55], v[54:55], v[70:71]
    v_pk_add_f32 v[56:57], v[56:57], v[70:71]
    v_pk_add_f32 v[58:59], v[58:59], v[70:71]
    v_pk_add_f32 v[60:61], v[60:61], v[70:71]
    v_pk_add_f32 v[62:63], v[62:63], v[70:71]
    v_pk_add_f32 v[64:65], v[64:65], v[70:71]
    v_pk_add_f32 v[66:67], v[66:67], v[70:71]
    v_pk_mul_f32 v[70:71], v[48:49], v[48:49]
    v_pk_mul_f32 v[72:73], v[50:51], v[50:51]
    v_pk_fma_f32 v[70:71], v[52:53], v[52:53], v[70:71]
    v_pk_fma_f32 v[72:73], v[54:55], v[54:55], v[72:73]
    v_pk_fma_f32 v[70:71], v[56:57], v[56:57], v[70:71]
    v_pk_fma_f32 v[72:73], v[58:59], v[58:59], v[72:73]
    v_pk_fma_f32 v[70:71], v[60:61], v[60:61], v[70:71]
    v_pk_fma_f32 v[72:73], v[62:63], v[62:63], v[72:73]
    v_pk_fma_f32 v[70:71], v[64:65], v[64:65], v[70:71]
    v_pk_fma_f32 v[72:73], v[66:67], v[66:67], v[72:73]
    v_pk_add_f32 v[70:71], v[70:71], v[72:73]
    v_add_f32 v69, v70, v71
    v_mov_b32 v70, v69
    s_nop 1
    v_permlane16_swap_b32 v69, v70
    v_add_f32 v69, v69, v70
    v_mov_b32 v70, v69
    s_nop 1
    v_permlane32_swap_b32 v69, v70
    v_add_f32 v69, v69, v70
    v_bfi_b32 v68, 15, 13, v68
    v_bfi_b32 v69, 15, 13, v69
    v_mov_b32 v151, 0x3f80
    v_mov_b32 v184, -1
    v_mov_b32 v185, -1
    v_mov_b32 v186, -1
    v_mov_b32 v187, -1
    s_waitcnt vmcnt(0)
    s_mov_b64 exec, 0xffff
    s_cmp_eq_u32 s23, 0
    s_cbranch_scc1 pk_slow17
    buffer_store_dwordx2 v[68:69], v6, s[8:11], s31 offen
    s_branch pk_join18
pk_slow17:
    buffer_store_dwordx2 v[68:69], v6, s[8:11], s31 offen sc1
    s_nop 0
pk_join18:
    s_mov_b64 exec, -1
    s_lshl_b32 s31, s20, 13
    s_add_u32 s31, s31, s25
    s_add_u32 s31, s31, 29360128
    s_nop 4
pk_poll19:
    buffer_load_dwordx2 v[112:113], v42, s[8:11], s31 offen offset:0 sc1
    buffer_load_dwordx2 v[114:115], v42, s[8:11], s31 offen offset:128 sc1
    buffer_load_dwordx2 v[116:117], v42, s[8:11], s31 offen offset:256 sc1
    buffer_load_dwordx2 v[118:119], v42, s[8:11], s31 offen offset:384 sc1
    s_waitcnt vmcnt(0)
    v_or3_b32 v132, v112, v113, v114
    v_or3_b32 v133, v115, v116, v117
    v_or3_b32 v132, v132, v118, v119
    v_or_b32 v132, v132, v133
    v_and_b32 v132, 2, v132
    v_cmp_ne_u32 vcc, 0, v132
    s_sub_u32 s22, s22, 1
    s_cbranch_scc1 pk_go20
    s_mov_b64 exec, vcc
    s_cbranch_vccnz pk_poll19
pk_go20:
    s_mov_b64 exec, -1
    s_max_i32 s22, s22, 0
    s_barrier
    s_add_u32 m0, s37, 0
    s_nop 0
    buffer_load_dwordx4 v1, s[12:15], m0 offen sc1 lds
    s_add_u32 m0, s37, 4096
    s_nop 0
    buffer_load_dwordx4 v1, s[12:15], m0 offen sc1 lds
    s_add_u32 m0, s37, 8192
    s_nop 0
    buffer_load_dwordx4 v1, s[12:15], m0 offen sc1 lds
    s_add_u32 m0, s37, 12288
    s_nop 0
    buffer_load_dwordx4 v1, s[12:15], m0 offen sc1 lds
    s_add_u32 m0, s37, 16384
    s_nop 0
    buffer_load_dwordx4 v1, s[12:15], m0 offen sc1 lds
    s_add_u32 m0, s37, 20480
    s_nop 0
    buffer_load_dwordx4 v1, s[12:15], m0 offen sc1 lds
    s_add_u32 m0, s37, 24576
    s_nop 0
    buffer_load_dwordx4 v1, s[12:15], m0 offen sc1 lds
    s_add_u32 m0, s37, 28672
    s_nop 0
    buffer_load_dwordx4 v1, s[12:15], m0 offen sc1 lds
    v_lshrrev_b32 v132, 2, v0
    v_xor_b32 v132, v132, v0
    v_and_b32 v132, 4, v132
    v_cmp_eq_u32 vcc, 0, v132
    v_mov_b32 v132, 0x3f803f80
    s_nop 0
    v_cndmask_b32 v8, 0, v132, vcc
    v_cndmask_b32 v9, 0, v132, vcc
    v_cndmask_b32 v10, 0, v132, vcc
    v_cndmask_b32 v11, 0, v132, vcc
    s_nop 1
    v_mfma_f32_16x16x32_bf16 v[48:51], v[8:11], a[240:243], 0
    v_mfma_f32_16x16x32_bf16 v[52:55], v[8:11], a[244:247], 0
    v_mfma_f32_16x16x32_bf16 v[48:51], v[8:11], a[248:251], v[48:51]
    v_mfma_f32_16x16x32_bf16 v[52:55], v[8:11], a[252:255], v[52:55]
    v_mfma_f32_16x16x32_bf16 v[48:51], v[8:11], v[192:195], v[48:51]
    v_mfma_f32_16x16x32_bf16 v[52:55], v[8:11], v[196:199], v[52:55]
    v_mfma_f32_16x16x32_bf16 v[48:51], v[8:11], v[200:203], v[48:51]
    v_mfma_f32_16x16x32_bf16 v[52:55], v[8:11], v[204:207], v[52:55]
    v_mfma_f32_16x16x32_bf16 v[48:51], v[8:11], v[208:211], v[48:51]
    v_mfma_f32_16x16x32_bf16 v[52:55], v[8:11], v[212:215], v[52:55]
    v_mfma_f32_16x16x32_bf16 v[48:51], v[8:11], v[216:219], v[48:51]
    v_mfma_f32_16x16x32_bf16 v[52:55], v[8:11], v[220:223], v[52:55]
    v_mfma_f32_16x16x32_bf16 v[48:51], v[8:11], v[224:227], v[48:51]
    v_mfma_f32_16x16x32_bf16 v[52:55], v[8:11], v[228:231], v[52:55]
    v_mfma_f32_16x16x32_bf16 v[48:51], v[8:11], v[232:235], v[48:51]
    v_mfma_f32_16x16x32_bf16 v[52:55], v[8:11], v[236:239], v[52:55]
    v_mfma_f32_16x16x32_bf16 v[48:51], v[8:11], v[240:243], v[48:51]
    v_mfma_f32_16x16x32_bf16 v[52:55], v[8:11], v[244:247], v[52:55]
    v_mfma_f32_16x16x32_bf16 v[48:51], v[8:11], v[248:251], v[48:51]
    v_mfma_f32_16x16x32_bf16 v[52:55], v[8:11], v[252:255], v[52:55]
    s_nop 7
    v_add_f32 v48, v48, v52
    v_add_f32 v48, v48, v16
    v_cvt_pk_bf16_f32 v16, v48, v48
    v_lshlrev_b32 v17, 16, v16
    v_sub_f32 v48, v48, v17
    v_cvt_pk_bf16_f32 v17, v48, v48
    v_and_b32 v17, 0xffff0000, v17
    v_sub_f32 v48, v48, v17
    v_and_b32 v16, 0xffff, v16
    v_or_b32 v16, v16, v17
    v_mov_b32 v18, 0
    v_cvt_pk_bf16_f32 v17, v48, v18
    v_mov_b32 v19, 0
    v_cmp_gt_u32 vcc, 32, v0
    s_nop 1
    v_cndmask_b32 v16, v17, v16, vcc
    v_mov_b32 v17, 0
    s_waitcnt vmcnt(6)
    s_barrier
    ds_read_b128 v[80:83], v1 offset:0
    ds_read_b128 v[84:87], v1 offset:1024
    ds_read_b128 v[88:91], v1 offset:2048
    ds_read_b128 v[92:95], v1 offset:3072
    ds_read_b128 v[96:99], v1 offset:4096
    ds_read_b128 v[100:103], v1 offset:5120
    ds_read_b128 v[104:107], v1 offset:6144
    s_waitcnt lgkmcnt(5)
    v_mfma_f32_32x32x16_bf16 v[48:63], a[160:163], v[80:83], 0
    ds_read_b128 v[108:111], v1 offset:7168
    v_add_f32 v132, v112, v114
    v_add_f32 v133, v116, v118
    v_add_f32 v132, v132, v133
    v_mov_b32 v133, v132
    v_add_f32 v134, v113, v115
    v_mfma_f32_32x32x16_bf16 v[48:63], a[164:167], v[84:87], v[48:63]
    s_waitcnt vmcnt(4)
    s_barrier
    ds_read_b128 v[80:83], v1 offset:8192
    v_add_f32 v135, v117, v119
    s_waitcnt lgkmcnt(4)
    v_mfma_f32_32x32x16_bf16 v[48:63], a[168:171], v[88:91], v[48:63]
    s_add_u32 m0, s37, 32768
    ds_read_b128 v[84:87], v1 offset:9216
    buffer_load_dwordx4 v1, s[12:15], m0 offen sc1 lds
    v_permlane32_swap_b32 v132, v133
    v_add_f32 v134, v134, v135
    v_add_f32 v132, v132, v133
    v_mfma_f32_32x32x16_bf16 v[48:63], a[172:175], v[92:95], v[48:63]
    ds_read_b128 v[88:91], v1 offset:10240
    v_mul_f32 v132, 0.125, v132
    v_sub_f32 v112, v112, v132
    v_sub_f32 v114, v114, v132
    v_sub_f32 v116, v116, v132
    v_sub_f32 v118, v118, v132
    v_mfma_f32_32x32x16_bf16 v[48:63], a[176:179], v[96:99], v[48:63]
    ds_read_b128 v[92:95], v1 offset:11264
    v_mul_f32 v133, v112, v112
    v_fmac_f32 v133, v114, v114
    v_fmac_f32 v133, v116, v116
    v_fmac_f32 v133, v118, v118
    s_waitcnt lgkmcnt(4)
    v_mfma_f32_32x32x16_bf16 v[48:63], a[180:183], v[100:103], v[48:63]
    s_add_u32 m0, s37, 36864
    ds_read_b128 v[96:99], v1 offset:12288
    buffer_load_dwordx4 v1, s[12:15], m0 offen sc1 lds
    v_fmac_f32 v134, 0x42a00000, v133
    v_mov_b32 v135, v134
    v_cvt_pk_bf16_f32 v136, -v132, -v132
    v_mfma_f32_32x32x16_bf16 v[48:63], a[184:187], v[104:107], v[48:63]
    ds_read_b128 v[100:103], v1 offset:13312
    s_lshl_b32 s30, s3, 8
    v_permlane32_swap_b32 v134, v135
    v_add_u32 v132, s30, v41
    v_add_f32 v134, v134, v135
    v_mul_f32 v134, 0x3acccccd, v134
    v_mfma_f32_32x32x16_bf16 v[48:63], a[188:191], v[108:111], v[48:63]
    ds_read_b128 v[104:107], v1 offset:14336
    v_cvt_pk_bf16_f32 v134, v134, v134
    v_lshlrev_b32 v134, 16, v134
    v_add_f32 v134, 0x3727c5ac, v134
    v_cvt_pk_bf16_f32 v134, v134, v134
    s_waitcnt lgkmcnt(4)
    v_mfma_f32_32x32x16_bf16 v[48:63], a[192:195], v[80:83], v[48:63]
    s_add_u32 m0, s37, 40960
    ds_read_b128 v[108:111], v1 offset:15360
    buffer_load_dwordx4 v1, s[12:15], m0 offen sc1 lds
    v_lshlrev_b32 v134, 16, v134
    v_sqrt_f32 v134, v134
    v_mfma_f32_32x32x16_bf16 v[48:63], a[196:199], v[84:87], v[48:63]
    s_waitcnt vmcnt(5)
    s_barrier
    ds_read_b128 v[80:83], v1 offset:16384
    v_cvt_pk_bf16_f32 v134, v134, v134
    v_lshlrev_b32 v134, 16, v134
    v_mfma_f32_32x32x16_bf16 v[48:63], a[200:203], v[88:91], v[48:63]
    ds_read_b128 v[84:87], v1 offset:17408
    v_rcp_f32 v137, v134
    s_nop 0
    v_and_b32 v137, 0xffffff7f, v137
    s_waitcnt lgkmcnt(4)
    v_mfma_f32_32x32x16_bf16 v[48:63], a[204:207], v[92:95], v[48:63]
    s_add_u32 m0, s37, 45056
    ds_read_b128 v[88:91], v1 offset:18432
    buffer_load_dwordx4 v1, s[12:15], m0 offen sc1 lds
    v_lshrrev_b32 v133, 5, v0
    s_and_b32 s30, s3, 1
    v_sub_u32 v133, s30, v133
    v_mfma_f32_32x32x16_bf16 v[48:63], a[208:211], v[96:99], v[48:63]
    ds_read_b128 v[92:95], v1 offset:19456
    ds_write_b64 v132, v[136:137]
    v_lshl_add_u32 v32, v133, 6, v32
    v_bfe_u32 v132, v0, 3, 1
    v_lshrrev_b32 v133, 4, v0
    v_mfma_f32_32x32x16_bf16 v[48:63], a[212:215], v[100:103], v[48:63]
    ds_read_b128 v[96:99], v1 offset:20480
    s_lshr_b32 s30, s3, 1
    s_mul_i32 s30, s30, 3
    s_and_b32 s31, s3, 1
    s_lshl_b32 s31, s31, 1
    v_add_u32 v132, s31, v132
    v_cmp_gt_u32 s[32:33], 3, v132
    v_add_u32 v132, s30, v132
    s_waitcnt lgkmcnt(5)
    v_mfma_f32_32x32x16_bf16 v[48:63], a[216:219], v[104:107], v[48:63]
    s_add_u32 m0, s37, 49152
    ds_read_b128 v[100:103], v1 offset:21504
    buffer_load_dwordx4 v1, s[12:15], m0 offen sc1 lds
    v_mul_u32_u24 v132, 10, v132
    v_add_u32 v132, v132, v133
    v_mov_b32 v136, 1073741824
    v_mfma_f32_32x32x16_bf16 v[48:63], a[220:223], v[108:111], v[48:63]
    ds_read_b128 v[104:107], v1 offset:22528
    v_and_b32 v134, 7, v0
    v_lshlrev_b32 v134, 4, v134
    v_lshl_add_u32 v132, v132, 11, v134
    v_cndmask_b32 v188, v136, v132, s[32:33]
    v_add_u32 v189, 8192, v188
    v_mfma_f32_32x32x16_bf16 v[48:63], a[224:227], v[80:83], v[48:63]
    ds_read_b128 v[108:111], v1 offset:23552
    v_add_u32 v190, 16384, v188
    v_cmp_gt_u32 vcc, 2, v133
    s_nop 1
    v_cndmask_b32 v190, v136, v190, vcc
    s_waitcnt lgkmcnt(5)
    v_mfma_f32_32x32x16_bf16 v[48:63], a[228:231], v[84:87], v[48:63]
    s_waitcnt vmcnt(5)
    s_waitcnt lgkmcnt(4)
    s_barrier
    s_add_u32 m0, s37, 53248
    ds_read_b128 v[80:83], v1 offset:24576
    buffer_load_dwordx4 v1, s[12:15], m0 offen sc1 lds
    ds_read_b64 v[8:9], v41 offset:0
    v_mfma_f32_32x32x16_bf16 v[48:63], a[232:235], v[88:91], v[48:63]
    ds_read_b128 v[84:87], v1 offset:25600
    s_mul_i32 s30, s28, 102400
    s_add_u32 s30, s30, 6169088
    s_add_u32 s16, s4, s30
    s_addc_u32 s17, s5, 0
    s_and_b32 s17, s17, 0xffff
    v_mfma_f32_32x32x16_bf16 v[48:63], a[236:239], v[92:95], v[48:63]
    ds_read_b128 v[88:91], v1 offset:26624
    s_waitcnt lgkmcnt(5)
    v_mfma_f32_32x32x16_bf16 v[48:63], a[240:243], v[96:99], v[48:63]
    s_add_u32 m0, s37, 57344
    ds_read_b128 v[92:95], v1 offset:27648
    buffer_load_dwordx4 v1, s[12:15], m0 offen sc1 lds
    v_mfma_f32_32x32x16_bf16 v[48:63], a[244:247], v[100:103], v[48:63]
    ds_read_b128 v[96:99], v1 offset:28672
    v_mfma_f32_32x32x16_bf16 v[48:63], a[248:251], v[104:107], v[48:63]
    ds_read_b128 v[100:103], v1 offset:29696
    s_waitcnt lgkmcnt(4)
    v_mfma_f32_32x32x16_bf16 v[48:63], a[252:255], v[108:111], v[48:63]
    s_add_u32 m0, s37, 61440
    ds_read_b128 v[104:107], v1 offset:30720
    buffer_load_dwordx4 v1, s[12:15], m0 offen sc1 lds
    v_mfma_f32_32x32x16_bf16 v[48:63], v[192:195], v[80:83], v[48:63]
    ds_read_b128 v[108:111], v1 offset:31744
    v_mfma_f32_32x32x16_bf16 v[48:63], v[196:199], v[84:87], v[48:63]
    s_waitcnt vmcnt(6)
    s_barrier
    ds_read_b128 v[80:83], v1 offset:32768
    s_waitcnt lgkmcnt(4)
    v_mfma_f32_32x32x16_bf16 v[48:63], v[200:203], v[88:91], v[48:63]
    s_add_u32 m0, s37, 65536
    ds_read_b128 v[84:87], v1 offset:33792
    buffer_load_dwordx4 v1, s[12:15], m0 offen sc1 lds
    v_mfma_f32_32x32x16_bf16 v[48:63], v[204:207], v[92:95], v[48:63]
    ds_read_b128 v[88:91], v1 offset:34816
    v_mfma_f32_32x32x16_bf16 v[48:63], v[208:211], v[96:99], v[48:63]
    ds_read_b128 v[92:95], v1 offset:35840
    s_waitcnt lgkmcnt(4)
    v_mfma_f32_32x32x16_bf16 v[48:63], v[212:215], v[100:103], v[48:63]
    s_add_u32 m0, s37, 69632
    ds_read_b128 v[96:99], v1 offset:36864
    buffer_load_dwordx4 v1, s[12:15], m0 offen sc1 lds
    v_mfma_f32_32x32x16_bf16 v[48:63], v[216:219], v[104:107], v[48:63]
    ds_read_b128 v[100:103], v1 offset:37888
    v_mfma_f32_32x32x16_bf16 v[48:63], v[220:223], v[108:111], v[48:63]
    ds_read_b128 v[104:107], v1 offset:38912
    s_waitcnt lgkmcnt(4)
    v_mfma_f32_32x32x16_bf16 v[48:63], v[224:227], v[80:83], v[48:63]
    s_add_u32 m0, s37, 73728
    ds_read_b128 v[108:111], v1 offset:39936
    buffer_load_dwordx4 v1, s[12:15], m0 offen sc1 lds
    v_mfma_f32_32x32x16_bf16 v[48:63], v[228:231], v[84:87], v[48:63]
    s_waitcnt vmcnt(5)
    s_barrier
    ds_read_b128 v[80:83], v1 offset:40960
    v_mfma_f32_32x32x16_bf16 v[48:63], v[232:235], v[88:91], v[48:63]
    ds_read_b128 v[84:87], v1 offset:41984
    s_waitcnt lgkmcnt(4)
    v_mfma_f32_32x32x16_bf16 v[48:63], v[236:239], v[92:95], v[48:63]
    s_add_u32 m0, s37, 77824
    ds_read_b128 v[88:91], v1 offset:43008
    buffer_load_dwordx4 v1, s[12:15], m0 offen sc1 lds
    v_mfma_f32_32x32x16_bf16 v[48:63], v[240:243], v[96:99], v[48:63]
    ds_read_b128 v[92:95], v1 offset:44032
    v_mfma_f32_32x32x16_bf16 v[48:63], v[244:247], v[100:103], v[48:63]
    ds_read_b128 v[96:99], v1 offset:45056
    v_mul_f32 v4, 0x3fb8aa3b, v9
    s_waitcnt lgkmcnt(4)
    v_mfma_f32_32x32x16_bf16 v[48:63], v[248:251], v[104:107], v[48:63]
    s_add_u32 m0, s37, 81920
    ds_read_b128 v[100:103], v1 offset:46080
    buffer_load_dwordx4 v1, s[12:15], m0 offen sc1 lds
    v_mfma_f32_32x32x16_bf16 v[48:63], v[252:255], v[108:111], v[48:63]
    ds_read_b128 v[104:107], v1 offset:47104
    v_mfma_f32_32x32x16_bf16 v[48:63], v[16:19], v[8:11], v[48:63]
    v_mfma_f32_32x32x16_bf16 v[64:79], a[160:163], v[80:83], 0
    ds_read_b128 v[108:111], v1 offset:48128
    s_cmp_ge_u32 s3, 2
    s_cselect_b32 s30, 18944, 0
    v_add_u32 v33, s30, v32
    s_nop 6
    v_mul_f32 v58, v58, v9
    s_waitcnt lgkmcnt(4)
    v_mfma_f32_32x32x16_bf16 v[64:79], a[164:167], v[84:87], v[64:79]
    s_add_u32 m0, s37, 86016
    ds_read_b128 v[80:83], v1 offset:49152
    buffer_load_dwordx4 v1, s[12:15], m0 offen sc1 lds
    ds_read_b64 v[10:11], v41 offset:256
    v_mul_f32 v59, v59, v9
    v_mul_f32 v60, v60, v9
    v_mfma_f32_32x32x16_bf16 v[64:79], a[168:171], v[88:91], v[64:79]
    ds_read_b128 v[84:87], v1 offset:50176
    v_mul_f32 v61, v61, v9
    v_mul_f32 v62, v62, v9
    v_mul_f32 v63, v63, v9
    v_cvt_pk_bf16_f32 v148, v58, v59
    v_cvt_pk_bf16_f32 v149, v60, v61
    v_mfma_f32_32x32x16_bf16 v[64:79], a[172:175], v[92:95], v[64:79]
    ds_read_b128 v[88:91], v1 offset:51200
    v_cvt_pk_bf16_f32 v150, v62, v63
    v_max3_f32 v132, v48, v49, v50
    v_max3_f32 v133, -v48, -v49, -v50
    v_max3_f32 v132, v132, v51, v52
    s_waitcnt lgkmcnt(5)
    v_mfma_f32_32x32x16_bf16 v[64:79], a[176:179], v[96:99], v[64:79]
    s_add_u32 m0, s37, 90112
    ds_read_b128 v[92:95], v1 offset:52224
    buffer_load_dwordx4 v1, s[12:15], m0 offen sc1 lds
    ds_write_b64 v33, v[148:149] offset:48
    v_max3_f32 v133, v133, -v51, -v52
    v_max3_f32 v132, v132, v53, v54
    v_mfma_f32_32x32x16_bf16 v[64:79], a[180:183], v[100:103], v[64:79]
    ds_read_b128 v[96:99], v1 offset:53248
    ds_write_b64 v33, v[150:151] offset:56
    v_max3_f32 v133, v133, -v53, -v54
    v_max3_f32 v132, v132, v55, v56
    v_max3_f32 v133, v133, -v55, -v56
    v_mfma_f32_32x32x16_bf16 v[64:79], a[184:187], v[104:107], v[64:79]
    ds_read_b128 v[100:103], v1 offset:54272
    v_max_f32 v132, v132, v57
    v_max_f32_e64 v133, v133, -v57
    s_nop 1
    v_permlane32_swap_b32 v132, v133
    s_waitcnt lgkmcnt(6)
    v_mfma_f32_32x32x16_bf16 v[64:79], a[188:191], v[108:111], v[64:79]
    s_add_u32 m0, s37, 94208
    ds_read_b128 v[104:107], v1 offset:55296
    buffer_load_dwordx4 v1, s[12:15], m0 offen sc1 lds
    v_max_f32 v132, v132, v133
    v_mul_f32_e64 v132, -v132, v4
    v_mov_b32 v133, v132
    v_mfma_f32_32x32x16_bf16 v[64:79], a[192:195], v[80:83], v[64:79]
    ds_read_b128 v[108:111], v1 offset:56320
    v_permlane32_swap_b32 v132, v133
    v_fma_f32 v112, v48, v4, v132
    v_fma_f32 v122, -v48, v4, v133
    v_fma_f32 v113, v49, v4, v132
    v_fma_f32 v123, -v49, v4, v133
    v_mfma_f32_32x32x16_bf16 v[64:79], a[196:199], v[84:87], v[64:79]
    s_waitcnt vmcnt(6)
    s_barrier
    ds_read_b128 v[80:83], v1 offset:57344
    v_fma_f32 v114, v50, v4, v132
    s_waitcnt lgkmcnt(5)
    v_mfma_f32_32x32x16_bf16 v[64:79], a[200:203], v[88:91], v[64:79]
    s_add_u32 m0, s37, 98304
    ds_read_b128 v[84:87], v1 offset:58368
    buffer_load_dwordx4 v1, s[12:15], m0 offen sc1 lds
    v_fma_f32 v124, -v50, v4, v133
    v_fma_f32 v115, v51, v4, v132
    v_fma_f32 v125, -v51, v4, v133
    v_mfma_f32_32x32x16_bf16 v[64:79], a[204:207], v[92:95], v[64:79]
    ds_read_b128 v[88:91], v1 offset:59392
    v_exp_f32 v112, v112
    v_exp_f32 v122, v122
    v_exp_f32 v113, v113
    v_mfma_f32_32x32x16_bf16 v[64:79], a[208:211], v[96:99], v[64:79]
    ds_read_b128 v[92:95], v1 offset:60416
    v_exp_f32 v123, v123
    v_exp_f32 v114, v114
    s_waitcnt lgkmcnt(4)
    v_mfma_f32_32x32x16_bf16 v[64:79], a[212:215], v[100:103], v[64:79]
    s_add_u32 m0, s37, 102400
    ds_read_b128 v[96:99], v1 offset:61440
    buffer_load_dwordx4 v1, s[12:15], m0 offen sc1 lds
    v_exp_f32 v124, v124
    v_exp_f32 v115, v115
    v_mfma_f32_32x32x16_bf16 v[64:79], a[216:219], v[104:107], v[64:79]
    ds_read_b128 v[100:103], v1 offset:62464
    v_exp_f32 v125, v125
    v_fma_f32 v116, v52, v4, v132
    v_fma_f32 v126, -v52, v4, v133
    v_fma_f32 v117, v53, v4, v132
    v_mfma_f32_32x32x16_bf16 v[64:79], a[220:223], v[108:111], v[64:79]
    ds_read_b128 v[104:107], v1 offset:63488
    v_fma_f32 v127, -v53, v4, v133
    v_fma_f32 v118, v54, v4, v132
    v_fma_f32 v128, -v54, v4, v133
    v_fma_f32 v119, v55, v4, v132
    s_waitcnt lgkmcnt(4)
    v_mfma_f32_32x32x16_bf16 v[64:79], a[224:227], v[80:83], v[64:79]
    s_add_u32 m0, s37, 106496
    ds_read_b128 v[108:111], v1 offset:64512
    buffer_load_dwordx4 v1, s[12:15], m0 offen sc1 lds
    v_fma_f32 v129, -v55, v4, v133
    v_exp_f32 v116, v116
    v_mfma_f32_32x32x16_bf16 v[64:79], a[228:231], v[84:87], v[64:79]
    ds_read_b128 v[80:83], v30 offset:0
    v_exp_f32 v126, v126
    v_exp_f32 v117, v117
    v_exp_f32 v127, v127
    v_mfma_f32_32x32x16_bf16 v[64:79], a[232:235], v[88:91], v[64:79]
    ds_read_b128 v[84:87], v30 offset:1024
    v_exp_f32 v118, v118
    v_exp_f32 v128, v128
    s_waitcnt lgkmcnt(4)
    v_mfma_f32_32x32x16_bf16 v[64:79], a[236:239], v[92:95], v[64:79]
    s_add_u32 m0, s37, 110592
    ds_read_b128 v[88:91], v30 offset:2048
    buffer_load_dwordx4 v1, s[12:15], m0 offen sc1 lds
    v_exp_f32 v119, v119
    v_exp_f32 v129, v129
    v_mfma_f32_32x32x16_bf16 v[64:79], a[240:243], v[96:99], v[64:79]
    ds_read_b128 v[92:95], v30 offset:3072
    v_add_f32 v134, v112, v113
    v_add_f32 v135, v122, v123
    v_add_f32 v134, v134, v114
    v_add_f32 v135, v135, v124
    v_add_f32 v134, v134, v115
    v_mfma_f32_32x32x16_bf16 v[64:79], a[244:247], v[100:103], v[64:79]
    ds_read_b128 v[96:99], v30 offset:4096
    v_add_f32 v135, v135, v125
    v_fma_f32 v120, v56, v4, v132
    v_fma_f32 v130, -v56, v4, v133
    v_fma_f32 v121, v57, v4, v132
    s_waitcnt lgkmcnt(4)
    v_mfma_f32_32x32x16_bf16 v[64:79], a[248:251], v[104:107], v[64:79]
    s_add_u32 m0, s37, 114688
    ds_read_b128 v[100:103], v30 offset:5120
    buffer_load_dwordx4 v1, s[12:15], m0 offen sc1 lds
    v_fma_f32 v131, -v57, v4, v133
    v_exp_f32 v120, v120
    v_mfma_f32_32x32x16_bf16 v[64:79], a[252:255], v[108:111], v[64:79]
    ds_read_b128 v[104:107], v30 offset:6144
    v_exp_f32 v130, v130
    v_exp_f32 v121, v121
    v_exp_f32 v131, v131
    v_mfma_f32_32x32x16_bf16 v[64:79], v[192:195], v[80:83], v[64:79]
    ds_read_b128 v[108:111], v30 offset:7168
    v_add_f32 v134, v134, v116
    v_add_f32 v135, v135, v126
    v_add_f32 v134, v134, v117
    v_add_f32 v135, v135, v127
    s_waitcnt lgkmcnt(4)
    v_mfma_f32_32x32x16_bf16 v[64:79], v[196:199], v[84:87], v[64:79]
    s_waitcnt vmcnt(7)
    s_barrier
    s_add_u32 m0, s37, 118784
    ds_read_b128 v[80:83], v30 offset:8192
    buffer_load_dwordx4 v1, s[12:15], m0 offen sc1 lds
    v_mfma_f32_32x32x16_bf16 v[64:79], v[200:203], v[88:91], v[64:79]
    ds_read_b128 v[84:87], v30 offset:9216
    v_add_f32 v134, v134, v118
    v_add_f32 v135, v135, v128
    v_add_f32 v134, v134, v119
    v_add_f32 v135, v135, v129
    v_add_f32 v134, v134, v120
    v_mfma_f32_32x32x16_bf16 v[64:79], v[204:207], v[92:95], v[64:79]
    ds_read_b128 v[88:91], v30 offset:10240
    v_add_f32 v135, v135, v130
    v_add_f32 v134, v134, v121
    v_add_f32 v135, v135, v131
    s_nop 1
    v_permlane32_swap_b32 v134, v135
    s_waitcnt lgkmcnt(4)
    v_mfma_f32_32x32x16_bf16 v[64:79], v[208:211], v[96:99], v[64:79]
    s_add_u32 m0, s37, 122880
    ds_read_b128 v[92:95], v30 offset:11264
    buffer_load_dwordx4 v1, s[12:15], m0 offen sc1 lds
    v_add_f32 v134, v134, v135
    v_rcp_f32 v134, v134
    v_mfma_f32_32x32x16_bf16 v[64:79], v[212:215], v[100:103], v[64:79]
    ds_read_b128 v[96:99], v30 offset:12288
    v_mov_b32 v135, v134
    s_nop 1
    v_permlane32_swap_b32 v134, v135
    v_mul_f32 v112, v112, v134
    v_mfma_f32_32x32x16_bf16 v[64:79], v[216:219], v[104:107], v[64:79]
    ds_read_b128 v[100:103], v30 offset:13312
    v_mul_f32 v113, v113, v134
    v_cvt_pk_bf16_f32 v138, v112, v113
    v_mul_f32 v114, v114, v134
    v_mul_f32 v115, v115, v134
    s_waitcnt lgkmcnt(4)
    v_mfma_f32_32x32x16_bf16 v[64:79], v[220:223], v[108:111], v[64:79]
    s_add_u32 m0, s37, 126976
    ds_read_b128 v[104:107], v30 offset:14336
    buffer_load_dwordx4 v1, s[12:15], m0 offen sc1 lds
    v_cvt_pk_bf16_f32 v139, v114, v115
    v_mul_f32 v116, v116, v134
    v_mul_f32 v117, v117, v134
    v_cvt_pk_bf16_f32 v140, v116, v117
    v_mfma_f32_32x32x16_bf16 v[64:79], v[224:227], v[80:83], v[64:79]
    ds_read_b128 v[108:111], v30 offset:15360
    ds_write_b64 v33, v[138:139] offset:0
    v_mul_f32 v118, v118, v134
    v_mul_f32 v119, v119, v134
    v_cvt_pk_bf16_f32 v141, v118, v119
    v_mfma_f32_32x32x16_bf16 v[64:79], v[228:231], v[84:87], v[64:79]
    ds_read_b128 v[80:83], v30 offset:16384
    v_mul_f32 v120, v120, v134
    v_mul_f32 v121, v121, v134
    v_cvt_pk_bf16_f32 v142, v120, v121
    v_mul_f32 v122, v122, v135
    s_waitcnt lgkmcnt(5)
    v_mfma_f32_32x32x16_bf16 v[64:79], v[232:235], v[88:91], v[64:79]
    s_add_u32 m0, s37, 131072
    ds_read_b128 v[84:87], v30 offset:17408
    buffer_load_dwordx4 v1, s[12:15], m0 offen sc1 lds
    ds_write_b64 v33, v[140:141] offset:8
    v_mul_f32 v123, v123, v135
    v_mfma_f32_32x32x16_bf16 v[64:79], v[236:239], v[92:95], v[64:79]
    ds_read_b128 v[88:91], v30 offset:18432
    v_cvt_pk_bf16_f32 v143, v122, v123
    v_mul_f32 v124, v124, v135
    v_mul_f32 v125, v125, v135
    v_cvt_pk_bf16_f32 v144, v124, v125
    v_mul_f32 v126, v126, v135
    v_mul_f32 v127, v127, v135
    v_mfma_f32_32x32x16_bf16 v[64:79], v[240:243], v[96:99], v[64:79]
    ds_read_b128 v[92:95], v30 offset:19456
    ds_write_b64 v33, v[142:143] offset:16
    v_cvt_pk_bf16_f32 v145, v126, v127
    v_mul_f32 v128, v128, v135
    s_waitcnt lgkmcnt(7)
    v_mfma_f32_32x32x16_bf16 v[64:79], v[244:247], v[100:103], v[64:79]
    s_add_u32 m0, s37, 135168
    ds_read_b128 v[96:99], v30 offset:20480
    buffer_load_dwordx4 v1, s[12:15], m0 offen sc1 lds
    ds_write_b64 v33, v[144:145] offset:24
    v_mul_f32 v129, v129, v135
    v_mfma_f32_32x32x16_bf16 v[64:79], v[248:251], v[104:107], v[64:79]
    ds_read_b128 v[100:103], v30 offset:21504
    v_cvt_pk_bf16_f32 v146, v128, v129
    v_mul_f32 v130, v130, v135
    v_mul_f32 v131, v131, v135
    v_cvt_pk_bf16_f32 v147, v130, v131
    v_mul_f32 v5, 0x3fb8aa3b, v11
    v_mfma_f32_32x32x16_bf16 v[64:79], v[252:255], v[108:111], v[64:79]
    ds_read_b128 v[104:107], v30 offset:22528
    ds_write_b64 v33, v[146:147] offset:32
    s_waitcnt lgkmcnt(7)
    v_mfma_f32_32x32x16_bf16 v[64:79], v[16:19], v[10:13], v[64:79]
    s_waitcnt vmcnt(8)
    s_waitcnt lgkmcnt(0)
    s_barrier
    v_mfma_f32_32x32x16_bf16 v[48:63], a[160:163], v[80:83], 0
    s_add_u32 m0, s37, 139264
    ds_read_b128 v[108:111], v30 offset:23552
    buffer_load_dwordx4 v1, s[12:15], m0 offen sc1 lds
    s_bitcmp1_b32 s3, 0
    s_cselect_b32 s30, 18944, 0
    v_add_u32 v40, s30, v39
    v_mfma_f32_32x32x16_bf16 v[48:63], a[164:167], v[84:87], v[48:63]
    ds_read_b128 v[80:83], v30 offset:24576
    v_mul_f32 v74, v74, v11
    v_mul_f32 v75, v75, v11
    v_mul_f32 v76, v76, v11
    v_mul_f32 v77, v77, v11
    v_mul_f32 v78, v78, v11
    v_mfma_f32_32x32x16_bf16 v[48:63], a[168:171], v[88:91], v[48:63]
    ds_read_b128 v[84:87], v30 offset:25600
    ds_read_b64_tr_b16 v[164:165], v40 offset:0
    ds_read_b64_tr_b16 v[166:167], v40 offset:4736
    v_mul_f32 v79, v79, v11
    v_cvt_pk_bf16_f32 v148, v74, v75
    v_cvt_pk_bf16_f32 v149, v76, v77
    v_mfma_f32_32x32x16_bf16 v[48:63], a[172:175], v[92:95], v[48:63]
    s_add_u32 m0, s37, 143360
    ds_read_b128 v[88:91], v30 offset:26624
    buffer_load_dwordx4 v1, s[12:15], m0 offen sc1 lds
    ds_read_b64_tr_b16 v[152:153], v34 offset:0
    ds_read_b64_tr_b16 v[154:155], v34 offset:4736
    v_cvt_pk_bf16_f32 v150, v78, v79
    v_mfma_f32_32x32x16_bf16 v[48:63], a[176:179], v[96:99], v[48:63]
    ds_read_b128 v[92:95], v30 offset:27648
    ds_read_b64_tr_b16 v[156:157], v35 offset:0
    ds_read_b64_tr_b16 v[158:159], v35 offset:4736
    v_max3_f32 v132, v64, v65, v66
    v_max3_f32 v133, -v64, -v65, -v66
    v_max3_f32 v132, v132, v67, v68
    v_max3_f32 v133, v133, -v67, -v68
    v_mfma_f32_32x32x16_bf16 v[48:63], a[180:183], v[100:103], v[48:63]
    ds_read_b128 v[96:99], v30 offset:28672
    ds_read_b64_tr_b16 v[160:161], v36 offset:0
    ds_read_b64_tr_b16 v[162:163], v36 offset:4736
    v_max3_f32 v132, v132, v69, v70
    v_max3_f32 v133, v133, -v69, -v70
    v_max3_f32 v132, v132, v71, v72
    v_mfma_f32_32x32x16_bf16 v[48:63], a[184:187], v[104:107], v[48:63]
    s_add_u32 m0, s37, 147456
    ds_read_b128 v[100:103], v30 offset:29696
    buffer_load_dwordx4 v1, s[12:15], m0 offen sc1 lds
    ds_read_b64 v[8:9], v41 offset:512
    ds_write_b64 v33, v[148:149] offset:9520
    s_waitcnt lgkmcnt(14)
    v_mfma_f32_32x32x16_bf16 v[48:63], a[188:191], v[108:111], v[48:63]
    ds_read_b128 v[104:107], v30 offset:30720
    ds_write_b64 v33, v[150:151] offset:9528
    v_max3_f32 v133, v133, -v71, -v72
    v_max_f32 v132, v132, v73
    v_max_f32_e64 v133, v133, -v73
    v_mfma_f32_32x32x16_bf16 v[48:63], a[192:195], v[80:83], v[48:63]
    ds_read_b128 v[108:111], v30 offset:31744
    v_permlane32_swap_b32 v132, v133
    v_max_f32 v132, v132, v133
    v_mul_f32_e64 v132, -v132, v5
    v_mov_b32 v133, v132
    s_nop 1
    v_permlane32_swap_b32 v132, v133
    s_waitcnt lgkmcnt(6)
    v_mfma_f32_16x16x32_bf16 v[168:171], v[152:155], v[164:167], 0
    v_fma_f32 v112, v64, v5, v132
    v_fma_f32 v122, -v64, v5, v133
    v_mfma_f32_16x16x32_bf16 v[172:175], v[156:159], v[164:167], 0
    v_fma_f32 v113, v65, v5, v132
    v_fma_f32 v123, -v65, v5, v133
    v_mfma_f32_16x16x32_bf16 v[176:179], v[160:163], v[164:167], 0
    v_fma_f32 v114, v66, v5, v132
    v_fma_f32 v124, -v66, v5, v133
    v_mfma_f32_32x32x16_bf16 v[48:63], a[196:199], v[84:87], v[48:63]
    s_add_u32 m0, s37, 151552
    ds_read_b128 v[80:83], v30 offset:32768
    buffer_load_dwordx4 v1, s[12:15], m0 offen sc1 lds
    v_fma_f32 v115, v67, v5, v132
    v_fma_f32 v125, -v67, v5, v133
    v_mfma_f32_32x32x16_bf16 v[48:63], a[200:203], v[88:91], v[48:63]
    ds_read_b128 v[84:87], v30 offset:33792
    v_exp_f32 v112, v112
    v_exp_f32 v122, v122
    v_exp_f32 v113, v113
    v_mfma_f32_32x32x16_bf16 v[48:63], a[204:207], v[92:95], v[48:63]
    ds_read_b128 v[88:91], v30 offset:34816
    v_exp_f32 v123, v123
    v_exp_f32 v114, v114
    v_exp_f32 v124, v124
    v_mfma_f32_32x32x16_bf16 v[48:63], a[208:211], v[96:99], v[48:63]
    s_add_u32 m0, s37, 155648
    ds_read_b128 v[92:95], v30 offset:35840
    buffer_load_dwordx4 v1, s[12:15], m0 offen sc1 lds
    v_exp_f32 v115, v115
    s_waitcnt lgkmcnt(4)
    v_mfma_f32_32x32x16_bf16 v[48:63], a[212:215], v[100:103], v[48:63]
    ds_read_b128 v[96:99], v30 offset:36864
    v_exp_f32 v125, v125
    v_fma_f32 v116, v68, v5, v132
    v_fma_f32 v126, -v68, v5, v133
    v_fma_f32 v117, v69, v5, v132
    v_mfma_f32_32x32x16_bf16 v[48:63], a[216:219], v[104:107], v[48:63]
    ds_read_b128 v[100:103], v30 offset:37888
    v_fma_f32 v127, -v69, v5, v133
    v_fma_f32 v118, v70, v5, v132
    v_fma_f32 v128, -v70, v5, v133
    v_fma_f32 v119, v71, v5, v132
    v_fma_f32 v129, -v71, v5, v133
    v_mfma_f32_32x32x16_bf16 v[48:63], a[220:223], v[108:111], v[48:63]
    s_add_u32 m0, s37, 159744
    s_min_u32 m0, m0, 161792
    ds_read_b128 v[104:107], v30 offset:38912
    buffer_load_dwordx4 v1, s[12:15], m0 offen sc1 lds
    s_mov_b32 s30, 162816
    buffer_load_dwordx4 v[180:183], v1, s[12:15], s30 offen sc1
    s_waitcnt lgkmcnt(4)
    v_mfma_f32_32x32x16_bf16 v[48:63], a[224:227], v[80:83], v[48:63]
    ds_read_b128 v[108:111], v30 offset:39936
    v_exp_f32 v116, v116
    v_exp_f32 v126, v126
    v_exp_f32 v117, v117
    v_mfma_f32_32x32x16_bf16 v[48:63], a[228:231], v[84:87], v[48:63]
    s_waitcnt vmcnt(9)
    s_barrier
    ds_read_b128 v[80:83], v30 offset:40960
    v_exp_f32 v127, v127
    v_mfma_f32_32x32x16_bf16 v[48:63], a[232:235], v[88:91], v[48:63]
    s_add_u32 m0, s37, 56832
    ds_read_b128 v[84:87], v30 offset:41984
    buffer_load_dwordx4 v1, s[16:19], m0 offen lds
    v_exp_f32 v118, v118
    s_waitcnt lgkmcnt(4)
    v_mfma_f32_32x32x16_bf16 v[48:63], a[236:239], v[92:95], v[48:63]
    ds_read_b128 v[88:91], v30 offset:43008
    v_exp_f32 v128, v128
    v_exp_f32 v119, v119
    v_exp_f32 v129, v129
    v_mfma_f32_32x32x16_bf16 v[48:63], a[240:243], v[96:99], v[48:63]
    ds_read_b128 v[92:95], v30 offset:44032
    v_add_f32 v134, v112, v113
    v_add_f32 v135, v122, v123
    v_add_f32 v134, v134, v114
    v_add_f32 v135, v135, v124
    v_add_f32 v134, v134, v115
    v_mfma_f32_32x32x16_bf16 v[48:63], a[244:247], v[100:103], v[48:63]
    s_add_u32 m0, s37, 60928
    ds_read_b128 v[96:99], v30 offset:45056
    buffer_load_dwordx4 v1, s[16:19], m0 offen lds
    v_add_f32 v135, v135, v125
    v_fma_f32 v120, v72, v5, v132
    s_waitcnt lgkmcnt(4)
    v_mfma_f32_32x32x16_bf16 v[48:63], a[248:251], v[104:107], v[48:63]
    ds_read_b128 v[100:103], v30 offset:46080
    v_fma_f32 v130, -v72, v5, v133
    v_fma_f32 v121, v73, v5, v132
    v_fma_f32 v131, -v73, v5, v133
    v_exp_f32 v120, v120
    v_mfma_f32_32x32x16_bf16 v[48:63], a[252:255], v[108:111], v[48:63]
    ds_read_b128 v[104:107], v30 offset:47104
    v_exp_f32 v130, v130
    v_exp_f32 v121, v121
    v_exp_f32 v131, v131
    v_mfma_f32_32x32x16_bf16 v[48:63], v[192:195], v[80:83], v[48:63]
    s_add_u32 m0, s37, 65024
    ds_read_b128 v[108:111], v30 offset:48128
    buffer_load_dwordx4 v1, s[16:19], m0 offen lds
    v_add_f32 v134, v134, v116
    v_add_f32 v135, v135, v126
    s_waitcnt lgkmcnt(4)
    v_mfma_f32_32x32x16_bf16 v[48:63], v[196:199], v[84:87], v[48:63]
    ds_read_b128 v[80:83], v30 offset:49152
    v_add_f32 v134, v134, v117
    v_add_f32 v135, v135, v127
    v_add_f32 v134, v134, v118
    v_add_f32 v135, v135, v128
    v_add_f32 v134, v134, v119
    v_mfma_f32_32x32x16_bf16 v[48:63], v[200:203], v[88:91], v[48:63]
    ds_read_b128 v[84:87], v30 offset:50176
    v_add_f32 v135, v135, v129
    v_add_f32 v134, v134, v120
    v_add_f32 v135, v135, v130
    v_add_f32 v134, v134, v121
    v_add_f32 v135, v135, v131
    s_nop 1
    v_permlane32_swap_b32 v134, v135
    v_mfma_f32_32x32x16_bf16 v[48:63], v[204:207], v[92:95], v[48:63]
    s_add_u32 m0, s37, 69120
    ds_read_b128 v[88:91], v30 offset:51200
    buffer_load_dwordx4 v1, s[16:19], m0 offen lds
    v_add_f32 v134, v134, v135
    s_waitcnt lgkmcnt(4)
    v_mfma_f32_32x32x16_bf16 v[48:63], v[208:211], v[96:99], v[48:63]
    ds_read_b128 v[92:95], v30 offset:52224
    v_rcp_f32 v134, v134
    s_nop 0
    v_mov_b32 v135, v134
    s_nop 1
    v_permlane32_swap_b32 v134, v135
    v_mfma_f32_32x32x16_bf16 v[48:63], v[212:215], v[100:103], v[48:63]
    ds_read_b128 v[96:99], v30 offset:53248
    v_mul_f32 v112, v112, v134
    v_mul_f32 v113, v113, v134
    v_cvt_pk_bf16_f32 v138, v112, v113
    v_mul_f32 v114, v114, v134
    v_mul_f32 v115, v115, v134
    v_mfma_f32_32x32x16_bf16 v[48:63], v[216:219], v[104:107], v[48:63]
    s_add_u32 m0, s37, 73216
    ds_read_b128 v[100:103], v30 offset:54272
    buffer_load_dwordx4 v1, s[16:19], m0 offen lds
    v_cvt_pk_bf16_f32 v139, v114, v115
    v_mul_f32 v116, v116, v134
    s_waitcnt lgkmcnt(4)
    v_mfma_f32_32x32x16_bf16 v[48:63], v[220:223], v[108:111], v[48:63]
    ds_read_b128 v[104:107], v30 offset:55296
    ds_write_b64 v33, v[138:139] offset:9472
    v_mul_f32 v117, v117, v134
    v_cvt_pk_bf16_f32 v140, v116, v117
    v_mul_f32 v118, v118, v134
    v_mfma_f32_32x32x16_bf16 v[48:63], v[224:227], v[80:83], v[48:63]
    ds_read_b128 v[108:111], v30 offset:56320
    v_mul_f32 v119, v119, v134
    v_cvt_pk_bf16_f32 v141, v118, v119
    v_mul_f32 v120, v120, v134
    v_mul_f32 v121, v121, v134
    v_cvt_pk_bf16_f32 v142, v120, v121
    v_mul_f32 v122, v122, v135
    v_mfma_f32_32x32x16_bf16 v[48:63], v[228:231], v[84:87], v[48:63]
    s_add_u32 m0, s37, 77312
    ds_read_b128 v[80:83], v30 offset:57344
    buffer_load_dwordx4 v1, s[16:19], m0 offen lds
    ds_write_b64 v33, v[140:141] offset:9480
    s_waitcnt lgkmcnt(6)
    v_mfma_f32_32x32x16_bf16 v[48:63], v[232:235], v[88:91], v[48:63]
    ds_read_b128 v[84:87], v30 offset:58368
    v_mul_f32 v123, v123, v135
    v_cvt_pk_bf16_f32 v143, v122, v123
    v_mul_f32 v124, v124, v135
    v_mul_f32 v125, v125, v135
    v_cvt_pk_bf16_f32 v144, v124, v125
    v_mfma_f32_32x32x16_bf16 v[48:63], v[236:239], v[92:95], v[48:63]
    ds_read_b128 v[88:91], v30 offset:59392
    ds_write_b64 v33, v[142:143] offset:9488
    v_mul_f32 v126, v126, v135
    v_mul_f32 v127, v127, v135
    v_cvt_pk_bf16_f32 v145, v126, v127
    v_mfma_f32_32x32x16_bf16 v[48:63], v[240:243], v[96:99], v[48:63]
    s_add_u32 m0, s37, 81408
    ds_read_b128 v[92:95], v30 offset:60416
    buffer_load_dwordx4 v1, s[16:19], m0 offen lds
    v_mul_f32 v128, v128, v135
    v_mul_f32 v129, v129, v135
    v_cvt_pk_bf16_f32 v146, v128, v129
    s_waitcnt lgkmcnt(6)
    v_mfma_f32_32x32x16_bf16 v[48:63], v[244:247], v[100:103], v[48:63]
    ds_read_b128 v[96:99], v30 offset:61440
    ds_write_b64 v33, v[144:145] offset:9496
    v_mul_f32 v130, v130, v135
    v_mul_f32 v131, v131, v135
    v_cvt_pk_bf16_f32 v147, v130, v131
    v_mfma_f32_32x32x16_bf16 v[48:63], v[248:251], v[104:107], v[48:63]
    ds_read_b128 v[100:103], v30 offset:62464
    v_mul_f32 v4, 0x3fb8aa3b, v9
    v_mfma_f32_32x32x16_bf16 v[48:63], v[252:255], v[108:111], v[48:63]
    s_add_u32 m0, s37, 85504
    ds_read_b128 v[104:107], v30 offset:63488
    buffer_load_dwordx4 v1, s[16:19], m0 offen lds
    ds_write_b64 v33, v[146:147] offset:9504
    s_waitcnt lgkmcnt(7)
    v_mfma_f32_32x32x16_bf16 v[48:63], v[16:19], v[8:11], v[48:63]
    s_waitcnt vmcnt(13)
    s_waitcnt lgkmcnt(0)
    s_barrier
    v_mfma_f32_32x32x16_bf16 v[64:79], a[160:163], v[80:83], 0
    ds_read_b128 v[108:111], v30 offset:64512
    s_cmp_ge_u32 s3, 2
    s_cselect_b32 s30, 37888, 0
    v_add_u32 v33, s30, v32
    s_nop 3
    v_mul_f32 v58, v58, v9
    v_mfma_f32_32x32x16_bf16 v[64:79], a[164:167], v[84:87], v[64:79]
    ds_read_b128 v[80:83], v31 offset:0
    ds_read_b64_tr_b16 v[164:165], v40 offset:9472
    ds_read_b64_tr_b16 v[166:167], v40 offset:14208
    v_mul_f32 v59, v59, v9
    v_mul_f32 v60, v60, v9
    v_mul_f32 v61, v61, v9
    v_mfma_f32_32x32x16_bf16 v[64:79], a[168:171], v[88:91], v[64:79]
    s_add_u32 m0, s37, 89600
    ds_read_b128 v[84:87], v31 offset:1024
    buffer_load_dwordx4 v1, s[16:19], m0 offen lds
    ds_read_b64_tr_b16 v[152:153], v34 offset:9472
    ds_read_b64_tr_b16 v[154:155], v34 offset:14208
    v_mul_f32 v62, v62, v9
    v_mfma_f32_32x32x16_bf16 v[64:79], a[172:175], v[92:95], v[64:79]
    ds_read_b128 v[88:91], v31 offset:2048
    ds_read_b64_tr_b16 v[156:157], v35 offset:9472
    ds_read_b64_tr_b16 v[158:159], v35 offset:14208
    v_mul_f32 v63, v63, v9
    v_cvt_pk_bf16_f32 v148, v58, v59
    v_cvt_pk_bf16_f32 v149, v60, v61
    v_mfma_f32_32x32x16_bf16 v[64:79], a[176:179], v[96:99], v[64:79]
    ds_read_b128 v[92:95], v31 offset:3072
    ds_read_b64_tr_b16 v[160:161], v36 offset:9472
    ds_read_b64_tr_b16 v[162:163], v36 offset:14208
    v_cvt_pk_bf16_f32 v150, v62, v63
    v_max3_f32 v132, v48, v49, v50
    v_max3_f32 v133, -v48, -v49, -v50
    v_max3_f32 v132, v132, v51, v52
    v_mfma_f32_32x32x16_bf16 v[64:79], a[180:183], v[100:103], v[64:79]
    s_add_u32 m0, s37, 93696
    ds_read_b128 v[96:99], v31 offset:4096
    buffer_load_dwordx4 v1, s[16:19], m0 offen lds
    ds_read_b64 v[10:11], v41 offset:768
    ds_write_b64 v33, v[148:149] offset:48
    v_mfma_f32_32x32x16_bf16 v[64:79], a[184:187], v[104:107], v[64:79]
    ds_read_b128 v[100:103], v31 offset:5120
    ds_write_b64 v33, v[150:151] offset:56
    v_max3_f32 v133, v133, -v51, -v52
    v_max3_f32 v132, v132, v53, v54
    s_waitcnt lgkmcnt(13)
    v_mfma_f32_32x32x16_bf16 v[64:79], a[188:191], v[108:111], v[64:79]
    ds_read_b128 v[104:107], v31 offset:6144
    v_max3_f32 v133, v133, -v53, -v54
    v_max3_f32 v132, v132, v55, v56
    v_max3_f32 v133, v133, -v55, -v56
    v_max_f32 v132, v132, v57
    v_max_f32_e64 v133, v133, -v57
    s_waitcnt lgkmcnt(6)
    v_mfma_f32_16x16x32_bf16 v[168:171], v[152:155], v[164:167], v[168:171]
    v_permlane32_swap_b32 v132, v133
    v_max_f32 v132, v132, v133
    v_mfma_f32_16x16x32_bf16 v[172:175], v[156:159], v[164:167], v[172:175]
    v_mul_f32_e64 v132, -v132, v4
    v_mov_b32 v133, v132
    v_mfma_f32_16x16x32_bf16 v[176:179], v[160:163], v[164:167], v[176:179]
    s_nop 0
    v_permlane32_swap_b32 v132, v133
    v_mfma_f32_32x32x16_bf16 v[64:79], a[192:195], v[80:83], v[64:79]
    s_add_u32 m0, s37, 97792
    ds_read_b128 v[108:111], v31 offset:7168
    buffer_load_dwordx4 v1, s[16:19], m0 offen lds
    v_fma_f32 v112, v48, v4, v132
    v_fma_f32 v122, -v48, v4, v133
    v_fma_f32 v113, v49, v4, v132
    v_fma_f32 v123, -v49, v4, v133
    v_mfma_f32_32x32x16_bf16 v[64:79], a[196:199], v[84:87], v[64:79]
    ds_read_b128 v[80:83], v31 offset:8192
    v_fma_f32 v114, v50, v4, v132
    v_fma_f32 v124, -v50, v4, v133
    v_fma_f32 v115, v51, v4, v132
    v_fma_f32 v125, -v51, v4, v133
    v_exp_f32 v112, v112
    v_mfma_f32_32x32x16_bf16 v[64:79], a[200:203], v[88:91], v[64:79]
    ds_read_b128 v[84:87], v31 offset:9216
    v_exp_f32 v122, v122
    v_exp_f32 v113, v113
    v_mfma_f32_32x32x16_bf16 v[64:79], a[204:207], v[92:95], v[64:79]
    s_add_u32 m0, s37, 101888
    ds_read_b128 v[88:91], v31 offset:10240
    buffer_load_dwordx4 v1, s[16:19], m0 offen lds
    v_exp_f32 v123, v123
    s_waitcnt lgkmcnt(4)
    v_mfma_f32_32x32x16_bf16 v[64:79], a[208:211], v[96:99], v[64:79]
    ds_read_b128 v[92:95], v31 offset:11264
    v_exp_f32 v114, v114
    v_exp_f32 v124, v124
    v_exp_f32 v115, v115
    v_mfma_f32_32x32x16_bf16 v[64:79], a[212:215], v[100:103], v[64:79]
    ds_read_b128 v[96:99], v31 offset:12288
    v_exp_f32 v125, v125
    v_fma_f32 v116, v52, v4, v132
    v_fma_f32 v126, -v52, v4, v133
    v_fma_f32 v117, v53, v4, v132
    v_mfma_f32_32x32x16_bf16 v[64:79], a[216:219], v[104:107], v[64:79]
    s_add_u32 m0, s37, 105984
    ds_read_b128 v[100:103], v31 offset:13312
    buffer_load_dwordx4 v1, s[16:19], m0 offen lds
    v_fma_f32 v127, -v53, v4, v133
    v_fma_f32 v118, v54, v4, v132
    s_waitcnt lgkmcnt(4)
    v_mfma_f32_32x32x16_bf16 v[64:79], a[220:223], v[108:111], v[64:79]
    ds_read_b128 v[104:107], v31 offset:14336
    v_fma_f32 v128, -v54, v4, v133
    v_fma_f32 v119, v55, v4, v132
    v_fma_f32 v129, -v55, v4, v133
    v_exp_f32 v116, v116
    v_mfma_f32_32x32x16_bf16 v[64:79], a[224:227], v[80:83], v[64:79]
    ds_read_b128 v[108:111], v31 offset:15360
    v_exp_f32 v126, v126
    v_exp_f32 v117, v117
    v_exp_f32 v127, v127
    v_mfma_f32_32x32x16_bf16 v[64:79], a[228:231], v[84:87], v[64:79]
    s_waitcnt vmcnt(13)
    s_barrier
    s_add_u32 m0, s37, 110080
    ds_read_b128 v[80:83], v31 offset:16384
    buffer_load_dwordx4 v1, s[16:19], m0 offen lds
    s_waitcnt lgkmcnt(4)
    v_mfma_f32_32x32x16_bf16 v[64:79], a[232:235], v[88:91], v[64:79]
    ds_read_b128 v[84:87], v31 offset:17408
    v_exp_f32 v118, v118
    v_exp_f32 v128, v128
    v_mfma_f32_32x32x16_bf16 v[64:79], a[236:239], v[92:95], v[64:79]
    ds_read_b128 v[88:91], v31 offset:18432
    v_exp_f32 v119, v119
    v_exp_f32 v129, v129
    v_add_f32 v134, v112, v113
    v_add_f32 v135, v122, v123
    v_mfma_f32_32x32x16_bf16 v[64:79], a[240:243], v[96:99], v[64:79]
    s_add_u32 m0, s37, 114176
    ds_read_b128 v[92:95], v31 offset:19456
    buffer_load_dwordx4 v1, s[16:19], m0 offen lds
    v_add_f32 v134, v134, v114
    v_add_f32 v135, v135, v124
    s_waitcnt lgkmcnt(4)
    v_mfma_f32_32x32x16_bf16 v[64:79], a[244:247], v[100:103], v[64:79]
    ds_read_b128 v[96:99], v31 offset:20480
    v_add_f32 v134, v134, v115
    v_add_f32 v135, v135, v125
    v_fma_f32 v120, v56, v4, v132
    v_fma_f32 v130, -v56, v4, v133
    v_fma_f32 v121, v57, v4, v132
    v_mfma_f32_32x32x16_bf16 v[64:79], a[248:251], v[104:107], v[64:79]
    ds_read_b128 v[100:103], v31 offset:21504
    v_fma_f32 v131, -v57, v4, v133
    v_exp_f32 v120, v120
    v_exp_f32 v130, v130
    v_mfma_f32_32x32x16_bf16 v[64:79], a[252:255], v[108:111], v[64:79]
    s_add_u32 m0, s37, 118272
    ds_read_b128 v[104:107], v31 offset:22528
    buffer_load_dwordx4 v1, s[16:19], m0 offen lds
    v_exp_f32 v121, v121
    s_waitcnt lgkmcnt(4)
    v_mfma_f32_32x32x16_bf16 v[64:79], v[192:195], v[80:83], v[64:79]
    ds_read_b128 v[108:111], v31 offset:23552
    v_exp_f32 v131, v131
    v_add_f32 v134, v134, v116
    v_add_f32 v135, v135, v126
    v_add_f32 v134, v134, v117
    v_add_f32 v135, v135, v127
    v_mfma_f32_32x32x16_bf16 v[64:79], v[196:199], v[84:87], v[64:79]
    ds_read_b128 v[80:83], v31 offset:24576
    v_add_f32 v134, v134, v118
    v_add_f32 v135, v135, v128
    v_add_f32 v134, v134, v119
    v_add_f32 v135, v135, v129
    v_add_f32 v134, v134, v120
    v_mfma_f32_32x32x16_bf16 v[64:79], v[200:203], v[88:91], v[64:79]
    s_add_u32 m0, s37, 122368
    ds_read_b128 v[84:87], v31 offset:25600
    buffer_load_dwordx4 v1, s[16:19], m0 offen lds
    v_add_f32 v135, v135, v130
    v_add_f32 v134, v134, v121
    s_waitcnt lgkmcnt(4)
    v_mfma_f32_32x32x16_bf16 v[64:79], v[204:207], v[92:95], v[64:79]
    ds_read_b128 v[88:91], v31 offset:26624
    v_add_f32 v135, v135, v131
    s_nop 1
    v_permlane32_swap_b32 v134, v135
    v_add_f32 v134, v134, v135
    v_mfma_f32_32x32x16_bf16 v[64:79], v[208:211], v[96:99], v[64:79]
    ds_read_b128 v[92:95], v31 offset:27648
    v_rcp_f32 v134, v134
    s_nop 0
    v_mov_b32 v135, v134
    s_nop 1
    v_permlane32_swap_b32 v134, v135
    v_mfma_f32_32x32x16_bf16 v[64:79], v[212:215], v[100:103], v[64:79]
    s_add_u32 m0, s37, 126464
    ds_read_b128 v[96:99], v31 offset:28672
    buffer_load_dwordx4 v1, s[16:19], m0 offen lds
    v_mul_f32 v112, v112, v134
    v_mul_f32 v113, v113, v134
    s_waitcnt lgkmcnt(4)
    v_mfma_f32_32x32x16_bf16 v[64:79], v[216:219], v[104:107], v[64:79]
    ds_read_b128 v[100:103], v31 offset:29696
    v_cvt_pk_bf16_f32 v138, v112, v113
    v_mul_f32 v114, v114, v134
    v_mul_f32 v115, v115, v134
    v_cvt_pk_bf16_f32 v139, v114, v115
    v_mul_f32 v116, v116, v134
    v_mfma_f32_32x32x16_bf16 v[64:79], v[220:223], v[108:111], v[64:79]
    ds_read_b128 v[104:107], v31 offset:30720
    ds_write_b64 v33, v[138:139] offset:0
    v_mul_f32 v117, v117, v134
    v_cvt_pk_bf16_f32 v140, v116, v117
    v_mul_f32 v118, v118, v134
    v_mfma_f32_32x32x16_bf16 v[64:79], v[224:227], v[80:83], v[64:79]
    s_add_u32 m0, s37, 130560
    s_nop 0
    buffer_load_dwordx4 v1, s[16:19], m0 offen lds
    v_mul_f32 v119, v119, v134
    v_cvt_pk_bf16_f32 v141, v118, v119
    s_waitcnt lgkmcnt(4)
    v_mfma_f32_32x32x16_bf16 v[64:79], v[228:231], v[84:87], v[64:79]
    v_mul_f32 v120, v120, v134
    v_mul_f32 v121, v121, v134
    v_cvt_pk_bf16_f32 v142, v120, v121
    v_mul_f32 v122, v122, v135
    v_mul_f32 v123, v123, v135
    v_cvt_pk_bf16_f32 v143, v122, v123
    v_mfma_f32_32x32x16_bf16 v[64:79], v[232:235], v[88:91], v[64:79]
    ds_write_b64 v33, v[140:141] offset:8
    v_mul_f32 v124, v124, v135
    v_mul_f32 v125, v125, v135
    v_cvt_pk_bf16_f32 v144, v124, v125
    v_mul_f32 v126, v126, v135
    v_mul_f32 v127, v127, v135
    v_mfma_f32_32x32x16_bf16 v[64:79], v[236:239], v[92:95], v[64:79]
    s_add_u32 m0, s37, 134656
    s_nop 0
    buffer_load_dwordx4 v1, s[16:19], m0 offen lds
    ds_write_b64 v33, v[142:143] offset:16
    s_waitcnt lgkmcnt(3)
    v_mfma_f32_32x32x16_bf16 v[64:79], v[240:243], v[96:99], v[64:79]
    v_cvt_pk_bf16_f32 v145, v126, v127
    v_mul_f32 v128, v128, v135
    v_mul_f32 v129, v129, v135
    v_cvt_pk_bf16_f32 v146, v128, v129
    v_mul_f32 v130, v130, v135
    v_mul_f32 v131, v131, v135
    v_mfma_f32_32x32x16_bf16 v[64:79], v[244:247], v[100:103], v[64:79]
    ds_write_b64 v33, v[144:145] offset:24
    v_cvt_pk_bf16_f32 v147, v130, v131
    v_mul_f32 v5, 0x3fb8aa3b, v11
    v_mfma_f32_32x32x16_bf16 v[64:79], v[248:251], v[104:107], v[64:79]
    ds_write_b64 v33, v[146:147] offset:32
    v_mfma_f32_32x32x16_bf16 v[64:79], v[252:255], v[180:183], v[64:79]
    v_mfma_f32_32x32x16_bf16 v[64:79], v[16:19], v[10:13], v[64:79]
    s_waitcnt lgkmcnt(0)
    s_barrier
    s_mul_i32 s34, s21, 131072
    s_add_u32 s34, s34, 44040192
    s_lshl_b32 s31, s20, 7
    s_add_u32 s35, s34, s31
    v_mov_b32 v136, 1073741824
    s_bitcmp1_b32 s3, 0
    s_cselect_b32 s30, 37888, 0
    v_add_u32 v40, s30, v39
    ds_read_b64_tr_b16 v[164:165], v40 offset:0
    ds_read_b64_tr_b16 v[166:167], v40 offset:4736
    ds_read_b64_tr_b16 v[152:153], v34 offset:0
    ds_read_b64_tr_b16 v[154:155], v34 offset:4736
    ds_read_b64_tr_b16 v[156:157], v35 offset:0
    ds_read_b64_tr_b16 v[158:159], v35 offset:4736
    ds_read_b64_tr_b16 v[160:161], v36 offset:0
    ds_read_b64_tr_b16 v[162:163], v36 offset:4736
    v_pk_mul_f32 v[74:75], v[74:75], v[10:11] op_sel:[0,1] op_sel_hi:[1,1]
    v_pk_mul_f32 v[76:77], v[76:77], v[10:11] op_sel:[0,1] op_sel_hi:[1,1]
    v_pk_mul_f32 v[78:79], v[78:79], v[10:11] op_sel:[0,1] op_sel_hi:[1,1]
    v_cvt_pk_bf16_f32 v148, v74, v75
    v_cvt_pk_bf16_f32 v149, v76, v77
    v_cvt_pk_bf16_f32 v150, v78, v79
    ds_write_b64 v33, v[148:149] offset:9520
    ds_write_b64 v33, v[150:151] offset:9528
    v_max3_f32 v132, v64, v65, v66
    v_max3_f32 v133, -v64, -v65, -v66
    v_max3_f32 v132, v132, v67, v68
    v_max3_f32 v133, v133, -v67, -v68
    v_max3_f32 v132, v132, v69, v70
    v_max3_f32 v133, v133, -v69, -v70
    v_max3_f32 v132, v132, v71, v72
    v_max3_f32 v133, v133, -v71, -v72
    v_max_f32 v132, v132, v73
    v_max_f32_e64 v133, v133, -v73
    s_nop 1
    v_permlane32_swap_b32 v132, v133
    v_max_f32 v132, v132, v133
    v_mul_f32_e64 v132, -v132, v5
    v_mov_b32 v133, v132
    s_nop 1
    v_permlane32_swap_b32 v132, v133
    v_pk_fma_f32 v[112:113], v[64:65], v[4:5], v[132:133] op_sel:[0,1,0] op_sel_hi:[1,1,0]
    v_pk_fma_f32 v[122:123], v[64:65], v[4:5], v[132:133] op_sel:[0,1,1] op_sel_hi:[1,1,1] neg_lo:[1,0,0] neg_hi:[1,0,0]
    v_pk_fma_f32 v[114:115], v[66:67], v[4:5], v[132:133] op_sel:[0,1,0] op_sel_hi:[1,1,0]
    v_pk_fma_f32 v[124:125], v[66:67], v[4:5], v[132:133] op_sel:[0,1,1] op_sel_hi:[1,1,1] neg_lo:[1,0,0] neg_hi:[1,0,0]
    v_exp_f32 v112, v112
    v_exp_f32 v122, v122
    v_exp_f32 v113, v113
    v_exp_f32 v123, v123
    v_exp_f32 v114, v114
    v_exp_f32 v124, v124
    v_exp_f32 v115, v115
    v_exp_f32 v125, v125
    v_pk_fma_f32 v[116:117], v[68:69], v[4:5], v[132:133] op_sel:[0,1,0] op_sel_hi:[1,1,0]
    v_pk_fma_f32 v[126:127], v[68:69], v[4:5], v[132:133] op_sel:[0,1,1] op_sel_hi:[1,1,1] neg_lo:[1,0,0] neg_hi:[1,0,0]
    v_pk_fma_f32 v[118:119], v[70:71], v[4:5], v[132:133] op_sel:[0,1,0] op_sel_hi:[1,1,0]
    v_pk_fma_f32 v[128:129], v[70:71], v[4:5], v[132:133] op_sel:[0,1,1] op_sel_hi:[1,1,1] neg_lo:[1,0,0] neg_hi:[1,0,0]
    v_exp_f32 v116, v116
    v_exp_f32 v126, v126
    v_exp_f32 v117, v117
    v_exp_f32 v127, v127
    v_exp_f32 v118, v118
    v_exp_f32 v128, v128
    v_exp_f32 v119, v119
    v_exp_f32 v129, v129
    v_pk_add_f32 v[138:139], v[112:113], v[114:115]
    v_pk_add_f32 v[140:141], v[122:123], v[124:125]
    v_pk_fma_f32 v[120:121], v[72:73], v[4:5], v[132:133] op_sel:[0,1,0] op_sel_hi:[1,1,0]
    v_pk_fma_f32 v[130:131], v[72:73], v[4:5], v[132:133] op_sel:[0,1,1] op_sel_hi:[1,1,1] neg_lo:[1,0,0] neg_hi:[1,0,0]
    v_exp_f32 v120, v120
    v_exp_f32 v130, v130
    v_exp_f32 v121, v121
    v_exp_f32 v131, v131
    v_pk_add_f32 v[138:139], v[138:139], v[116:117]
    v_pk_add_f32 v[140:141], v[140:141], v[126:127]
    v_pk_add_f32 v[138:139], v[138:139], v[118:119]
    v_pk_add_f32 v[140:141], v[140:141], v[128:129]
    v_pk_add_f32 v[138:139], v[138:139], v[120:121]
    v_pk_add_f32 v[140:141], v[140:141], v[130:131]
    v_add_f32 v134, v138, v139
    v_add_f32 v135, v140, v141
    s_nop 1
    v_permlane32_swap_b32 v134, v135
    v_add_f32 v134, v134, v135
    v_rcp_f32 v134, v134
    s_nop 0
    v_mov_b32 v135, v134
    s_nop 1
    v_permlane32_swap_b32 v134, v135
    v_pk_mul_f32 v[112:113], v[112:113], v[134:135] op_sel:[0,0] op_sel_hi:[1,0]
    v_pk_mul_f32 v[114:115], v[114:115], v[134:135] op_sel:[0,0] op_sel_hi:[1,0]
    v_pk_mul_f32 v[116:117], v[116:117], v[134:135] op_sel:[0,0] op_sel_hi:[1,0]
    v_pk_mul_f32 v[118:119], v[118:119], v[134:135] op_sel:[0,0] op_sel_hi:[1,0]
    v_pk_mul_f32 v[120:121], v[120:121], v[134:135] op_sel:[0,0] op_sel_hi:[1,0]
    v_cvt_pk_bf16_f32 v138, v112, v113
    v_cvt_pk_bf16_f32 v139, v114, v115
    ds_write_b64 v33, v[138:139] offset:9472
    v_cvt_pk_bf16_f32 v140, v116, v117
    v_cvt_pk_bf16_f32 v141, v118, v119
    ds_write_b64 v33, v[140:141] offset:9480
    v_cvt_pk_bf16_f32 v142, v120, v121
    v_pk_mul_f32 v[122:123], v[122:123], v[134:135] op_sel:[0,1] op_sel_hi:[1,1]
    v_pk_mul_f32 v[124:125], v[124:125], v[134:135] op_sel:[0,1] op_sel_hi:[1,1]
    v_pk_mul_f32 v[126:127], v[126:127], v[134:135] op_sel:[0,1] op_sel_hi:[1,1]
    v_pk_mul_f32 v[128:129], v[128:129], v[134:135] op_sel:[0,1] op_sel_hi:[1,1]
    v_pk_mul_f32 v[130:131], v[130:131], v[134:135] op_sel:[0,1] op_sel_hi:[1,1]
    v_cvt_pk_bf16_f32 v143, v122, v123
    ds_write_b64 v33, v[142:143] offset:9488
    v_cvt_pk_bf16_f32 v144, v124, v125
    v_cvt_pk_bf16_f32 v145, v126, v127
    ds_write_b64 v33, v[144:145] offset:9496
    v_cvt_pk_bf16_f32 v146, v128, v129
    v_cvt_pk_bf16_f32 v147, v130, v131
    ds_write_b64 v33, v[146:147] offset:9504
    s_waitcnt lgkmcnt(0)
    s_barrier
    ds_read_b64_tr_b16 v[92:93], v40 offset:9472
    ds_read_b64_tr_b16 v[94:95], v40 offset:14208
    ds_read_b64_tr_b16 v[80:81], v34 offset:9472
    ds_read_b64_tr_b16 v[82:83], v34 offset:14208
    ds_read_b64_tr_b16 v[84:85], v35 offset:9472
    ds_read_b64_tr_b16 v[86:87], v35 offset:14208
    ds_read_b64_tr_b16 v[88:89], v36 offset:9472
    ds_read_b64_tr_b16 v[90:91], v36 offset:14208
    v_mfma_f32_16x16x32_bf16 v[168:171], v[152:155], v[164:167], v[168:171]
    v_mfma_f32_16x16x32_bf16 v[172:175], v[156:159], v[164:167], v[172:175]
    v_mfma_f32_16x16x32_bf16 v[176:179], v[160:163], v[164:167], v[176:179]
    s_waitcnt lgkmcnt(0)
    v_mfma_f32_16x16x32_bf16 v[168:171], v[80:83], v[92:95], v[168:171]
    v_mfma_f32_16x16x32_bf16 v[172:175], v[84:87], v[92:95], v[172:175]
    v_mfma_f32_16x16x32_bf16 v[176:179], v[88:91], v[92:95], v[176:179]
    s_nop 5
    buffer_store_dwordx4 v[168:171], v188, s[8:11], s35 offen sc1
    buffer_store_dwordx4 v[172:175], v189, s[8:11], s35 offen sc1
    buffer_store_dwordx4 v[176:179], v190, s[8:11], s35 offen sc1
    s_add_u32 m0, s37, 138752
    s_nop 0
    buffer_load_dwordx4 v1, s[16:19], m0 offen lds
    s_add_u32 m0, s37, 142848
    s_nop 0
    buffer_load_dwordx4 v1, s[16:19], m0 offen lds
    s_add_u32 m0, s37, 146944
    s_nop 0
    buffer_load_dwordx4 v1, s[16:19], m0 offen lds
    s_add_u32 m0, s37, 151040
    s_nop 0
    buffer_load_dwordx4 v1, s[16:19], m0 offen lds
    s_add_u32 m0, s37, 155136
    s_nop 0
    buffer_load_dwordx4 v1, s[16:19], m0 offen lds
    ds_read_b64 v[80:81], v47 offset:0
    ds_read_b64 v[82:83], v47 offset:8
    ds_read_b64 v[84:85], v47 offset:16
    ds_read_b64 v[86:87], v47 offset:24
    ds_read_b64 v[88:89], v47 offset:32
    v_mov_b32 v90, 0
    v_mov_b32 v91, 0
    ds_read_b64 v[92:93], v47 offset:128
    ds_read_b64 v[94:95], v47 offset:136
    ds_read_b64 v[96:97], v47 offset:144
    ds_read_b64 v[98:99], v47 offset:152
    ds_read_b64 v[100:101], v47 offset:160
    v_mov_b32 v102, 0
    v_mov_b32 v103, 0
    s_lshl_b32 s30, s3, 4
    s_add_u32 s30, s30, s20
    s_lshl_b32 s31, s30, 11
    s_add_u32 s34, s34, s31
    s_lshl_b32 s35, s21, 13
    s_add_u32 s35, s35, 51380224
    s_lshl_b32 s31, s30, 7
    s_add_u32 s36, s35, s31
    v_and_b32 v132, 7, v0
    v_lshrrev_b32 v133, 5, v0
    v_lshlrev_b32 v132, 3, v132
    v_lshl_add_u32 v132, v133, 2, v132
    v_bfe_u32 v133, v0, 3, 2
    v_lshl_add_u32 v138, v133, 17, v132
    v_add_u32 v141, 524288, v138
    v_lshrrev_b32 v132, 2, v0
    v_and_b32 v133, 3, v0
    v_lshlrev_b32 v133, 4, v133
    v_lshl_add_u32 v132, v132, 7, v133
    v_cmp_gt_u32 vcc, 60, v0
    s_nop 1
    v_cndmask_b32 v139, v136, v132, vcc
    s_mul_i32 s31, s3, 960
    s_add_u32 s35, s35, s31
    s_add_u32 s35, s35, s31
    s_lshr_b32 s32, s20, 1
    s_lshl_b32 s32, s32, 17
    s_add_u32 s35, s35, s32
    v_add_u32 v132, s31, v1
    v_add_u32 v133, 0x1000, v1
    v_cndmask_b32 v140, v133, v132, vcc
    v_mov_b32 v122, 0
    v_mov_b32 v123, 0
    v_mov_b32 v134, 0
    v_mov_b32 v135, 0
    s_cmp_ge_u32 s30, 60
    s_cbranch_scc1 pk_nored21
    s_nop 4
    s_sleep 12
pk_poll22:
    buffer_load_dwordx4 v[56:59], v1, s[8:11], s34 offen sc1
    buffer_load_dwordx4 v[60:63], v1, s[8:11], s34 offen offset:1024 sc1
    s_waitcnt vmcnt(0)
    v_max3_u32 v132, v56, v57, v58
    v_max3_u32 v132, v132, v59, v60
    v_max3_u32 v132, v132, v61, v62
    v_max_u32 v132, v132, v63
    v_cmp_eq_u32 vcc, -1, v132
    s_sub_u32 s22, s22, 1
    s_cbranch_scc1 pk_go23
    s_mov_b64 exec, vcc
    s_cbranch_vccnz pk_poll22
pk_go23:
    s_mov_b64 exec, -1
    s_max_i32 s22, s22, 0
    v_add_f32 v48, v56, v60
    v_add_f32 v49, v57, v61
    v_add_f32 v50, v58, v62
    v_add_f32 v51, v59, v63
    s_nop 0
    v_permlane32_swap_b32 v48, v50
    v_permlane32_swap_b32 v49, v51
    v_add_f32 v48, v48, v50
    v_add_f32 v49, v49, v51
    s_nop 0
    v_add_f32_dpp v50, v48, v48 row_ror:8 row_mask:0xf bank_mask:0xf
    v_add_f32_dpp v51, v49, v49 row_ror:8 row_mask:0xf bank_mask:0xf
    v_mov_b32 v48, v50
    v_mov_b32 v49, v51
    s_nop 0
    v_permlane16_swap_b32 v48, v50
    v_permlane16_swap_b32 v49, v51
    v_add_f32 v48, v48, v50
    v_add_f32 v49, v49, v51
    v_cvt_pk_bf16_f32 v48, v48, v49
    buffer_store_dword v48, v138, s[8:11], s36 offen sc1
    buffer_store_dword v48, v141, s[8:11], s36 offen sc1
pk_nored21:
    s_barrier
    v_lshrrev_b32 v136, 3, v0
    v_and_b32 v137, 7, v0
    v_lshlrev_b32 v136, 11, v136
    v_lshl_add_u32 v136, v137, 4, v136
    s_mul_i32 s30, s21, 131072
    s_lshl_b32 s31, s20, 7
    s_add_u32 s30, s30, s31
    s_lshl_b32 s31, s3, 15
    s_add_u32 s30, s30, s31
    s_add_u32 s30, s30, 48234496
    buffer_store_dwordx4 v[184:187], v136, s[8:11], s30 offen sc1
    s_add_u32 s30, s30, 16384
    buffer_store_dwordx4 v[184:187], v136, s[8:11], s30 offen sc1
    v_lshrrev_b32 v136, 3, v0
    v_lshlrev_b32 v136, 17, v136
    v_lshl_add_u32 v136, v137, 4, v136
    s_lshl_b32 s30, s21, 13
    s_lshl_b32 s31, s20, 7
    s_add_u32 s30, s30, s31
    s_add_u32 s30, s30, s25
    s_add_u32 s30, s30, 53477376
    buffer_store_dwordx4 v[184:187], v136, s[8:11], s30 offen sc1
    s_nop 4
    s_sleep 14
pk_poll24:
    buffer_load_dwordx4 v[108:111], v139, s[8:11], s35 offen sc1
    s_waitcnt vmcnt(0)
    v_max3_u32 v132, v108, v109, v110
    v_max_u32 v132, v132, v111
    v_cmp_eq_u32 vcc, -1, v132
    s_sub_u32 s22, s22, 1
    s_cbranch_scc1 pk_go25
    s_mov_b64 exec, vcc
    s_cbranch_vccnz pk_poll24
pk_go25:
    s_mov_b64 exec, -1
    s_max_i32 s22, s22, 0
    ds_write_b128 v140, v[108:111]
    v_bfe_u32 v132, v0, 4, 1
    v_mul_u32_u24 v132, 20480, v132
    v_and_b32 v133, 15, v0
    v_lshl_add_u32 v132, v133, 4, v132
    v_lshrrev_b32 v133, 5, v0
    v_lshl_add_u32 v138, v133, 8, v132
    v_lshl_add_u32 v139, v133, 3, v132
    s_waitcnt lgkmcnt(0)
    s_barrier
    ds_read_b64 v[112:113], v46 offset:0
    ds_read_b64 v[114:115], v46 offset:64
    ds_read_b64 v[116:117], v46 offset:128
    ds_read_b64 v[118:119], v46 offset:192
    ds_read_b64 v[120:121], v46 offset:256
    ds_read_b64 v[124:125], v46 offset:1920
    ds_read_b64 v[126:127], v46 offset:1984
    ds_read_b64 v[128:129], v46 offset:2048
    ds_read_b64 v[130:131], v46 offset:2112
    ds_read_b64 v[132:133], v46 offset:2176
    s_lshl_b32 s30, s20, 2
    s_add_u32 s30, s30, s3
    s_mul_i32 s31, s30, 40960
    s_mul_i32 s32, s21, 1280
    s_add_u32 s31, s31, s32
    s_add_u32 s31, s31, 17825792
    s_lshl_b32 s30, s30, 11
    s_lshl_b32 s32, s21, 7
    s_add_u32 s30, s30, s32
    s_add_u32 s30, s30, 29491200
    v_mov_b32 v188, 1
    s_waitcnt lgkmcnt(8)
    v_mfma_f32_32x32x16_bf16 v[48:63], v[112:115], v[80:83], 0
    s_waitcnt lgkmcnt(3)
    v_mfma_f32_32x32x16_bf16 v[64:79], v[124:127], v[92:95], 0
    v_mfma_f32_32x32x16_bf16 v[48:63], v[116:119], v[84:87], v[48:63]
    s_waitcnt lgkmcnt(1)
    v_mfma_f32_32x32x16_bf16 v[64:79], v[128:131], v[96:99], v[64:79]
    v_mfma_f32_32x32x16_bf16 v[48:63], v[120:123], v[88:91], v[48:63]
    s_waitcnt lgkmcnt(0)
    v_mfma_f32_32x32x16_bf16 v[64:79], v[132:135], v[100:103], v[64:79]
    s_nop 7
    s_nop 1
    v_add_f32 v58, s24, v58
    v_rcp_f32 v58, v58
    s_nop 0
    v_mov_b32 v59, v58
    v_pk_mul_f32 v[48:49], v[48:49], v[58:59]
    v_pk_mul_f32 v[50:51], v[50:51], v[58:59]
    v_pk_mul_f32 v[52:53], v[52:53], v[58:59]
    v_pk_mul_f32 v[54:55], v[54:55], v[58:59]
    v_pk_mul_f32 v[56:57], v[56:57], v[58:59]
    v_cvt_pk_bf16_f32 v140, v48, v49
    v_cvt_pk_bf16_f32 v141, v50, v51
    v_cvt_pk_bf16_f32 v142, v52, v53
    v_cvt_pk_bf16_f32 v143, v54, v55
    v_cvt_pk_bf16_f32 v148, v56, v57
    v_add_f32 v74, s24, v74
    v_rcp_f32 v74, v74
    s_nop 0
    v_mov_b32 v75, v74
    v_pk_mul_f32 v[64:65], v[64:65], v[74:75]
    v_pk_mul_f32 v[66:67], v[66:67], v[74:75]
    v_pk_mul_f32 v[68:69], v[68:69], v[74:75]
    v_pk_mul_f32 v[70:71], v[70:71], v[74:75]
    v_pk_mul_f32 v[72:73], v[72:73], v[74:75]
    v_cvt_pk_bf16_f32 v144, v64, v65
    v_cvt_pk_bf16_f32 v145, v66, v67
    v_cvt_pk_bf16_f32 v146, v68, v69
    v_cvt_pk_bf16_f32 v147, v70, v71
    v_cvt_pk_bf16_f32 v149, v72, v73
    s_cmp_eq_u32 s23, 0
    s_cbranch_scc1 pk_slow26
    buffer_store_dwordx4 v[140:143], v138, s[8:11], s31 offen
    buffer_store_dwordx4 v[144:147], v138, s[8:11], s31 offen offset:512
    buffer_store_dwordx2 v[148:149], v139, s[8:11], s31 offen offset:1024
    s_branch pk_join27
pk_slow26:
    buffer_store_dwordx4 v[140:143], v138, s[8:11], s31 offen sc1
    buffer_store_dwordx4 v[144:147], v138, s[8:11], s31 offen offset:512 sc1
    buffer_store_dwordx2 v[148:149], v139, s[8:11], s31 offen offset:1024 sc1
    s_nop 0
pk_join27:
    v_lshlrev_b32 v168, 16, v20
    v_and_b32 v169, 0xffff0000, v20
    v_lshlrev_b32 v170, 16, v21
    v_and_b32 v171, 0xffff0000, v21
    v_lshlrev_b32 v172, 16, v22
    v_and_b32 v173, 0xffff0000, v22
    v_lshlrev_b32 v174, 16, v23
    v_and_b32 v175, 0xffff0000, v23
    v_lshlrev_b32 v176, 16, v24
    v_and_b32 v177, 0xffff0000, v24
    v_lshlrev_b32 v178, 16, v25
    v_and_b32 v179, 0xffff0000, v25
    v_lshlrev_b32 v180, 16, v26
    v_and_b32 v181, 0xffff0000, v26
    v_lshlrev_b32 v182, 16, v27
    v_and_b32 v183, 0xffff0000, v27
    v_lshlrev_b32 v184, 16, v28
    v_and_b32 v185, 0xffff0000, v28
    v_lshlrev_b32 v186, 16, v29
    v_and_b32 v187, 0xffff0000, v29
    v_and_b32 v6, 15, v0
    v_lshlrev_b32 v6, 7, v6
    s_lshr_b32 s32, s27, 1
    s_lshl_b32 s32, s32, 11
    s_add_u32 s32, s32, 29491200
    s_mul_i32 s33, s27, 20480
    s_add_u32 s33, s33, 17825792
    s_waitcnt vmcnt(0)
    s_mov_b64 exec, 1
    s_cmp_eq_u32 s23, 0
    s_cbranch_scc1 pk_slow29
    buffer_store_dword v188, off, s[8:11], s30
    s_branch pk_join30
pk_slow29:
    buffer_store_dword v188, off, s[8:11], s30 sc1
    s_nop 0
pk_join30:
    s_mov_b64 exec, -1
    ds_read_b128 v[128:131], v1 offset:56832
    ds_read_b128 v[132:135], v1 offset:57856
    ds_read_b128 v[136:139], v1 offset:58880
    ds_read_b128 v[140:143], v1 offset:59904
    ds_read_b128 v[144:147], v1 offset:60928
    ds_read_b128 v[148:151], v1 offset:61952
    ds_read_b128 v[152:155], v1 offset:62976
    ds_read_b128 v[156:159], v1 offset:64000
    ds_read_b128 v[160:163], v1 offset:65024
    s_nop 4
pk_poll31:
    buffer_load_dword v189, v6, s[8:11], s32 offen sc1
    s_waitcnt vmcnt(0)
    v_cmp_ne_u32 vcc, 1, v189
    s_sub_u32 s22, s22, 1
    s_cbranch_scc1 pk_go32
    s_mov_b64 exec, vcc
    s_cbranch_vccnz pk_poll31
pk_go32:
    s_mov_b64 exec, -1
    s_max_i32 s22, s22, 0
    buffer_load_dwordx4 v[48:51], v1, s[8:11], s33 offen offset:0 sc1
    buffer_load_dwordx4 v[52:55], v1, s[8:11], s33 offen offset:1024 sc1
    buffer_load_dwordx4 v[56:59], v1, s[8:11], s33 offen offset:2048 sc1
    buffer_load_dwordx4 v[60:63], v1, s[8:11], s33 offen offset:3072 sc1
    s_add_u32 s33, s33, 4096
    buffer_load_dwordx4 v[64:67], v1, s[8:11], s33 offen offset:0 sc1
    buffer_load_dwordx4 v[68:71], v1, s[8:11], s33 offen offset:1024 sc1
    buffer_load_dwordx4 v[72:75], v1, s[8:11], s33 offen offset:2048 sc1
    buffer_load_dwordx4 v[76:79], v1, s[8:11], s33 offen offset:3072 sc1
    s_add_u32 s33, s33, 4096
    buffer_load_dwordx4 v[80:83], v1, s[8:11], s33 offen offset:0 sc1
    buffer_load_dwordx4 v[84:87], v1, s[8:11], s33 offen offset:1024 sc1
    buffer_load_dwordx4 v[88:91], v1, s[8:11], s33 offen offset:2048 sc1
    buffer_load_dwordx4 v[92:95], v1, s[8:11], s33 offen offset:3072 sc1
    s_add_u32 s33, s33, 4096
    buffer_load_dwordx4 v[96:99], v1, s[8:11], s33 offen offset:0 sc1
    buffer_load_dwordx4 v[100:103], v1, s[8:11], s33 offen offset:1024 sc1
    buffer_load_dwordx4 v[104:107], v1, s[8:11], s33 offen offset:2048 sc1
    buffer_load_dwordx4 v[108:111], v1, s[8:11], s33 offen offset:3072 sc1
    s_add_u32 s33, s33, 4096
    buffer_load_dwordx4 v[112:115], v1, s[8:11], s33 offen offset:0 sc1
    buffer_load_dwordx4 v[116:119], v1, s[8:11], s33 offen offset:1024 sc1
    buffer_load_dwordx4 v[120:123], v1, s[8:11], s33 offen offset:2048 sc1
    buffer_load_dwordx4 v[124:127], v1, s[8:11], s33 offen offset:3072 sc1
    s_bfe_u32 s30, s27, 0x20001
    s_mul_i32 s30, s30, 40960
    s_mul_i32 s31, s28, 5120
    s_lshl_b32 s32, s29, 12
    s_sub_u32 s31, s31, s32
    s_add_u32 s32, s31, 40960
    s_min_u32 s31, s31, s32
    v_add_u32 v2, s31, v43
    v_add_u32 v3, 0x800, v2
    v_add_u32 v4, s31, v44
    v_subrev_u32 v6, 40960, v2
    v_min_u32 v2, v2, v6
    v_subrev_u32 v6, 40960, v3
    v_min_u32 v3, v3, v6
    v_subrev_u32 v6, 40960, v4
    v_min_u32 v4, v4, v6
    s_lshl_b32 s31, s27, 10
    s_lshl_b32 s32, s28, 7
    s_add_u32 s31, s31, s32
    s_add_u32 s31, s31, 29360128
    v_lshlrev_b32 v6, 3, v0
    s_waitcnt vmcnt(19)
    ds_read_b128 v[164:167], v30 offset:512
    s_waitcnt lgkmcnt(9)
    v_mfma_f32_16x16x32_bf16 v[168:171], v[128:131], v[48:51], v[168:171]
    ds_read_b128 v[128:131], v30 offset:1536
    s_waitcnt lgkmcnt(9)
    v_mfma_f32_16x16x32_bf16 v[172:175], v[132:135], v[48:51], v[172:175]
    ds_read_b128 v[132:135], v30 offset:2560
    s_waitcnt lgkmcnt(9)
    v_mfma_f32_16x16x32_bf16 v[176:179], v[136:139], v[48:51], v[176:179]
    ds_read_b128 v[136:139], v30 offset:3584
    s_waitcnt lgkmcnt(9)
    v_mfma_f32_16x16x32_bf16 v[180:183], v[140:143], v[48:51], v[180:183]
    ds_read_b128 v[140:143], v30 offset:4608
    s_waitcnt lgkmcnt(9)
    v_mfma_f32_16x16x32_bf16 v[184:187], v[144:147], v[48:51], v[184:187]
    s_waitcnt vmcnt(18)
    ds_read_b128 v[144:147], v30 offset:5632
    s_waitcnt lgkmcnt(9)
    v_mfma_f32_16x16x32_bf16 v[168:171], v[148:151], v[52:55], v[168:171]
    ds_read_b128 v[148:151], v30 offset:6656
    s_waitcnt lgkmcnt(9)
    v_mfma_f32_16x16x32_bf16 v[172:175], v[152:155], v[52:55], v[172:175]
    ds_read_b128 v[152:155], v30 offset:7680
    s_waitcnt lgkmcnt(9)
    v_mfma_f32_16x16x32_bf16 v[176:179], v[156:159], v[52:55], v[176:179]
    ds_read_b128 v[156:159], v30 offset:8704
    s_waitcnt lgkmcnt(9)
    v_mfma_f32_16x16x32_bf16 v[180:183], v[160:163], v[52:55], v[180:183]
    ds_read_b128 v[160:163], v30 offset:9728
    s_waitcnt lgkmcnt(9)
    v_mfma_f32_16x16x32_bf16 v[184:187], v[164:167], v[52:55], v[184:187]
    s_waitcnt vmcnt(17)
    ds_read_b128 v[164:167], v30 offset:10752
    s_waitcnt lgkmcnt(9)
    v_mfma_f32_16x16x32_bf16 v[168:171], v[128:131], v[56:59], v[168:171]
    ds_read_b128 v[128:131], v30 offset:11776
    s_waitcnt lgkmcnt(9)
    v_mfma_f32_16x16x32_bf16 v[172:175], v[132:135], v[56:59], v[172:175]
    ds_read_b128 v[132:135], v30 offset:12800
    s_waitcnt lgkmcnt(9)
    v_mfma_f32_16x16x32_bf16 v[176:179], v[136:139], v[56:59], v[176:179]
    ds_read_b128 v[136:139], v30 offset:13824
    s_waitcnt lgkmcnt(9)
    v_mfma_f32_16x16x32_bf16 v[180:183], v[140:143], v[56:59], v[180:183]
    ds_read_b128 v[140:143], v30 offset:14848
    s_waitcnt lgkmcnt(9)
    v_mfma_f32_16x16x32_bf16 v[184:187], v[144:147], v[56:59], v[184:187]
    s_waitcnt vmcnt(16)
    ds_read_b128 v[144:147], v30 offset:15872
    s_waitcnt lgkmcnt(9)
    v_mfma_f32_16x16x32_bf16 v[168:171], v[148:151], v[60:63], v[168:171]
    ds_read_b128 v[148:151], v30 offset:16896
    s_waitcnt lgkmcnt(9)
    v_mfma_f32_16x16x32_bf16 v[172:175], v[152:155], v[60:63], v[172:175]
    ds_read_b128 v[152:155], v30 offset:17920
    s_waitcnt lgkmcnt(9)
    v_mfma_f32_16x16x32_bf16 v[176:179], v[156:159], v[60:63], v[176:179]
    ds_read_b128 v[156:159], v30 offset:18944
    s_waitcnt lgkmcnt(9)
    v_mfma_f32_16x16x32_bf16 v[180:183], v[160:163], v[60:63], v[180:183]
    ds_read_b128 v[160:163], v30 offset:19968
    s_waitcnt lgkmcnt(9)
    v_mfma_f32_16x16x32_bf16 v[184:187], v[164:167], v[60:63], v[184:187]
    s_waitcnt vmcnt(15)
    ds_read_b128 v[164:167], v30 offset:20992
    s_waitcnt lgkmcnt(9)
    v_mfma_f32_16x16x32_bf16 v[168:171], v[128:131], v[64:67], v[168:171]
    ds_read_b128 v[128:131], v30 offset:22016
    s_waitcnt lgkmcnt(9)
    v_mfma_f32_16x16x32_bf16 v[172:175], v[132:135], v[64:67], v[172:175]
    ds_read_b128 v[132:135], v30 offset:23040
    s_waitcnt lgkmcnt(9)
    v_mfma_f32_16x16x32_bf16 v[176:179], v[136:139], v[64:67], v[176:179]
    ds_read_b128 v[136:139], v30 offset:24064
    s_waitcnt lgkmcnt(9)
    v_mfma_f32_16x16x32_bf16 v[180:183], v[140:143], v[64:67], v[180:183]
    ds_read_b128 v[140:143], v30 offset:25088
    s_waitcnt lgkmcnt(9)
    v_mfma_f32_16x16x32_bf16 v[184:187], v[144:147], v[64:67], v[184:187]
    s_waitcnt vmcnt(14)
    ds_read_b128 v[144:147], v30 offset:26112
    s_waitcnt lgkmcnt(9)
    v_mfma_f32_16x16x32_bf16 v[168:171], v[148:151], v[68:71], v[168:171]
    ds_read_b128 v[148:151], v30 offset:27136
    s_waitcnt lgkmcnt(9)
    v_mfma_f32_16x16x32_bf16 v[172:175], v[152:155], v[68:71], v[172:175]
    ds_read_b128 v[152:155], v30 offset:28160
    s_waitcnt lgkmcnt(9)
    v_mfma_f32_16x16x32_bf16 v[176:179], v[156:159], v[68:71], v[176:179]
    ds_read_b128 v[156:159], v30 offset:29184
    s_waitcnt lgkmcnt(9)
    v_mfma_f32_16x16x32_bf16 v[180:183], v[160:163], v[68:71], v[180:183]
    ds_read_b128 v[160:163], v30 offset:30208
    s_waitcnt lgkmcnt(9)
    v_mfma_f32_16x16x32_bf16 v[184:187], v[164:167], v[68:71], v[184:187]
    s_waitcnt vmcnt(13)
    ds_read_b128 v[164:167], v30 offset:31232
    s_waitcnt lgkmcnt(9)
    v_mfma_f32_16x16x32_bf16 v[168:171], v[128:131], v[72:75], v[168:171]
    ds_read_b128 v[128:131], v30 offset:32256
    s_waitcnt lgkmcnt(9)
    v_mfma_f32_16x16x32_bf16 v[172:175], v[132:135], v[72:75], v[172:175]
    ds_read_b128 v[132:135], v30 offset:33280
    s_waitcnt lgkmcnt(9)
    v_mfma_f32_16x16x32_bf16 v[176:179], v[136:139], v[72:75], v[176:179]
    ds_read_b128 v[136:139], v30 offset:34304
    s_waitcnt lgkmcnt(9)
    v_mfma_f32_16x16x32_bf16 v[180:183], v[140:143], v[72:75], v[180:183]
    ds_read_b128 v[140:143], v30 offset:35328
    s_waitcnt lgkmcnt(9)
    v_mfma_f32_16x16x32_bf16 v[184:187], v[144:147], v[72:75], v[184:187]
    s_waitcnt vmcnt(12)
    ds_read_b128 v[144:147], v30 offset:36352
    s_waitcnt lgkmcnt(9)
    v_mfma_f32_16x16x32_bf16 v[168:171], v[148:151], v[76:79], v[168:171]
    ds_read_b128 v[148:151], v30 offset:37376
    s_waitcnt lgkmcnt(9)
    v_mfma_f32_16x16x32_bf16 v[172:175], v[152:155], v[76:79], v[172:175]
    ds_read_b128 v[152:155], v30 offset:38400
    s_waitcnt lgkmcnt(9)
    v_mfma_f32_16x16x32_bf16 v[176:179], v[156:159], v[76:79], v[176:179]
    ds_read_b128 v[156:159], v30 offset:39424
    s_waitcnt lgkmcnt(9)
    v_mfma_f32_16x16x32_bf16 v[180:183], v[160:163], v[76:79], v[180:183]
    ds_read_b128 v[160:163], v30 offset:40448
    s_waitcnt lgkmcnt(9)
    v_mfma_f32_16x16x32_bf16 v[184:187], v[164:167], v[76:79], v[184:187]
    s_waitcnt vmcnt(11)
    ds_read_b128 v[164:167], v30 offset:41472
    s_waitcnt lgkmcnt(9)
    v_mfma_f32_16x16x32_bf16 v[168:171], v[128:131], v[80:83], v[168:171]
    ds_read_b128 v[128:131], v30 offset:42496
    s_waitcnt lgkmcnt(9)
    v_mfma_f32_16x16x32_bf16 v[172:175], v[132:135], v[80:83], v[172:175]
    ds_read_b128 v[132:135], v30 offset:43520
    s_waitcnt lgkmcnt(9)
    v_mfma_f32_16x16x32_bf16 v[176:179], v[136:139], v[80:83], v[176:179]
    ds_read_b128 v[136:139], v30 offset:44544
    s_waitcnt lgkmcnt(9)
    v_mfma_f32_16x16x32_bf16 v[180:183], v[140:143], v[80:83], v[180:183]
    ds_read_b128 v[140:143], v30 offset:45568
    s_waitcnt lgkmcnt(9)
    v_mfma_f32_16x16x32_bf16 v[184:187], v[144:147], v[80:83], v[184:187]
    s_waitcnt vmcnt(10)
    ds_read_b128 v[144:147], v30 offset:46592
    s_waitcnt lgkmcnt(9)
    v_mfma_f32_16x16x32_bf16 v[168:171], v[148:151], v[84:87], v[168:171]
    ds_read_b128 v[148:151], v30 offset:47616
    s_waitcnt lgkmcnt(9)
    v_mfma_f32_16x16x32_bf16 v[172:175], v[152:155], v[84:87], v[172:175]
    ds_read_b128 v[152:155], v30 offset:48640
    s_waitcnt lgkmcnt(9)
    v_mfma_f32_16x16x32_bf16 v[176:179], v[156:159], v[84:87], v[176:179]
    ds_read_b128 v[156:159], v30 offset:49664
    s_waitcnt lgkmcnt(9)
    v_mfma_f32_16x16x32_bf16 v[180:183], v[160:163], v[84:87], v[180:183]
    ds_read_b128 v[160:163], v30 offset:50688
    s_waitcnt lgkmcnt(9)
    v_mfma_f32_16x16x32_bf16 v[184:187], v[164:167], v[84:87], v[184:187]
    s_waitcnt vmcnt(9)
    ds_read_b128 v[164:167], v30 offset:51712
    s_waitcnt lgkmcnt(9)
    v_mfma_f32_16x16x32_bf16 v[168:171], v[128:131], v[88:91], v[168:171]
    ds_read_b128 v[128:131], v30 offset:52736
    s_waitcnt lgkmcnt(9)
    v_mfma_f32_16x16x32_bf16 v[172:175], v[132:135], v[88:91], v[172:175]
    ds_read_b128 v[132:135], v30 offset:53760
    s_waitcnt lgkmcnt(9)
    v_mfma_f32_16x16x32_bf16 v[176:179], v[136:139], v[88:91], v[176:179]
    ds_read_b128 v[136:139], v30 offset:54784
    s_waitcnt lgkmcnt(9)
    v_mfma_f32_16x16x32_bf16 v[180:183], v[140:143], v[88:91], v[180:183]
    ds_read_b128 v[140:143], v30 offset:55808
    s_waitcnt lgkmcnt(9)
    v_mfma_f32_16x16x32_bf16 v[184:187], v[144:147], v[88:91], v[184:187]
    s_waitcnt vmcnt(8)
    ds_read_b128 v[144:147], v30 offset:56832
    s_waitcnt lgkmcnt(9)
    v_mfma_f32_16x16x32_bf16 v[168:171], v[148:151], v[92:95], v[168:171]
    ds_read_b128 v[148:151], v30 offset:57856
    s_waitcnt lgkmcnt(9)
    v_mfma_f32_16x16x32_bf16 v[172:175], v[152:155], v[92:95], v[172:175]
    ds_read_b128 v[152:155], v30 offset:58880
    s_waitcnt lgkmcnt(9)
    v_mfma_f32_16x16x32_bf16 v[176:179], v[156:159], v[92:95], v[176:179]
    ds_read_b128 v[156:159], v30 offset:59904
    s_waitcnt lgkmcnt(9)
    v_mfma_f32_16x16x32_bf16 v[180:183], v[160:163], v[92:95], v[180:183]
    ds_read_b128 v[160:163], v30 offset:60928
    s_waitcnt lgkmcnt(9)
    v_mfma_f32_16x16x32_bf16 v[184:187], v[164:167], v[92:95], v[184:187]
    s_waitcnt vmcnt(7)
    ds_read_b128 v[164:167], v30 offset:61952
    s_waitcnt lgkmcnt(9)
    v_mfma_f32_16x16x32_bf16 v[168:171], v[128:131], v[96:99], v[168:171]
    ds_read_b128 v[128:131], v30 offset:62976
    s_waitcnt lgkmcnt(9)
    v_mfma_f32_16x16x32_bf16 v[172:175], v[132:135], v[96:99], v[172:175]
    ds_read_b128 v[132:135], v30 offset:64000
    s_waitcnt lgkmcnt(9)
    v_mfma_f32_16x16x32_bf16 v[176:179], v[136:139], v[96:99], v[176:179]
    ds_read_b128 v[136:139], v30 offset:65024
    s_waitcnt lgkmcnt(9)
    v_mfma_f32_16x16x32_bf16 v[180:183], v[140:143], v[96:99], v[180:183]
    ds_read_b128 v[140:143], v31 offset:512
    s_waitcnt lgkmcnt(9)
    v_mfma_f32_16x16x32_bf16 v[184:187], v[144:147], v[96:99], v[184:187]
    s_waitcnt vmcnt(6)
    ds_read_b128 v[144:147], v31 offset:1536
    s_waitcnt lgkmcnt(9)
    v_mfma_f32_16x16x32_bf16 v[168:171], v[148:151], v[100:103], v[168:171]
    ds_read_b128 v[148:151], v31 offset:2560
    s_waitcnt lgkmcnt(9)
    v_mfma_f32_16x16x32_bf16 v[172:175], v[152:155], v[100:103], v[172:175]
    ds_read_b128 v[152:155], v31 offset:3584
    s_waitcnt lgkmcnt(9)
    v_mfma_f32_16x16x32_bf16 v[176:179], v[156:159], v[100:103], v[176:179]
    ds_read_b128 v[156:159], v31 offset:4608
    s_waitcnt lgkmcnt(9)
    v_mfma_f32_16x16x32_bf16 v[180:183], v[160:163], v[100:103], v[180:183]
    ds_read_b128 v[160:163], v31 offset:5632
    s_waitcnt lgkmcnt(9)
    v_mfma_f32_16x16x32_bf16 v[184:187], v[164:167], v[100:103], v[184:187]
    s_waitcnt vmcnt(5)
    ds_read_b128 v[164:167], v31 offset:6656
    s_waitcnt lgkmcnt(9)
    v_mfma_f32_16x16x32_bf16 v[168:171], v[128:131], v[104:107], v[168:171]
    ds_read_b128 v[128:131], v31 offset:7680
    s_waitcnt lgkmcnt(9)
    v_mfma_f32_16x16x32_bf16 v[172:175], v[132:135], v[104:107], v[172:175]
    ds_read_b128 v[132:135], v31 offset:8704
    s_waitcnt lgkmcnt(9)
    v_mfma_f32_16x16x32_bf16 v[176:179], v[136:139], v[104:107], v[176:179]
    ds_read_b128 v[136:139], v31 offset:9728
    s_waitcnt lgkmcnt(9)
    v_mfma_f32_16x16x32_bf16 v[180:183], v[140:143], v[104:107], v[180:183]
    ds_read_b128 v[140:143], v31 offset:10752
    s_waitcnt lgkmcnt(9)
    v_mfma_f32_16x16x32_bf16 v[184:187], v[144:147], v[104:107], v[184:187]
    s_waitcnt vmcnt(4)
    ds_read_b128 v[144:147], v31 offset:11776
    s_waitcnt lgkmcnt(9)
    v_mfma_f32_16x16x32_bf16 v[168:171], v[148:151], v[108:111], v[168:171]
    ds_read_b128 v[148:151], v31 offset:12800
    s_waitcnt lgkmcnt(9)
    v_mfma_f32_16x16x32_bf16 v[172:175], v[152:155], v[108:111], v[172:175]
    ds_read_b128 v[152:155], v31 offset:13824
    s_waitcnt lgkmcnt(9)
    v_mfma_f32_16x16x32_bf16 v[176:179], v[156:159], v[108:111], v[176:179]
    ds_read_b128 v[156:159], v31 offset:14848
    s_waitcnt lgkmcnt(9)
    v_mfma_f32_16x16x32_bf16 v[180:183], v[160:163], v[108:111], v[180:183]
    ds_read_b128 v[160:163], v31 offset:15872
    s_waitcnt lgkmcnt(9)
    v_mfma_f32_16x16x32_bf16 v[184:187], v[164:167], v[108:111], v[184:187]
    s_waitcnt vmcnt(3)
    ds_read_b128 v[164:167], v31 offset:16896
    s_waitcnt lgkmcnt(9)
    v_mfma_f32_16x16x32_bf16 v[168:171], v[128:131], v[112:115], v[168:171]
    ds_read_b128 v[128:131], v31 offset:17920
    s_waitcnt lgkmcnt(9)
    v_mfma_f32_16x16x32_bf16 v[172:175], v[132:135], v[112:115], v[172:175]
    ds_read_b128 v[132:135], v31 offset:18944
    s_waitcnt lgkmcnt(9)
    v_mfma_f32_16x16x32_bf16 v[176:179], v[136:139], v[112:115], v[176:179]
    ds_read_b128 v[136:139], v31 offset:19968
    s_waitcnt lgkmcnt(9)
    v_mfma_f32_16x16x32_bf16 v[180:183], v[140:143], v[112:115], v[180:183]
    ds_read_b128 v[140:143], v31 offset:20992
    s_waitcnt lgkmcnt(9)
    v_mfma_f32_16x16x32_bf16 v[184:187], v[144:147], v[112:115], v[184:187]
    s_waitcnt vmcnt(2)
    ds_read_b128 v[144:147], v31 offset:22016
    s_waitcnt lgkmcnt(9)
    v_mfma_f32_16x16x32_bf16 v[168:171], v[148:151], v[116:119], v[168:171]
    ds_read_b128 v[148:151], v31 offset:23040
    s_waitcnt lgkmcnt(9)
    v_mfma_f32_16x16x32_bf16 v[172:175], v[152:155], v[116:119], v[172:175]
    ds_read_b128 v[152:155], v31 offset:24064
    s_waitcnt lgkmcnt(9)
    v_mfma_f32_16x16x32_bf16 v[176:179], v[156:159], v[116:119], v[176:179]
    ds_read_b128 v[156:159], v31 offset:25088
    s_waitcnt lgkmcnt(9)
    v_mfma_f32_16x16x32_bf16 v[180:183], v[160:163], v[116:119], v[180:183]
    ds_read_b128 v[160:163], v31 offset:26112
    s_waitcnt lgkmcnt(9)
    v_mfma_f32_16x16x32_bf16 v[184:187], v[164:167], v[116:119], v[184:187]
    s_waitcnt vmcnt(1)
    ds_read_b128 v[164:167], v31 offset:27136
    s_waitcnt lgkmcnt(9)
    v_mfma_f32_16x16x32_bf16 v[168:171], v[128:131], v[120:123], v[168:171]
    s_waitcnt lgkmcnt(8)
    v_mfma_f32_16x16x32_bf16 v[172:175], v[132:135], v[120:123], v[172:175]
    s_waitcnt lgkmcnt(7)
    v_mfma_f32_16x16x32_bf16 v[176:179], v[136:139], v[120:123], v[176:179]
    s_waitcnt lgkmcnt(6)
    v_mfma_f32_16x16x32_bf16 v[180:183], v[140:143], v[120:123], v[180:183]
    s_waitcnt lgkmcnt(5)
    v_mfma_f32_16x16x32_bf16 v[184:187], v[144:147], v[120:123], v[184:187]
    s_waitcnt vmcnt(0)
    s_waitcnt lgkmcnt(4)
    v_mfma_f32_16x16x32_bf16 v[168:171], v[148:151], v[124:127], v[168:171]
    s_waitcnt lgkmcnt(3)
    v_mfma_f32_16x16x32_bf16 v[172:175], v[152:155], v[124:127], v[172:175]
    s_waitcnt lgkmcnt(2)
    v_mfma_f32_16x16x32_bf16 v[176:179], v[156:159], v[124:127], v[176:179]
    s_waitcnt lgkmcnt(1)
    v_mfma_f32_16x16x32_bf16 v[180:183], v[160:163], v[124:127], v[180:183]
    s_waitcnt lgkmcnt(0)
    v_mfma_f32_16x16x32_bf16 v[184:187], v[164:167], v[124:127], v[184:187]
    v_cvt_pk_bf16_f32 v20, v168, v169
    v_cvt_pk_bf16_f32 v21, v170, v171
    v_cvt_pk_bf16_f32 v22, v172, v173
    v_cvt_pk_bf16_f32 v23, v174, v175
    v_cvt_pk_bf16_f32 v24, v176, v177
    v_cvt_pk_bf16_f32 v25, v178, v179
    v_cvt_pk_bf16_f32 v26, v180, v181
    v_cvt_pk_bf16_f32 v27, v182, v183
    v_cvt_pk_bf16_f32 v28, v184, v185
    v_cvt_pk_bf16_f32 v29, v186, v187
    s_cmp_eq_u32 s23, 0
    s_cbranch_scc1 pk_slow33
    buffer_store_dwordx4 v[20:23], v2, s[12:15], s30 offen
    buffer_store_dwordx4 v[24:27], v3, s[12:15], s30 offen offset:0
    buffer_store_dwordx2 v[28:29], v4, s[12:15], s30 offen
    s_branch pk_join34
pk_slow33:
    buffer_store_dwordx4 v[20:23], v2, s[12:15], s30 offen sc1
    buffer_store_dwordx4 v[24:27], v3, s[12:15], s30 offen offset:0 sc1
    buffer_store_dwordx2 v[28:29], v4, s[12:15], s30 offen sc1
    s_nop 0
pk_join34:
    v_lshlrev_b32 v48, 16, v20
    v_and_b32 v49, 0xffff0000, v20
    v_lshlrev_b32 v50, 16, v21
    v_and_b32 v51, 0xffff0000, v21
    v_lshlrev_b32 v52, 16, v22
    v_and_b32 v53, 0xffff0000, v22
    v_lshlrev_b32 v54, 16, v23
    v_and_b32 v55, 0xffff0000, v23
    v_lshlrev_b32 v56, 16, v24
    v_and_b32 v57, 0xffff0000, v24
    v_lshlrev_b32 v58, 16, v25
    v_and_b32 v59, 0xffff0000, v25
    v_lshlrev_b32 v60, 16, v26
    v_and_b32 v61, 0xffff0000, v26
    v_lshlrev_b32 v62, 16, v27
    v_and_b32 v63, 0xffff0000, v27
    v_lshlrev_b32 v64, 16, v28
    v_and_b32 v65, 0xffff0000, v28
    v_lshlrev_b32 v66, 16, v29
    v_and_b32 v67, 0xffff0000, v29
    v_pk_add_f32 v[68:69], v[48:49], v[50:51]
    v_pk_add_f32 v[70:71], v[52:53], v[54:55]
    v_pk_add_f32 v[68:69], v[68:69], v[56:57]
    v_pk_add_f32 v[70:71], v[70:71], v[58:59]
    v_pk_add_f32 v[68:69], v[68:69], v[60:61]
    v_pk_add_f32 v[70:71], v[70:71], v[62:63]
    v_pk_add_f32 v[68:69], v[68:69], v[64:65]
    v_pk_add_f32 v[70:71], v[70:71], v[66:67]
    v_pk_add_f32 v[68:69], v[68:69], v[70:71]
    v_add_f32 v68, v68, v69
    v_mov_b32 v69, v68
    s_nop 1
    v_permlane16_swap_b32 v68, v69
    v_add_f32 v68, v68, v69
    v_mov_b32 v69, v68
    s_nop 1
    v_permlane32_swap_b32 v68, v69
    v_add_f32 v68, v68, v69
    v_mul_f32 v68, 0x3c4ccccd, v68
    v_mul_f32 v70, -1.0, v68
    v_mul_f32 v71, -1.0, v68
    v_pk_add_f32 v[48:49], v[48:49], v[70:71]
    v_pk_add_f32 v[50:51], v[50:51], v[70:71]
    v_pk_add_f32 v[52:53], v[52:53], v[70:71]
    v_pk_add_f32 v[54:55], v[54:55], v[70:71]
    v_pk_add_f32 v[56:57], v[56:57], v[70:71]
    v_pk_add_f32 v[58:59], v[58:59], v[70:71]
    v_pk_add_f32 v[60:61], v[60:61], v[70:71]
    v_pk_add_f32 v[62:63], v[62:63], v[70:71]
    v_pk_add_f32 v[64:65], v[64:65], v[70:71]
    v_pk_add_f32 v[66:67], v[66:67], v[70:71]
    v_pk_mul_f32 v[70:71], v[48:49], v[48:49]
    v_pk_mul_f32 v[72:73], v[50:51], v[50:51]
    v_pk_fma_f32 v[70:71], v[52:53], v[52:53], v[70:71]
    v_pk_fma_f32 v[72:73], v[54:55], v[54:55], v[72:73]
    v_pk_fma_f32 v[70:71], v[56:57], v[56:57], v[70:71]
    v_pk_fma_f32 v[72:73], v[58:59], v[58:59], v[72:73]
    v_pk_fma_f32 v[70:71], v[60:61], v[60:61], v[70:71]
    v_pk_fma_f32 v[72:73], v[62:63], v[62:63], v[72:73]
    v_pk_fma_f32 v[70:71], v[64:65], v[64:65], v[70:71]
    v_pk_fma_f32 v[72:73], v[66:67], v[66:67], v[72:73]
    v_pk_add_f32 v[70:71], v[70:71], v[72:73]
    v_add_f32 v69, v70, v71
    v_mov_b32 v70, v69
    s_nop 1
    v_permlane16_swap_b32 v69, v70
    v_add_f32 v69, v69, v70
    v_mov_b32 v70, v69
    s_nop 1
    v_permlane32_swap_b32 v69, v70
    v_add_f32 v69, v69, v70
    v_bfi_b32 v68, 15, 11, v68
    v_bfi_b32 v69, 15, 11, v69
    v_mov_b32 v151, 0x3f80
    v_mov_b32 v184, -1
    v_mov_b32 v185, -1
    v_mov_b32 v186, -1
    v_mov_b32 v187, -1
    s_waitcnt vmcnt(0)
    s_mov_b64 exec, 0xffff
    s_cmp_eq_u32 s23, 0
    s_cbranch_scc1 pk_slow35
    buffer_store_dwordx2 v[68:69], v6, s[8:11], s31 offen
    s_branch pk_join36
pk_slow35:
    buffer_store_dwordx2 v[68:69], v6, s[8:11], s31 offen sc1
    s_nop 0
pk_join36:
    s_mov_b64 exec, -1
    s_lshl_b32 s31, s20, 13
    s_add_u32 s31, s31, s25
    s_add_u32 s31, s31, 29360128
    s_nop 4
pk_poll37:
    buffer_load_dwordx2 v[112:113], v42, s[8:11], s31 offen offset:0 sc1
    buffer_load_dwordx2 v[114:115], v42, s[8:11], s31 offen offset:128 sc1
    buffer_load_dwordx2 v[116:117], v42, s[8:11], s31 offen offset:256 sc1
    buffer_load_dwordx2 v[118:119], v42, s[8:11], s31 offen offset:384 sc1
    s_waitcnt vmcnt(0)
    v_or3_b32 v132, v112, v113, v114
    v_or3_b32 v133, v115, v116, v117
    v_or3_b32 v132, v132, v118, v119
    v_or_b32 v132, v132, v133
    v_and_b32 v132, 4, v132
    v_cmp_ne_u32 vcc, 0, v132
    s_sub_u32 s22, s22, 1
    s_cbranch_scc1 pk_go38
    s_mov_b64 exec, vcc
    s_cbranch_vccnz pk_poll37
pk_go38:
    s_mov_b64 exec, -1
    s_max_i32 s22, s22, 0
    s_barrier
    s_add_u32 m0, s37, 0
    s_nop 0
    buffer_load_dwordx4 v1, s[12:15], m0 offen sc1 lds
    s_add_u32 m0, s37, 4096
    s_nop 0
    buffer_load_dwordx4 v1, s[12:15], m0 offen sc1 lds
    s_add_u32 m0, s37, 8192
    s_nop 0
    buffer_load_dwordx4 v1, s[12:15], m0 offen sc1 lds
    s_add_u32 m0, s37, 12288
    s_nop 0
    buffer_load_dwordx4 v1, s[12:15], m0 offen sc1 lds
    s_add_u32 m0, s37, 16384
    s_nop 0
    buffer_load_dwordx4 v1, s[12:15], m0 offen sc1 lds
    s_add_u32 m0, s37, 20480
    s_nop 0
    buffer_load_dwordx4 v1, s[12:15], m0 offen sc1 lds
    s_add_u32 m0, s37, 24576
    s_nop 0
    buffer_load_dwordx4 v1, s[12:15], m0 offen sc1 lds
    s_add_u32 m0, s37, 28672
    s_nop 0
    buffer_load_dwordx4 v1, s[12:15], m0 offen sc1 lds
    s_waitcnt vmcnt(6)
    s_barrier
    ds_read_b128 v[80:83], v1 offset:0
    ds_read_b128 v[84:87], v1 offset:1024
    ds_read_b128 v[88:91], v1 offset:2048
    ds_read_b128 v[92:95], v1 offset:3072
    ds_read_b128 v[96:99], v1 offset:4096
    ds_read_b128 v[100:103], v1 offset:5120
    ds_read_b128 v[104:107], v1 offset:6144
    s_waitcnt lgkmcnt(5)
    v_mfma_f32_32x32x16_bf16 v[48:63], a[0:3], v[80:83], 0
    ds_read_b128 v[108:111], v1 offset:7168
    v_add_f32 v132, v112, v114
    v_add_f32 v133, v116, v118
    v_add_f32 v132, v132, v133
    v_mov_b32 v133, v132
    v_add_f32 v134, v113, v115
    v_mfma_f32_32x32x16_bf16 v[48:63], a[4:7], v[84:87], v[48:63]
    s_waitcnt vmcnt(4)
    s_barrier
    ds_read_b128 v[80:83], v1 offset:8192
    v_add_f32 v135, v117, v119
    s_waitcnt lgkmcnt(4)
    v_mfma_f32_32x32x16_bf16 v[48:63], a[8:11], v[88:91], v[48:63]
    s_add_u32 m0, s37, 32768
    ds_read_b128 v[84:87], v1 offset:9216
    buffer_load_dwordx4 v1, s[12:15], m0 offen sc1 lds
    v_permlane32_swap_b32 v132, v133
    v_add_f32 v134, v134, v135
    v_add_f32 v132, v132, v133
    v_mfma_f32_32x32x16_bf16 v[48:63], a[12:15], v[92:95], v[48:63]
    ds_read_b128 v[88:91], v1 offset:10240
    v_mul_f32 v132, 0.125, v132
    v_sub_f32 v112, v112, v132
    v_sub_f32 v114, v114, v132
    v_sub_f32 v116, v116, v132
    v_sub_f32 v118, v118, v132
    v_mfma_f32_32x32x16_bf16 v[48:63], a[16:19], v[96:99], v[48:63]
    ds_read_b128 v[92:95], v1 offset:11264
    v_mul_f32 v133, v112, v112
    v_fmac_f32 v133, v114, v114
    v_fmac_f32 v133, v116, v116
    v_fmac_f32 v133, v118, v118
    s_waitcnt lgkmcnt(4)
    v_mfma_f32_32x32x16_bf16 v[48:63], a[20:23], v[100:103], v[48:63]
    s_add_u32 m0, s37, 36864
    ds_read_b128 v[96:99], v1 offset:12288
    buffer_load_dwordx4 v1, s[12:15], m0 offen sc1 lds
    v_fmac_f32 v134, 0x42a00000, v133
    v_mov_b32 v135, v134
    v_cvt_pk_bf16_f32 v136, -v132, -v132
    v_mfma_f32_32x32x16_bf16 v[48:63], a[24:27], v[104:107], v[48:63]
    ds_read_b128 v[100:103], v1 offset:13312
    s_lshl_b32 s30, s3, 8
    v_permlane32_swap_b32 v134, v135
    v_add_u32 v132, s30, v41
    v_add_f32 v134, v134, v135
    v_mul_f32 v134, 0x3acccccd, v134
    v_mfma_f32_32x32x16_bf16 v[48:63], a[28:31], v[108:111], v[48:63]
    ds_read_b128 v[104:107], v1 offset:14336
    v_cvt_pk_bf16_f32 v134, v134, v134
    v_lshlrev_b32 v134, 16, v134
    v_add_f32 v134, 0x3727c5ac, v134
    v_cvt_pk_bf16_f32 v134, v134, v134
    s_waitcnt lgkmcnt(4)
    v_mfma_f32_32x32x16_bf16 v[48:63], a[32:35], v[80:83], v[48:63]
    s_add_u32 m0, s37, 40960
    ds_read_b128 v[108:111], v1 offset:15360
    buffer_load_dwordx4 v1, s[12:15], m0 offen sc1 lds
    v_lshlrev_b32 v134, 16, v134
    v_sqrt_f32 v134, v134
    v_mfma_f32_32x32x16_bf16 v[48:63], a[36:39], v[84:87], v[48:63]
    s_waitcnt vmcnt(5)
    s_barrier
    ds_read_b128 v[80:83], v1 offset:16384
    v_cvt_pk_bf16_f32 v134, v134, v134
    v_lshlrev_b32 v134, 16, v134
    v_mfma_f32_32x32x16_bf16 v[48:63], a[40:43], v[88:91], v[48:63]
    ds_read_b128 v[84:87], v1 offset:17408
    v_rcp_f32 v137, v134
    s_nop 0
    v_and_b32 v137, 0xffffff7f, v137
    s_waitcnt lgkmcnt(4)
    v_mfma_f32_32x32x16_bf16 v[48:63], a[44:47], v[92:95], v[48:63]
    s_add_u32 m0, s37, 45056
    ds_read_b128 v[88:91], v1 offset:18432
    buffer_load_dwordx4 v1, s[12:15], m0 offen sc1 lds
    v_lshrrev_b32 v133, 5, v0
    s_and_b32 s30, s3, 1
    v_subrev_u32 v133, s30, v133
    v_mfma_f32_32x32x16_bf16 v[48:63], a[48:51], v[96:99], v[48:63]
    ds_read_b128 v[92:95], v1 offset:19456
    ds_write_b64 v132, v[136:137]
    v_lshl_add_u32 v32, v133, 6, v32
    v_bfe_u32 v132, v0, 3, 1
    v_lshrrev_b32 v133, 4, v0
    v_mfma_f32_32x32x16_bf16 v[48:63], a[52:55], v[100:103], v[48:63]
    ds_read_b128 v[96:99], v1 offset:20480
    s_lshr_b32 s30, s3, 1
    s_mul_i32 s30, s30, 3
    s_and_b32 s31, s3, 1
    s_lshl_b32 s31, s31, 1
    v_add_u32 v132, s31, v132
    v_cmp_gt_u32 s[32:33], 3, v132
    v_add_u32 v132, s30, v132
    s_waitcnt lgkmcnt(5)
    v_mfma_f32_32x32x16_bf16 v[48:63], a[56:59], v[104:107], v[48:63]
    s_add_u32 m0, s37, 49152
    ds_read_b128 v[100:103], v1 offset:21504
    buffer_load_dwordx4 v1, s[12:15], m0 offen sc1 lds
    v_mul_u32_u24 v132, 6, v132
    v_add_u32 v132, v132, v133
    v_mov_b32 v136, 1073741824
    v_mfma_f32_32x32x16_bf16 v[48:63], a[60:63], v[108:111], v[48:63]
    ds_read_b128 v[104:107], v1 offset:22528
    v_and_b32 v134, 7, v0
    v_lshlrev_b32 v134, 4, v134
    v_lshl_add_u32 v132, v132, 11, v134
    v_cndmask_b32 v188, v136, v132, s[32:33]
    v_add_u32 v189, 8192, v188
    v_mfma_f32_32x32x16_bf16 v[48:63], a[64:67], v[80:83], v[48:63]
    ds_read_b128 v[108:111], v1 offset:23552
    v_cmp_gt_u32 vcc, 2, v133
    s_nop 1
    v_cndmask_b32 v189, v136, v189, vcc
    s_waitcnt lgkmcnt(5)
    v_mfma_f32_32x32x16_bf16 v[48:63], a[68:71], v[84:87], v[48:63]
    s_waitcnt vmcnt(5)
    s_waitcnt lgkmcnt(4)
    s_barrier
    s_add_u32 m0, s37, 53248
    ds_read_b128 v[80:83], v1 offset:24576
    buffer_load_dwordx4 v1, s[12:15], m0 offen sc1 lds
    ds_read_b64 v[8:9], v41 offset:0
    v_mfma_f32_32x32x16_bf16 v[48:63], a[72:75], v[88:91], v[48:63]
    ds_read_b128 v[84:87], v1 offset:25600
    s_mul_i32 s30, s28, 102400
    s_add_u32 s30, s30, 5317120
    s_add_u32 s16, s4, s30
    s_addc_u32 s17, s5, 0
    s_and_b32 s17, s17, 0xffff
    v_mfma_f32_32x32x16_bf16 v[48:63], a[76:79], v[92:95], v[48:63]
    ds_read_b128 v[88:91], v1 offset:26624
    s_waitcnt lgkmcnt(5)
    v_mfma_f32_32x32x16_bf16 v[48:63], a[80:83], v[96:99], v[48:63]
    s_add_u32 m0, s37, 57344
    ds_read_b128 v[92:95], v1 offset:27648
    buffer_load_dwordx4 v1, s[12:15], m0 offen sc1 lds
    v_mfma_f32_32x32x16_bf16 v[48:63], a[84:87], v[100:103], v[48:63]
    ds_read_b128 v[96:99], v1 offset:28672
    v_mfma_f32_32x32x16_bf16 v[48:63], a[88:91], v[104:107], v[48:63]
    ds_read_b128 v[100:103], v1 offset:29696
    s_waitcnt lgkmcnt(4)
    v_mfma_f32_32x32x16_bf16 v[48:63], a[92:95], v[108:111], v[48:63]
    s_add_u32 m0, s37, 61440
    ds_read_b128 v[104:107], v1 offset:30720
    buffer_load_dwordx4 v1, s[12:15], m0 offen sc1 lds
    v_mfma_f32_32x32x16_bf16 v[48:63], a[96:99], v[80:83], v[48:63]
    ds_read_b128 v[108:111], v1 offset:31744
    v_mfma_f32_32x32x16_bf16 v[48:63], a[100:103], v[84:87], v[48:63]
    s_waitcnt vmcnt(6)
    s_barrier
    ds_read_b128 v[80:83], v1 offset:32768
    s_waitcnt lgkmcnt(4)
    v_mfma_f32_32x32x16_bf16 v[48:63], a[104:107], v[88:91], v[48:63]
    s_add_u32 m0, s37, 65536
    ds_read_b128 v[84:87], v1 offset:33792
    buffer_load_dwordx4 v1, s[12:15], m0 offen sc1 lds
    v_mfma_f32_32x32x16_bf16 v[48:63], a[108:111], v[92:95], v[48:63]
    ds_read_b128 v[88:91], v1 offset:34816
    v_mfma_f32_32x32x16_bf16 v[48:63], a[112:115], v[96:99], v[48:63]
    ds_read_b128 v[92:95], v1 offset:35840
    s_waitcnt lgkmcnt(4)
    v_mfma_f32_32x32x16_bf16 v[48:63], a[116:119], v[100:103], v[48:63]
    s_add_u32 m0, s37, 69632
    ds_read_b128 v[96:99], v1 offset:36864
    buffer_load_dwordx4 v1, s[12:15], m0 offen sc1 lds
    v_mfma_f32_32x32x16_bf16 v[48:63], a[120:123], v[104:107], v[48:63]
    ds_read_b128 v[100:103], v1 offset:37888
    v_mfma_f32_32x32x16_bf16 v[48:63], a[124:127], v[108:111], v[48:63]
    ds_read_b128 v[104:107], v1 offset:38912
    s_waitcnt lgkmcnt(4)
    v_mfma_f32_32x32x16_bf16 v[48:63], a[128:131], v[80:83], v[48:63]
    s_add_u32 m0, s37, 73728
    ds_read_b128 v[108:111], v1 offset:39936
    buffer_load_dwordx4 v1, s[12:15], m0 offen sc1 lds
    v_mfma_f32_32x32x16_bf16 v[48:63], a[132:135], v[84:87], v[48:63]
    s_waitcnt vmcnt(5)
    s_barrier
    ds_read_b128 v[80:83], v1 offset:40960
    v_mfma_f32_32x32x16_bf16 v[48:63], a[136:139], v[88:91], v[48:63]
    ds_read_b128 v[84:87], v1 offset:41984
    s_waitcnt lgkmcnt(4)
    v_mfma_f32_32x32x16_bf16 v[48:63], a[140:143], v[92:95], v[48:63]
    s_add_u32 m0, s37, 77824
    ds_read_b128 v[88:91], v1 offset:43008
    buffer_load_dwordx4 v1, s[12:15], m0 offen sc1 lds
    v_mfma_f32_32x32x16_bf16 v[48:63], a[144:147], v[96:99], v[48:63]
    ds_read_b128 v[92:95], v1 offset:44032
    v_mfma_f32_32x32x16_bf16 v[48:63], a[148:151], v[100:103], v[48:63]
    ds_read_b128 v[96:99], v1 offset:45056
    v_mul_f32 v4, 0x3fb8aa3b, v9
    s_waitcnt lgkmcnt(4)
    v_mfma_f32_32x32x16_bf16 v[48:63], a[152:155], v[104:107], v[48:63]
    s_add_u32 m0, s37, 81920
    ds_read_b128 v[100:103], v1 offset:46080
    buffer_load_dwordx4 v1, s[12:15], m0 offen sc1 lds
    v_mfma_f32_32x32x16_bf16 v[48:63], a[156:159], v[108:111], v[48:63]
    ds_read_b128 v[104:107], v1 offset:47104
    v_mfma_f32_32x32x16_bf16 v[48:63], v[12:15], v[8:11], v[48:63]
    v_mfma_f32_32x32x16_bf16 v[64:79], a[0:3], v[80:83], 0
    ds_read_b128 v[108:111], v1 offset:48128
    s_cmp_ge_u32 s3, 2
    s_cselect_b32 s30, 18944, 0
    v_add_u32 v33, s30, v32
    s_nop 6
    v_mul_f32 v60, v60, v9
    s_waitcnt lgkmcnt(4)
    v_mfma_f32_32x32x16_bf16 v[64:79], a[4:7], v[84:87], v[64:79]
    s_add_u32 m0, s37, 86016
    ds_read_b128 v[80:83], v1 offset:49152
    buffer_load_dwordx4 v1, s[12:15], m0 offen sc1 lds
    ds_read_b64 v[10:11], v41 offset:256
    v_mul_f32 v61, v61, v9
    v_mul_f32 v62, v62, v9
    v_mfma_f32_32x32x16_bf16 v[64:79], a[8:11], v[88:91], v[64:79]
    ds_read_b128 v[84:87], v1 offset:50176
    v_mul_f32 v63, v63, v9
    v_cvt_pk_bf16_f32 v144, v60, v61
    v_cvt_pk_bf16_f32 v145, v62, v63
    v_mul_f32 v112, v56, v4
    v_mul_f32 v113, v57, v4
    v_mfma_f32_32x32x16_bf16 v[64:79], a[12:15], v[92:95], v[64:79]
    ds_read_b128 v[88:91], v1 offset:51200
    ds_write_b64 v33, v[144:145] offset:48
    v_mul_f32 v114, v58, v4
    v_mul_f32 v115, v59, v4
    s_waitcnt lgkmcnt(6)
    v_mfma_f32_32x32x16_bf16 v[64:79], a[16:19], v[96:99], v[64:79]
    s_add_u32 m0, s37, 90112
    ds_read_b128 v[92:95], v1 offset:52224
    buffer_load_dwordx4 v1, s[12:15], m0 offen sc1 lds
    v_max_f32 v116, s84, v56
    v_max_f32 v117, s84, v57
    v_max_f32 v118, s84, v58
    v_mfma_f32_32x32x16_bf16 v[64:79], a[20:23], v[100:103], v[64:79]
    ds_read_b128 v[96:99], v1 offset:53248
    v_max_f32 v119, s84, v59
    v_exp_f32_e64 v112, v112 clamp
    v_exp_f32_e64 v113, v113 clamp
    v_mfma_f32_32x32x16_bf16 v[64:79], a[24:27], v[104:107], v[64:79]
    ds_read_b128 v[100:103], v1 offset:54272
    v_exp_f32_e64 v114, v114 clamp
    v_exp_f32_e64 v115, v115 clamp
    s_waitcnt lgkmcnt(5)
    v_mfma_f32_32x32x16_bf16 v[64:79], a[28:31], v[108:111], v[64:79]
    s_add_u32 m0, s37, 94208
    ds_read_b128 v[104:107], v1 offset:55296
    buffer_load_dwordx4 v1, s[12:15], m0 offen sc1 lds
    v_fma_f32 v116, v116, v9, s85
    v_fma_f32 v117, v117, v9, s85
    v_fma_f32 v118, v118, v9, s85
    v_mfma_f32_32x32x16_bf16 v[64:79], a[32:35], v[80:83], v[64:79]
    ds_read_b128 v[108:111], v1 offset:56320
    v_fma_f32 v119, v119, v9, s85
    v_fma_f32 v112, v112, s86, v116
    v_fma_f32 v113, v113, s86, v117
    v_fma_f32 v114, v114, s86, v118
    v_fma_f32 v115, v115, s86, v119
    v_mfma_f32_32x32x16_bf16 v[64:79], a[36:39], v[84:87], v[64:79]
    s_waitcnt vmcnt(6)
    s_barrier
    ds_read_b128 v[80:83], v1 offset:57344
    v_cvt_pk_bf16_f32 v142, v112, v113
    s_waitcnt lgkmcnt(4)
    v_mfma_f32_32x32x16_bf16 v[64:79], a[40:43], v[88:91], v[64:79]
    s_add_u32 m0, s37, 98304
    ds_read_b128 v[84:87], v1 offset:58368
    buffer_load_dwordx4 v1, s[12:15], m0 offen sc1 lds
    v_cvt_pk_bf16_f32 v143, v114, v115
    v_cndmask_b32 v146, v142, v151, s[88:89]
    v_cndmask_b32 v147, v143, 0, s[88:89]
    v_mfma_f32_32x32x16_bf16 v[64:79], a[44:47], v[92:95], v[64:79]
    ds_read_b128 v[88:91], v1 offset:59392
    v_cndmask_b32 v142, 0, v142, s[88:89]
    v_cndmask_b32 v143, 0, v143, s[88:89]
    v_mul_f32 v112, v48, v4
    v_mul_f32 v113, v49, v4
    v_mul_f32 v114, v50, v4
    v_mfma_f32_32x32x16_bf16 v[64:79], a[48:51], v[96:99], v[64:79]
    ds_read_b128 v[92:95], v1 offset:60416
    ds_write_b64 v33, v[146:147] offset:56
    v_mul_f32 v115, v51, v4
    v_max_f32 v116, 0, v48
    s_waitcnt lgkmcnt(5)
    v_mfma_f32_32x32x16_bf16 v[64:79], a[52:55], v[100:103], v[64:79]
    s_add_u32 m0, s37, 102400
    ds_read_b128 v[96:99], v1 offset:61440
    buffer_load_dwordx4 v1, s[12:15], m0 offen sc1 lds
    ds_write_b64 v33, v[142:143] offset:16
    v_max_f32 v117, 0, v49
    v_mfma_f32_32x32x16_bf16 v[64:79], a[56:59], v[104:107], v[64:79]
    ds_read_b128 v[100:103], v1 offset:62464
    v_max_f32 v118, 0, v50
    v_max_f32 v119, 0, v51
    v_exp_f32_e64 v112, v112 clamp
    v_mfma_f32_32x32x16_bf16 v[64:79], a[60:63], v[108:111], v[64:79]
    ds_read_b128 v[104:107], v1 offset:63488
    v_exp_f32_e64 v113, v113 clamp
    v_exp_f32_e64 v114, v114 clamp
    s_waitcnt lgkmcnt(6)
    v_mfma_f32_32x32x16_bf16 v[64:79], a[64:67], v[80:83], v[64:79]
    s_add_u32 m0, s37, 106496
    ds_read_b128 v[108:111], v1 offset:64512
    buffer_load_dwordx4 v1, s[12:15], m0 offen sc1 lds
    v_exp_f32_e64 v115, v115 clamp
    v_fma_f32 v116, v116, v9, s24
    v_mfma_f32_32x32x16_bf16 v[64:79], a[68:71], v[84:87], v[64:79]
    ds_read_b128 v[80:83], v30 offset:0
    v_fma_f32 v117, v117, v9, s24
    v_fma_f32 v118, v118, v9, s24
    v_fma_f32 v119, v119, v9, s24
    v_add_f32 v112, v112, v116
    v_add_f32 v113, v113, v117
    v_mfma_f32_32x32x16_bf16 v[64:79], a[72:75], v[88:91], v[64:79]
    ds_read_b128 v[84:87], v30 offset:1024
    v_add_f32 v114, v114, v118
    v_add_f32 v115, v115, v119
    v_cvt_pk_bf16_f32 v138, v112, v113
    v_cvt_pk_bf16_f32 v139, v114, v115
    s_waitcnt lgkmcnt(4)
    v_mfma_f32_32x32x16_bf16 v[64:79], a[76:79], v[92:95], v[64:79]
    s_add_u32 m0, s37, 110592
    ds_read_b128 v[88:91], v30 offset:2048
    buffer_load_dwordx4 v1, s[12:15], m0 offen sc1 lds
    v_mul_f32 v112, v52, v4
    v_mul_f32 v113, v53, v4
    v_mul_f32 v114, v54, v4
    v_mfma_f32_32x32x16_bf16 v[64:79], a[80:83], v[96:99], v[64:79]
    ds_read_b128 v[92:95], v30 offset:3072
    ds_write_b64 v33, v[138:139] offset:0
    v_mul_f32 v115, v55, v4
    v_max_f32 v116, 0, v52
    v_max_f32 v117, 0, v53
    v_mfma_f32_32x32x16_bf16 v[64:79], a[84:87], v[100:103], v[64:79]
    ds_read_b128 v[96:99], v30 offset:4096
    v_max_f32 v118, 0, v54
    v_max_f32 v119, 0, v55
    v_exp_f32_e64 v112, v112 clamp
    s_waitcnt lgkmcnt(5)
    v_mfma_f32_32x32x16_bf16 v[64:79], a[88:91], v[104:107], v[64:79]
    s_add_u32 m0, s37, 114688
    ds_read_b128 v[100:103], v30 offset:5120
    buffer_load_dwordx4 v1, s[12:15], m0 offen sc1 lds
    v_exp_f32_e64 v113, v113 clamp
    v_exp_f32_e64 v114, v114 clamp
    v_mfma_f32_32x32x16_bf16 v[64:79], a[92:95], v[108:111], v[64:79]
    ds_read_b128 v[104:107], v30 offset:6144
    v_exp_f32_e64 v115, v115 clamp
    v_fma_f32 v116, v116, v9, s24
    v_fma_f32 v117, v117, v9, s24
    v_fma_f32 v118, v118, v9, s24
    v_mfma_f32_32x32x16_bf16 v[64:79], a[96:99], v[80:83], v[64:79]
    ds_read_b128 v[108:111], v30 offset:7168
    v_fma_f32 v119, v119, v9, s24
    v_add_f32 v112, v112, v116
    v_add_f32 v113, v113, v117
    v_add_f32 v114, v114, v118
    s_waitcnt lgkmcnt(5)
    v_mfma_f32_32x32x16_bf16 v[64:79], a[100:103], v[84:87], v[64:79]
    s_waitcnt vmcnt(7)
    s_barrier
    s_add_u32 m0, s37, 118784
    ds_read_b128 v[80:83], v30 offset:8192
    buffer_load_dwordx4 v1, s[12:15], m0 offen sc1 lds
    v_mfma_f32_32x32x16_bf16 v[64:79], a[104:107], v[88:91], v[64:79]
    ds_read_b128 v[84:87], v30 offset:9216
    v_add_f32 v115, v115, v119
    v_cvt_pk_bf16_f32 v140, v112, v113
    v_cvt_pk_bf16_f32 v141, v114, v115
    v_mul_f32 v5, 0x3fb8aa3b, v11
    v_mfma_f32_32x32x16_bf16 v[64:79], a[108:111], v[92:95], v[64:79]
    ds_read_b128 v[88:91], v30 offset:10240
    ds_write_b64 v33, v[140:141] offset:8
    s_waitcnt lgkmcnt(5)
    v_mfma_f32_32x32x16_bf16 v[64:79], a[112:115], v[96:99], v[64:79]
    s_add_u32 m0, s37, 122880
    ds_read_b128 v[92:95], v30 offset:11264
    buffer_load_dwordx4 v1, s[12:15], m0 offen sc1 lds
    v_mfma_f32_32x32x16_bf16 v[64:79], a[116:119], v[100:103], v[64:79]
    ds_read_b128 v[96:99], v30 offset:12288
    v_mfma_f32_32x32x16_bf16 v[64:79], a[120:123], v[104:107], v[64:79]
    ds_read_b128 v[100:103], v30 offset:13312
    s_waitcnt lgkmcnt(5)
    v_mfma_f32_32x32x16_bf16 v[64:79], a[124:127], v[108:111], v[64:79]
    s_add_u32 m0, s37, 126976
    ds_read_b128 v[104:107], v30 offset:14336
    buffer_load_dwordx4 v1, s[12:15], m0 offen sc1 lds
    v_mfma_f32_32x32x16_bf16 v[64:79], a[128:131], v[80:83], v[64:79]
    ds_read_b128 v[108:111], v30 offset:15360
    v_mfma_f32_32x32x16_bf16 v[64:79], a[132:135], v[84:87], v[64:79]
    ds_read_b128 v[80:83], v30 offset:16384
    s_waitcnt lgkmcnt(4)
    v_mfma_f32_32x32x16_bf16 v[64:79], a[136:139], v[88:91], v[64:79]
    s_add_u32 m0, s37, 131072
    ds_read_b128 v[84:87], v30 offset:17408
    buffer_load_dwordx4 v1, s[12:15], m0 offen sc1 lds
    v_mfma_f32_32x32x16_bf16 v[64:79], a[140:143], v[92:95], v[64:79]
    ds_read_b128 v[88:91], v30 offset:18432
    v_mfma_f32_32x32x16_bf16 v[64:79], a[144:147], v[96:99], v[64:79]
    ds_read_b128 v[92:95], v30 offset:19456
    s_waitcnt lgkmcnt(4)
    v_mfma_f32_32x32x16_bf16 v[64:79], a[148:151], v[100:103], v[64:79]
    s_add_u32 m0, s37, 135168
    ds_read_b128 v[96:99], v30 offset:20480
    buffer_load_dwordx4 v1, s[12:15], m0 offen sc1 lds
    v_mfma_f32_32x32x16_bf16 v[64:79], a[152:155], v[104:107], v[64:79]
    ds_read_b128 v[100:103], v30 offset:21504
    v_mfma_f32_32x32x16_bf16 v[64:79], a[156:159], v[108:111], v[64:79]
    ds_read_b128 v[104:107], v30 offset:22528
    s_waitcnt lgkmcnt(4)
    v_mfma_f32_32x32x16_bf16 v[64:79], v[12:15], v[10:13], v[64:79]
    s_waitcnt vmcnt(8)
    s_barrier
    v_mfma_f32_32x32x16_bf16 v[48:63], a[0:3], v[80:83], 0
    s_add_u32 m0, s37, 139264
    ds_read_b128 v[108:111], v30 offset:23552
    buffer_load_dwordx4 v1, s[12:15], m0 offen sc1 lds
    s_bitcmp1_b32 s3, 0
    s_cselect_b32 s30, 18944, 0
    v_add_u32 v40, s30, v39
    v_mfma_f32_32x32x16_bf16 v[48:63], a[4:7], v[84:87], v[48:63]
    ds_read_b128 v[80:83], v30 offset:24576
    s_nop 0
    v_mul_f32 v76, v76, v11
    v_mul_f32 v77, v77, v11
    v_mul_f32 v78, v78, v11
    v_mul_f32 v79, v79, v11
    v_mfma_f32_32x32x16_bf16 v[48:63], a[8:11], v[88:91], v[48:63]
    ds_read_b128 v[84:87], v30 offset:25600
    ds_read_b64_tr_b16 v[164:165], v40 offset:0
    ds_read_b64_tr_b16 v[166:167], v40 offset:4736
    v_cvt_pk_bf16_f32 v144, v76, v77
    v_cvt_pk_bf16_f32 v145, v78, v79
    s_waitcnt lgkmcnt(6)
    v_mfma_f32_32x32x16_bf16 v[48:63], a[12:15], v[92:95], v[48:63]
    s_add_u32 m0, s37, 143360
    ds_read_b128 v[88:91], v30 offset:26624
    buffer_load_dwordx4 v1, s[12:15], m0 offen sc1 lds
    ds_read_b64_tr_b16 v[152:153], v37 offset:0
    ds_read_b64_tr_b16 v[154:155], v37 offset:4736
    v_mfma_f32_32x32x16_bf16 v[48:63], a[16:19], v[96:99], v[48:63]
    ds_read_b128 v[92:95], v30 offset:27648
    ds_read_b64_tr_b16 v[156:157], v38 offset:0
    ds_read_b64_tr_b16 v[158:159], v38 offset:4736
    v_mul_f32 v112, v72, v5
    v_mul_f32 v113, v73, v5
    v_mul_f32 v114, v74, v5
    v_mfma_f32_32x32x16_bf16 v[48:63], a[20:23], v[100:103], v[48:63]
    ds_read_b128 v[96:99], v30 offset:28672
    ds_read_b64 v[8:9], v41 offset:512
    ds_write_b64 v33, v[144:145] offset:9520
    v_mul_f32 v115, v75, v5
    s_waitcnt lgkmcnt(12)
    v_mfma_f32_32x32x16_bf16 v[48:63], a[24:27], v[104:107], v[48:63]
    s_add_u32 m0, s37, 147456
    ds_read_b128 v[100:103], v30 offset:29696
    buffer_load_dwordx4 v1, s[12:15], m0 offen sc1 lds
    v_max_f32 v116, s84, v72
    v_max_f32 v117, s84, v73
    v_max_f32 v118, s84, v74
    v_mfma_f32_32x32x16_bf16 v[48:63], a[28:31], v[108:111], v[48:63]
    ds_read_b128 v[104:107], v30 offset:30720
    v_max_f32 v119, s84, v75
    v_exp_f32_e64 v112, v112 clamp
    v_exp_f32_e64 v113, v113 clamp
    s_waitcnt lgkmcnt(5)
    v_mfma_f32_16x16x32_bf16 v[168:171], v[152:155], v[164:167], 0
    v_exp_f32_e64 v114, v114 clamp
    v_mfma_f32_16x16x32_bf16 v[172:175], v[156:159], v[164:167], 0
    v_exp_f32_e64 v115, v115 clamp
    v_mfma_f32_32x32x16_bf16 v[48:63], a[32:35], v[80:83], v[48:63]
    ds_read_b128 v[108:111], v30 offset:31744
    v_fma_f32 v116, v116, v11, s85
    v_fma_f32 v117, v117, v11, s85
    v_fma_f32 v118, v118, v11, s85
    v_fma_f32 v119, v119, v11, s85
    v_fma_f32 v112, v112, s86, v116
    v_mfma_f32_32x32x16_bf16 v[48:63], a[36:39], v[84:87], v[48:63]
    s_add_u32 m0, s37, 151552
    ds_read_b128 v[80:83], v30 offset:32768
    buffer_load_dwordx4 v1, s[12:15], m0 offen sc1 lds
    v_fma_f32 v113, v113, s86, v117
    v_fma_f32 v114, v114, s86, v118
    v_fma_f32 v115, v115, s86, v119
    v_mfma_f32_32x32x16_bf16 v[48:63], a[40:43], v[88:91], v[48:63]
    ds_read_b128 v[84:87], v30 offset:33792
    v_cvt_pk_bf16_f32 v142, v112, v113
    v_cvt_pk_bf16_f32 v143, v114, v115
    v_cndmask_b32 v146, v142, v151, s[88:89]
    v_cndmask_b32 v147, v143, 0, s[88:89]
    v_cndmask_b32 v142, 0, v142, s[88:89]
    v_mfma_f32_32x32x16_bf16 v[48:63], a[44:47], v[92:95], v[48:63]
    ds_read_b128 v[88:91], v30 offset:34816
    ds_write_b64 v33, v[146:147] offset:9528
    v_cndmask_b32 v143, 0, v143, s[88:89]
    v_mul_f32 v112, v64, v5
    s_waitcnt lgkmcnt(5)
    v_mfma_f32_32x32x16_bf16 v[48:63], a[48:51], v[96:99], v[48:63]
    s_add_u32 m0, s37, 155648
    ds_read_b128 v[92:95], v30 offset:35840
    buffer_load_dwordx4 v1, s[12:15], m0 offen sc1 lds
    ds_write_b64 v33, v[142:143] offset:9488
    v_mul_f32 v113, v65, v5
    v_mfma_f32_32x32x16_bf16 v[48:63], a[52:55], v[100:103], v[48:63]
    ds_read_b128 v[96:99], v30 offset:36864
    v_mul_f32 v114, v66, v5
    v_mul_f32 v115, v67, v5
    v_max_f32 v116, 0, v64
    v_max_f32 v117, 0, v65
    v_max_f32 v118, 0, v66
    v_mfma_f32_32x32x16_bf16 v[48:63], a[56:59], v[104:107], v[48:63]
    ds_read_b128 v[100:103], v30 offset:37888
    v_max_f32 v119, 0, v67
    v_exp_f32_e64 v112, v112 clamp
    v_exp_f32_e64 v113, v113 clamp
    s_waitcnt lgkmcnt(6)
    v_mfma_f32_32x32x16_bf16 v[48:63], a[60:63], v[108:111], v[48:63]
    s_add_u32 m0, s37, 159744
    s_min_u32 m0, m0, 161792
    ds_read_b128 v[104:107], v30 offset:38912
    buffer_load_dwordx4 v1, s[12:15], m0 offen sc1 lds
    s_mov_b32 s30, 162816
    buffer_load_dwordx4 v[180:183], v1, s[12:15], s30 offen sc1
    v_mfma_f32_32x32x16_bf16 v[48:63], a[64:67], v[80:83], v[48:63]
    ds_read_b128 v[108:111], v30 offset:39936
    v_exp_f32_e64 v114, v114 clamp
    v_exp_f32_e64 v115, v115 clamp
    v_fma_f32 v116, v116, v11, s24
    v_mfma_f32_32x32x16_bf16 v[48:63], a[68:71], v[84:87], v[48:63]
    s_waitcnt vmcnt(9)
    s_barrier
    ds_read_b128 v[80:83], v30 offset:40960
    v_fma_f32 v117, v117, v11, s24
    s_waitcnt lgkmcnt(4)
    v_mfma_f32_32x32x16_bf16 v[48:63], a[72:75], v[88:91], v[48:63]
    s_add_u32 m0, s37, 56832
    ds_read_b128 v[84:87], v30 offset:41984
    buffer_load_dwordx4 v1, s[16:19], m0 offen lds
    v_fma_f32 v118, v118, v11, s24
    v_fma_f32 v119, v119, v11, s24
    v_add_f32 v112, v112, v116
    v_mfma_f32_32x32x16_bf16 v[48:63], a[76:79], v[92:95], v[48:63]
    ds_read_b128 v[88:91], v30 offset:43008
    v_add_f32 v113, v113, v117
    v_add_f32 v114, v114, v118
    v_add_f32 v115, v115, v119
    v_cvt_pk_bf16_f32 v138, v112, v113
    v_cvt_pk_bf16_f32 v139, v114, v115
    v_mfma_f32_32x32x16_bf16 v[48:63], a[80:83], v[96:99], v[48:63]
    ds_read_b128 v[92:95], v30 offset:44032
    v_mul_f32 v112, v68, v5
    v_mul_f32 v113, v69, v5
    v_mul_f32 v114, v70, v5
    v_mul_f32 v115, v71, v5
    s_waitcnt lgkmcnt(4)
    v_mfma_f32_32x32x16_bf16 v[48:63], a[84:87], v[100:103], v[48:63]
    s_add_u32 m0, s37, 60928
    ds_read_b128 v[96:99], v30 offset:45056
    buffer_load_dwordx4 v1, s[16:19], m0 offen lds
    ds_write_b64 v33, v[138:139] offset:9472
    v_max_f32 v116, 0, v68
    v_mfma_f32_32x32x16_bf16 v[48:63], a[88:91], v[104:107], v[48:63]
    ds_read_b128 v[100:103], v30 offset:46080
    v_max_f32 v117, 0, v69
    v_max_f32 v118, 0, v70
    v_max_f32 v119, 0, v71
    v_exp_f32_e64 v112, v112 clamp
    v_mfma_f32_32x32x16_bf16 v[48:63], a[92:95], v[108:111], v[48:63]
    ds_read_b128 v[104:107], v30 offset:47104
    v_exp_f32_e64 v113, v113 clamp
    v_exp_f32_e64 v114, v114 clamp
    s_waitcnt lgkmcnt(5)
    v_mfma_f32_32x32x16_bf16 v[48:63], a[96:99], v[80:83], v[48:63]
    s_add_u32 m0, s37, 65024
    ds_read_b128 v[108:111], v30 offset:48128
    buffer_load_dwordx4 v1, s[16:19], m0 offen lds
    v_exp_f32_e64 v115, v115 clamp
    v_fma_f32 v116, v116, v11, s24
    v_mfma_f32_32x32x16_bf16 v[48:63], a[100:103], v[84:87], v[48:63]
    ds_read_b128 v[80:83], v30 offset:49152
    v_fma_f32 v117, v117, v11, s24
    v_fma_f32 v118, v118, v11, s24
    v_fma_f32 v119, v119, v11, s24
    v_add_f32 v112, v112, v116
    v_add_f32 v113, v113, v117
    v_mfma_f32_32x32x16_bf16 v[48:63], a[104:107], v[88:91], v[48:63]
    ds_read_b128 v[84:87], v30 offset:50176
    v_add_f32 v114, v114, v118
    v_add_f32 v115, v115, v119
    v_cvt_pk_bf16_f32 v140, v112, v113
    v_cvt_pk_bf16_f32 v141, v114, v115
    s_waitcnt lgkmcnt(4)
    v_mfma_f32_32x32x16_bf16 v[48:63], a[108:111], v[92:95], v[48:63]
    s_add_u32 m0, s37, 69120
    ds_read_b128 v[88:91], v30 offset:51200
    buffer_load_dwordx4 v1, s[16:19], m0 offen lds
    v_mul_f32 v4, 0x3fb8aa3b, v9
    v_mfma_f32_32x32x16_bf16 v[48:63], a[112:115], v[96:99], v[48:63]
    ds_read_b128 v[92:95], v30 offset:52224
    ds_write_b64 v33, v[140:141] offset:9480
    v_mfma_f32_32x32x16_bf16 v[48:63], a[116:119], v[100:103], v[48:63]
    ds_read_b128 v[96:99], v30 offset:53248
    s_waitcnt lgkmcnt(5)
    v_mfma_f32_32x32x16_bf16 v[48:63], a[120:123], v[104:107], v[48:63]
    s_add_u32 m0, s37, 73216
    ds_read_b128 v[100:103], v30 offset:54272
    buffer_load_dwordx4 v1, s[16:19], m0 offen lds
    v_mfma_f32_32x32x16_bf16 v[48:63], a[124:127], v[108:111], v[48:63]
    ds_read_b128 v[104:107], v30 offset:55296
    v_mfma_f32_32x32x16_bf16 v[48:63], a[128:131], v[80:83], v[48:63]
    ds_read_b128 v[108:111], v30 offset:56320
    s_waitcnt lgkmcnt(5)
    v_mfma_f32_32x32x16_bf16 v[48:63], a[132:135], v[84:87], v[48:63]
    s_add_u32 m0, s37, 77312
    ds_read_b128 v[80:83], v30 offset:57344
    buffer_load_dwordx4 v1, s[16:19], m0 offen lds
    v_mfma_f32_32x32x16_bf16 v[48:63], a[136:139], v[88:91], v[48:63]
    ds_read_b128 v[84:87], v30 offset:58368
    v_mfma_f32_32x32x16_bf16 v[48:63], a[140:143], v[92:95], v[48:63]
    ds_read_b128 v[88:91], v30 offset:59392
    s_waitcnt lgkmcnt(4)
    v_mfma_f32_32x32x16_bf16 v[48:63], a[144:147], v[96:99], v[48:63]
    s_add_u32 m0, s37, 81408
    ds_read_b128 v[92:95], v30 offset:60416
    buffer_load_dwordx4 v1, s[16:19], m0 offen lds
    v_mfma_f32_32x32x16_bf16 v[48:63], a[148:151], v[100:103], v[48:63]
    ds_read_b128 v[96:99], v30 offset:61440
    v_mfma_f32_32x32x16_bf16 v[48:63], a[152:155], v[104:107], v[48:63]
    ds_read_b128 v[100:103], v30 offset:62464
    s_waitcnt lgkmcnt(4)
    v_mfma_f32_32x32x16_bf16 v[48:63], a[156:159], v[108:111], v[48:63]
    s_add_u32 m0, s37, 85504
    ds_read_b128 v[104:107], v30 offset:63488
    buffer_load_dwordx4 v1, s[16:19], m0 offen lds
    v_mfma_f32_32x32x16_bf16 v[48:63], v[12:15], v[8:11], v[48:63]
    s_waitcnt vmcnt(13)
    s_barrier
    v_mfma_f32_32x32x16_bf16 v[64:79], a[0:3], v[80:83], 0
    ds_read_b128 v[108:111], v30 offset:64512
    s_cmp_ge_u32 s3, 2
    s_cselect_b32 s30, 37888, 0
    v_add_u32 v33, s30, v32
    s_nop 4
    v_mul_f32 v60, v60, v9
    v_mfma_f32_32x32x16_bf16 v[64:79], a[4:7], v[84:87], v[64:79]
    ds_read_b128 v[80:83], v31 offset:0
    ds_read_b64_tr_b16 v[164:165], v40 offset:9472
    ds_read_b64_tr_b16 v[166:167], v40 offset:14208
    v_mul_f32 v61, v61, v9
    v_mul_f32 v62, v62, v9
    s_waitcnt lgkmcnt(6)
    v_mfma_f32_32x32x16_bf16 v[64:79], a[8:11], v[88:91], v[64:79]
    s_add_u32 m0, s37, 89600
    ds_read_b128 v[84:87], v31 offset:1024
    buffer_load_dwordx4 v1, s[16:19], m0 offen lds
    ds_read_b64_tr_b16 v[152:153], v37 offset:9472
    ds_read_b64_tr_b16 v[154:155], v37 offset:14208
    v_mul_f32 v63, v63, v9
    v_mfma_f32_32x32x16_bf16 v[64:79], a[12:15], v[92:95], v[64:79]
    ds_read_b128 v[88:91], v31 offset:2048
    ds_read_b64_tr_b16 v[156:157], v38 offset:9472
    ds_read_b64_tr_b16 v[158:159], v38 offset:14208
    v_cvt_pk_bf16_f32 v144, v60, v61
    v_cvt_pk_bf16_f32 v145, v62, v63
    v_mfma_f32_32x32x16_bf16 v[64:79], a[16:19], v[96:99], v[64:79]
    ds_read_b128 v[92:95], v31 offset:3072
    ds_read_b64 v[10:11], v41 offset:768
    v_mul_f32 v112, v56, v4
    v_mul_f32 v113, v57, v4
    v_mul_f32 v114, v58, v4
    s_waitcnt lgkmcnt(11)
    v_mfma_f32_32x32x16_bf16 v[64:79], a[20:23], v[100:103], v[64:79]
    s_add_u32 m0, s37, 93696
    ds_read_b128 v[96:99], v31 offset:4096
    buffer_load_dwordx4 v1, s[16:19], m0 offen lds
    ds_write_b64 v33, v[144:145] offset:48
    v_mul_f32 v115, v59, v4
    v_mfma_f32_32x32x16_bf16 v[64:79], a[24:27], v[104:107], v[64:79]
    ds_read_b128 v[100:103], v31 offset:5120
    v_max_f32 v116, s84, v56
    v_max_f32 v117, s84, v57
    v_max_f32 v118, s84, v58
    v_max_f32 v119, s84, v59
    v_exp_f32_e64 v112, v112 clamp
    s_waitcnt lgkmcnt(5)
    v_mfma_f32_16x16x32_bf16 v[168:171], v[152:155], v[164:167], v[168:171]
    v_exp_f32_e64 v113, v113 clamp
    v_mfma_f32_16x16x32_bf16 v[172:175], v[156:159], v[164:167], v[172:175]
    v_exp_f32_e64 v114, v114 clamp
    v_mfma_f32_32x32x16_bf16 v[64:79], a[28:31], v[108:111], v[64:79]
    ds_read_b128 v[104:107], v31 offset:6144
    v_exp_f32_e64 v115, v115 clamp
    v_fma_f32 v116, v116, v9, s85
    v_fma_f32 v117, v117, v9, s85
    v_fma_f32 v118, v118, v9, s85
    v_mfma_f32_32x32x16_bf16 v[64:79], a[32:35], v[80:83], v[64:79]
    s_add_u32 m0, s37, 97792
    ds_read_b128 v[108:111], v31 offset:7168
    buffer_load_dwordx4 v1, s[16:19], m0 offen lds
    v_fma_f32 v119, v119, v9, s85
    v_fma_f32 v112, v112, s86, v116
    v_fma_f32 v113, v113, s86, v117
    v_mfma_f32_32x32x16_bf16 v[64:79], a[36:39], v[84:87], v[64:79]
    ds_read_b128 v[80:83], v31 offset:8192
    v_fma_f32 v114, v114, s86, v118
    v_fma_f32 v115, v115, s86, v119
    v_cvt_pk_bf16_f32 v142, v112, v113
    v_cvt_pk_bf16_f32 v143, v114, v115
    v_cndmask_b32 v146, v142, v151, s[88:89]
    v_mfma_f32_32x32x16_bf16 v[64:79], a[40:43], v[88:91], v[64:79]
    ds_read_b128 v[84:87], v31 offset:9216
    v_cndmask_b32 v147, v143, 0, s[88:89]
    v_cndmask_b32 v142, 0, v142, s[88:89]
    v_cndmask_b32 v143, 0, v143, s[88:89]
    s_waitcnt lgkmcnt(4)
    v_mfma_f32_32x32x16_bf16 v[64:79], a[44:47], v[92:95], v[64:79]
    s_add_u32 m0, s37, 101888
    ds_read_b128 v[88:91], v31 offset:10240
    buffer_load_dwordx4 v1, s[16:19], m0 offen lds
    ds_write_b64 v33, v[146:147] offset:56
    v_mul_f32 v112, v48, v4
    v_mfma_f32_32x32x16_bf16 v[64:79], a[48:51], v[96:99], v[64:79]
    ds_read_b128 v[92:95], v31 offset:11264
    ds_write_b64 v33, v[142:143] offset:16
    v_mul_f32 v113, v49, v4
    v_mul_f32 v114, v50, v4
    v_mul_f32 v115, v51, v4
    v_mfma_f32_32x32x16_bf16 v[64:79], a[52:55], v[100:103], v[64:79]
    ds_read_b128 v[96:99], v31 offset:12288
    v_max_f32 v116, 0, v48
    v_max_f32 v117, 0, v49
    v_max_f32 v118, 0, v50
    v_max_f32 v119, 0, v51
    s_waitcnt lgkmcnt(6)
    v_mfma_f32_32x32x16_bf16 v[64:79], a[56:59], v[104:107], v[64:79]
    s_add_u32 m0, s37, 105984
    ds_read_b128 v[100:103], v31 offset:13312
    buffer_load_dwordx4 v1, s[16:19], m0 offen lds
    v_exp_f32_e64 v112, v112 clamp
    v_exp_f32_e64 v113, v113 clamp
    v_mfma_f32_32x32x16_bf16 v[64:79], a[60:63], v[108:111], v[64:79]
    ds_read_b128 v[104:107], v31 offset:14336
    v_exp_f32_e64 v114, v114 clamp
    v_exp_f32_e64 v115, v115 clamp
    v_fma_f32 v116, v116, v9, s24
    v_mfma_f32_32x32x16_bf16 v[64:79], a[64:67], v[80:83], v[64:79]
    ds_read_b128 v[108:111], v31 offset:15360
    v_fma_f32 v117, v117, v9, s24
    v_fma_f32 v118, v118, v9, s24
    v_fma_f32 v119, v119, v9, s24
    v_add_f32 v112, v112, v116
    s_waitcnt lgkmcnt(5)
    v_mfma_f32_32x32x16_bf16 v[64:79], a[68:71], v[84:87], v[64:79]
    s_waitcnt vmcnt(13)
    s_barrier
    s_add_u32 m0, s37, 110080
    ds_read_b128 v[80:83], v31 offset:16384
    buffer_load_dwordx4 v1, s[16:19], m0 offen lds
    v_mfma_f32_32x32x16_bf16 v[64:79], a[72:75], v[88:91], v[64:79]
    ds_read_b128 v[84:87], v31 offset:17408
    v_add_f32 v113, v113, v117
    v_add_f32 v114, v114, v118
    v_add_f32 v115, v115, v119
    v_cvt_pk_bf16_f32 v138, v112, v113
    v_cvt_pk_bf16_f32 v139, v114, v115
    v_mfma_f32_32x32x16_bf16 v[64:79], a[76:79], v[92:95], v[64:79]
    ds_read_b128 v[88:91], v31 offset:18432
    v_mul_f32 v112, v52, v4
    v_mul_f32 v113, v53, v4
    v_mul_f32 v114, v54, v4
    v_mul_f32 v115, v55, v4
    s_waitcnt lgkmcnt(4)
    v_mfma_f32_32x32x16_bf16 v[64:79], a[80:83], v[96:99], v[64:79]
    s_add_u32 m0, s37, 114176
    ds_read_b128 v[92:95], v31 offset:19456
    buffer_load_dwordx4 v1, s[16:19], m0 offen lds
    ds_write_b64 v33, v[138:139] offset:0
    v_max_f32 v116, 0, v52
    v_mfma_f32_32x32x16_bf16 v[64:79], a[84:87], v[100:103], v[64:79]
    ds_read_b128 v[96:99], v31 offset:20480
    v_max_f32 v117, 0, v53
    v_max_f32 v118, 0, v54
    v_max_f32 v119, 0, v55
    v_exp_f32_e64 v112, v112 clamp
    v_mfma_f32_32x32x16_bf16 v[64:79], a[88:91], v[104:107], v[64:79]
    ds_read_b128 v[100:103], v31 offset:21504
    v_exp_f32_e64 v113, v113 clamp
    v_exp_f32_e64 v114, v114 clamp
    s_waitcnt lgkmcnt(5)
    v_mfma_f32_32x32x16_bf16 v[64:79], a[92:95], v[108:111], v[64:79]
    s_add_u32 m0, s37, 118272
    ds_read_b128 v[104:107], v31 offset:22528
    buffer_load_dwordx4 v1, s[16:19], m0 offen lds
    v_exp_f32_e64 v115, v115 clamp
    v_fma_f32 v116, v116, v9, s24
    v_mfma_f32_32x32x16_bf16 v[64:79], a[96:99], v[80:83], v[64:79]
    ds_read_b128 v[108:111], v31 offset:23552
    v_fma_f32 v117, v117, v9, s24
    v_fma_f32 v118, v118, v9, s24
    v_fma_f32 v119, v119, v9, s24
    v_add_f32 v112, v112, v116
    v_add_f32 v113, v113, v117
    v_mfma_f32_32x32x16_bf16 v[64:79], a[100:103], v[84:87], v[64:79]
    ds_read_b128 v[80:83], v31 offset:24576
    v_add_f32 v114, v114, v118
    v_add_f32 v115, v115, v119
    v_cvt_pk_bf16_f32 v140, v112, v113
    v_cvt_pk_bf16_f32 v141, v114, v115
    s_waitcnt lgkmcnt(4)
    v_mfma_f32_32x32x16_bf16 v[64:79], a[104:107], v[88:91], v[64:79]
    s_add_u32 m0, s37, 122368
    ds_read_b128 v[84:87], v31 offset:25600
    buffer_load_dwordx4 v1, s[16:19], m0 offen lds
    v_mul_f32 v5, 0x3fb8aa3b, v11
    v_mfma_f32_32x32x16_bf16 v[64:79], a[108:111], v[92:95], v[64:79]
    ds_read_b128 v[88:91], v31 offset:26624
    ds_write_b64 v33, v[140:141] offset:8
    v_mfma_f32_32x32x16_bf16 v[64:79], a[112:115], v[96:99], v[64:79]
    ds_read_b128 v[92:95], v31 offset:27648
    s_waitcnt lgkmcnt(5)
    v_mfma_f32_32x32x16_bf16 v[64:79], a[116:119], v[100:103], v[64:79]
    s_add_u32 m0, s37, 126464
    ds_read_b128 v[96:99], v31 offset:28672
    buffer_load_dwordx4 v1, s[16:19], m0 offen lds
    v_mfma_f32_32x32x16_bf16 v[64:79], a[120:123], v[104:107], v[64:79]
    ds_read_b128 v[100:103], v31 offset:29696
    v_mfma_f32_32x32x16_bf16 v[64:79], a[124:127], v[108:111], v[64:79]
    ds_read_b128 v[104:107], v31 offset:30720
    s_waitcnt lgkmcnt(5)
    v_mfma_f32_32x32x16_bf16 v[64:79], a[128:131], v[80:83], v[64:79]
    s_add_u32 m0, s37, 130560
    s_nop 0
    buffer_load_dwordx4 v1, s[16:19], m0 offen lds
    v_mfma_f32_32x32x16_bf16 v[64:79], a[132:135], v[84:87], v[64:79]
    v_mfma_f32_32x32x16_bf16 v[64:79], a[136:139], v[88:91], v[64:79]
    s_waitcnt lgkmcnt(1)
    v_mfma_f32_32x32x16_bf16 v[64:79], a[140:143], v[92:95], v[64:79]
    s_add_u32 m0, s37, 134656
    s_nop 0
    buffer_load_dwordx4 v1, s[16:19], m0 offen lds
    v_mfma_f32_32x32x16_bf16 v[64:79], a[144:147], v[96:99], v[64:79]
    v_mfma_f32_32x32x16_bf16 v[64:79], a[148:151], v[100:103], v[64:79]
    s_waitcnt lgkmcnt(0)
    v_mfma_f32_32x32x16_bf16 v[64:79], a[152:155], v[104:107], v[64:79]
    v_mfma_f32_32x32x16_bf16 v[64:79], a[156:159], v[180:183], v[64:79]
    v_mfma_f32_32x32x16_bf16 v[64:79], v[12:15], v[10:13], v[64:79]
    s_barrier
    s_mul_i32 s34, s21, 131072
    s_add_u32 s34, s34, 46137344
    s_lshl_b32 s31, s20, 7
    s_add_u32 s35, s34, s31
    v_mov_b32 v136, 1073741824
    s_bitcmp1_b32 s3, 0
    s_cselect_b32 s30, 37888, 0
    v_add_u32 v40, s30, v39
    ds_read_b64_tr_b16 v[164:165], v40 offset:0
    ds_read_b64_tr_b16 v[166:167], v40 offset:4736
    ds_read_b64_tr_b16 v[152:153], v37 offset:0
    ds_read_b64_tr_b16 v[154:155], v37 offset:4736
    ds_read_b64_tr_b16 v[156:157], v38 offset:0
    ds_read_b64_tr_b16 v[158:159], v38 offset:4736
    v_pk_mul_f32 v[76:77], v[76:77], v[10:11] op_sel:[0,1] op_sel_hi:[1,1]
    v_pk_mul_f32 v[78:79], v[78:79], v[10:11] op_sel:[0,1] op_sel_hi:[1,1]
    v_cvt_pk_bf16_f32 v144, v76, v77
    v_cvt_pk_bf16_f32 v145, v78, v79
    ds_write_b64 v33, v[144:145] offset:9520
    v_pk_mul_f32 v[112:113], v[72:73], v[4:5] op_sel:[0,1] op_sel_hi:[1,1]
    v_pk_mul_f32 v[114:115], v[74:75], v[4:5] op_sel:[0,1] op_sel_hi:[1,1]
    v_max_f32 v116, s84, v72
    v_max_f32 v117, s84, v73
    v_max_f32 v118, s84, v74
    v_max_f32 v119, s84, v75
    v_exp_f32_e64 v112, v112 clamp
    v_exp_f32_e64 v113, v113 clamp
    v_exp_f32_e64 v114, v114 clamp
    v_exp_f32_e64 v115, v115 clamp
    v_pk_fma_f32 v[116:117], v[116:117], v[10:11], s[84:85] op_sel:[0,1,1] op_sel_hi:[1,1,1]
    v_pk_fma_f32 v[118:119], v[118:119], v[10:11], s[84:85] op_sel:[0,1,1] op_sel_hi:[1,1,1]
    v_pk_fma_f32 v[112:113], v[112:113], s[86:87], v[116:117] op_sel:[0,0,0] op_sel_hi:[1,0,1]
    v_pk_fma_f32 v[114:115], v[114:115], s[86:87], v[118:119] op_sel:[0,0,0] op_sel_hi:[1,0,1]
    v_cvt_pk_bf16_f32 v142, v112, v113
    v_cvt_pk_bf16_f32 v143, v114, v115
    v_cndmask_b32 v146, v142, v151, s[88:89]
    v_cndmask_b32 v147, v143, 0, s[88:89]
    ds_write_b64 v33, v[146:147] offset:9528
    v_cndmask_b32 v142, 0, v142, s[88:89]
    v_cndmask_b32 v143, 0, v143, s[88:89]
    ds_write_b64 v33, v[142:143] offset:9488
    v_pk_mul_f32 v[112:113], v[64:65], v[4:5] op_sel:[0,1] op_sel_hi:[1,1]
    v_pk_mul_f32 v[114:115], v[66:67], v[4:5] op_sel:[0,1] op_sel_hi:[1,1]
    v_max_f32 v116, 0, v64
    v_max_f32 v117, 0, v65
    v_max_f32 v118, 0, v66
    v_max_f32 v119, 0, v67
    v_exp_f32_e64 v112, v112 clamp
    v_exp_f32_e64 v113, v113 clamp
    v_exp_f32_e64 v114, v114 clamp
    v_exp_f32_e64 v115, v115 clamp
    v_pk_fma_f32 v[116:117], v[116:117], v[10:11], s[24:25] op_sel:[0,1,0] op_sel_hi:[1,1,0]
    v_pk_fma_f32 v[118:119], v[118:119], v[10:11], s[24:25] op_sel:[0,1,0] op_sel_hi:[1,1,0]
    v_pk_add_f32 v[112:113], v[112:113], v[116:117]
    v_pk_add_f32 v[114:115], v[114:115], v[118:119]
    v_cvt_pk_bf16_f32 v138, v112, v113
    v_cvt_pk_bf16_f32 v139, v114, v115
    ds_write_b64 v33, v[138:139] offset:9472
    v_pk_mul_f32 v[112:113], v[68:69], v[4:5] op_sel:[0,1] op_sel_hi:[1,1]
    v_pk_mul_f32 v[114:115], v[70:71], v[4:5] op_sel:[0,1] op_sel_hi:[1,1]
    v_max_f32 v116, 0, v68
    v_max_f32 v117, 0, v69
    v_max_f32 v118, 0, v70
    v_max_f32 v119, 0, v71
    v_exp_f32_e64 v112, v112 clamp
    v_exp_f32_e64 v113, v113 clamp
    v_exp_f32_e64 v114, v114 clamp
    v_exp_f32_e64 v115, v115 clamp
    v_pk_fma_f32 v[116:117], v[116:117], v[10:11], s[24:25] op_sel:[0,1,0] op_sel_hi:[1,1,0]
    v_pk_fma_f32 v[118:119], v[118:119], v[10:11], s[24:25] op_sel:[0,1,0] op_sel_hi:[1,1,0]
    v_pk_add_f32 v[112:113], v[112:113], v[116:117]
    v_pk_add_f32 v[114:115], v[114:115], v[118:119]
    v_cvt_pk_bf16_f32 v140, v112, v113
    v_cvt_pk_bf16_f32 v141, v114, v115
    ds_write_b64 v33, v[140:141] offset:9480
    s_waitcnt lgkmcnt(0)
    s_barrier
    ds_read_b64_tr_b16 v[92:93], v40 offset:9472
    ds_read_b64_tr_b16 v[94:95], v40 offset:14208
    ds_read_b64_tr_b16 v[80:81], v37 offset:9472
    ds_read_b64_tr_b16 v[82:83], v37 offset:14208
    ds_read_b64_tr_b16 v[84:85], v38 offset:9472
    ds_read_b64_tr_b16 v[86:87], v38 offset:14208
    v_mfma_f32_16x16x32_bf16 v[168:171], v[152:155], v[164:167], v[168:171]
    v_mfma_f32_16x16x32_bf16 v[172:175], v[156:159], v[164:167], v[172:175]
    s_waitcnt lgkmcnt(0)
    v_mfma_f32_16x16x32_bf16 v[168:171], v[80:83], v[92:95], v[168:171]
    v_mfma_f32_16x16x32_bf16 v[172:175], v[84:87], v[92:95], v[172:175]
    s_nop 6
    buffer_store_dwordx4 v[168:171], v188, s[8:11], s35 offen sc1
    buffer_store_dwordx4 v[172:175], v189, s[8:11], s35 offen sc1
    s_add_u32 m0, s37, 138752
    s_nop 0
    buffer_load_dwordx4 v1, s[16:19], m0 offen lds
    s_add_u32 m0, s37, 142848
    s_nop 0
    buffer_load_dwordx4 v1, s[16:19], m0 offen lds
    s_add_u32 m0, s37, 146944
    s_nop 0
    buffer_load_dwordx4 v1, s[16:19], m0 offen lds
    s_add_u32 m0, s37, 151040
    s_nop 0
    buffer_load_dwordx4 v1, s[16:19], m0 offen lds
    s_add_u32 m0, s37, 155136
    s_nop 0
    buffer_load_dwordx4 v1, s[16:19], m0 offen lds
    ds_read_b64 v[80:81], v47 offset:0
    ds_read_b64 v[82:83], v47 offset:8
    ds_read_b64 v[84:85], v47 offset:16
    v_mov_b32 v86, 0
    v_mov_b32 v87, 0
    ds_read_b64 v[92:93], v47 offset:128
    ds_read_b64 v[94:95], v47 offset:136
    ds_read_b64 v[96:97], v47 offset:144
    v_mov_b32 v98, 0
    v_mov_b32 v99, 0
    s_lshl_b32 s30, s3, 4
    s_add_u32 s30, s30, s20
    s_lshl_b32 s31, s30, 11
    s_add_u32 s34, s34, s31
    s_lshl_b32 s35, s21, 13
    s_add_u32 s35, s35, 52428800
    s_lshl_b32 s31, s30, 7
    s_add_u32 s36, s35, s31
    v_and_b32 v132, 7, v0
    v_lshrrev_b32 v133, 5, v0
    v_lshlrev_b32 v132, 3, v132
    v_lshl_add_u32 v132, v133, 2, v132
    v_bfe_u32 v133, v0, 3, 2
    v_lshl_add_u32 v138, v133, 17, v132
    v_add_u32 v141, 524288, v138
    v_lshrrev_b32 v132, 2, v0
    v_and_b32 v133, 3, v0
    v_lshlrev_b32 v133, 4, v133
    v_lshl_add_u32 v132, v132, 7, v133
    v_cmp_gt_u32 vcc, 36, v0
    s_nop 1
    v_cndmask_b32 v139, v136, v132, vcc
    s_mul_i32 s31, s3, 576
    s_add_u32 s35, s35, s31
    s_add_u32 s35, s35, s31
    s_lshr_b32 s32, s20, 1
    s_lshl_b32 s32, s32, 17
    s_add_u32 s35, s35, s32
    v_add_u32 v132, s31, v1
    v_add_u32 v133, 0x1000, v1
    v_cndmask_b32 v140, v133, v132, vcc
    v_mov_b32 v118, 0
    v_mov_b32 v119, 0
    v_mov_b32 v130, 0
    v_mov_b32 v131, 0
    s_cmp_ge_u32 s30, 36
    s_cbranch_scc1 pk_nored39
    s_nop 4
    s_sleep 12
pk_poll40:
    buffer_load_dwordx4 v[56:59], v1, s[8:11], s34 offen sc1
    buffer_load_dwordx4 v[60:63], v1, s[8:11], s34 offen offset:1024 sc1
    s_waitcnt vmcnt(0)
    v_max3_u32 v132, v56, v57, v58
    v_max3_u32 v132, v132, v59, v60
    v_max3_u32 v132, v132, v61, v62
    v_max_u32 v132, v132, v63
    v_cmp_eq_u32 vcc, -1, v132
    s_sub_u32 s22, s22, 1
    s_cbranch_scc1 pk_go41
    s_mov_b64 exec, vcc
    s_cbranch_vccnz pk_poll40
pk_go41:
    s_mov_b64 exec, -1
    s_max_i32 s22, s22, 0
    v_add_f32 v48, v56, v60
    v_add_f32 v49, v57, v61
    v_add_f32 v50, v58, v62
    v_add_f32 v51, v59, v63
    s_nop 0
    v_permlane32_swap_b32 v48, v50
    v_permlane32_swap_b32 v49, v51
    v_add_f32 v48, v48, v50
    v_add_f32 v49, v49, v51
    s_nop 0
    v_add_f32_dpp v50, v48, v48 row_ror:8 row_mask:0xf bank_mask:0xf
    v_add_f32_dpp v51, v49, v49 row_ror:8 row_mask:0xf bank_mask:0xf
    v_mov_b32 v48, v50
    v_mov_b32 v49, v51
    s_nop 0
    v_permlane16_swap_b32 v48, v50
    v_permlane16_swap_b32 v49, v51
    v_add_f32 v48, v48, v50
    v_add_f32 v49, v49, v51
    v_cvt_pk_bf16_f32 v48, v48, v49
    buffer_store_dword v48, v138, s[8:11], s36 offen sc1
    buffer_store_dword v48, v141, s[8:11], s36 offen sc1
pk_nored39:
    s_barrier
    s_nop 4
    s_sleep 14
pk_poll42:
    buffer_load_dwordx4 v[108:111], v139, s[8:11], s35 offen sc1
    s_waitcnt vmcnt(0)
    v_max3_u32 v132, v108, v109, v110
    v_max_u32 v132, v132, v111
    v_cmp_eq_u32 vcc, -1, v132
    s_sub_u32 s22, s22, 1
    s_cbranch_scc1 pk_go43
    s_mov_b64 exec, vcc
    s_cbranch_vccnz pk_poll42
pk_go43:
    s_mov_b64 exec, -1
    s_max_i32 s22, s22, 0
    ds_write_b128 v140, v[108:111]
    v_bfe_u32 v132, v0, 4, 1
    v_mul_u32_u24 v132, 20480, v132
    v_and_b32 v133, 15, v0
    v_lshl_add_u32 v132, v133, 4, v132
    v_lshrrev_b32 v133, 5, v0
    v_lshl_add_u32 v138, v133, 8, v132
    v_lshl_add_u32 v139, v133, 3, v132
    s_waitcnt lgkmcnt(0)
    s_barrier
    ds_read_b64 v[112:113], v45 offset:0
    ds_read_b64 v[114:115], v45 offset:64
    ds_read_b64 v[116:117], v45 offset:128
    ds_read_b64 v[124:125], v45 offset:1152
    ds_read_b64 v[126:127], v45 offset:1216
    ds_read_b64 v[128:129], v45 offset:1280
    s_lshl_b32 s30, s20, 2
    s_add_u32 s30, s30, s3
    s_mul_i32 s31, s30, 40960
    s_mul_i32 s32, s21, 1280
    s_add_u32 s31, s31, s32
    s_add_u32 s31, s31, 17825792
    s_lshl_b32 s30, s30, 11
    s_lshl_b32 s32, s21, 7
    s_add_u32 s30, s30, s32
    s_add_u32 s30, s30, 29491200
    v_mov_b32 v188, 2
    s_waitcnt lgkmcnt(4)
    v_mfma_f32_32x32x16_bf16 v[48:63], v[112:115], v[80:83], 0
    s_waitcnt lgkmcnt(1)
    v_mfma_f32_32x32x16_bf16 v[64:79], v[124:127], v[92:95], 0
    v_mfma_f32_32x32x16_bf16 v[48:63], v[116:119], v[84:87], v[48:63]
    s_waitcnt lgkmcnt(0)
    v_mfma_f32_32x32x16_bf16 v[64:79], v[128:131], v[96:99], v[64:79]
    s_nop 7
    s_nop 1
    v_add_f32 v58, s24, v58
    v_rcp_f32 v58, v58
    s_nop 0
    v_mov_b32 v59, v58
    v_pk_mul_f32 v[48:49], v[48:49], v[58:59]
    v_pk_mul_f32 v[50:51], v[50:51], v[58:59]
    v_pk_mul_f32 v[52:53], v[52:53], v[58:59]
    v_pk_mul_f32 v[54:55], v[54:55], v[58:59]
    v_pk_mul_f32 v[56:57], v[56:57], v[58:59]
    v_cvt_pk_bf16_f32 v140, v48, v49
    v_cvt_pk_bf16_f32 v141, v50, v51
    v_cvt_pk_bf16_f32 v142, v52, v53
    v_cvt_pk_bf16_f32 v143, v54, v55
    v_cvt_pk_bf16_f32 v148, v56, v57
    v_add_f32 v74, s24, v74
    v_rcp_f32 v74, v74
    s_nop 0
    v_mov_b32 v75, v74
    v_pk_mul_f32 v[64:65], v[64:65], v[74:75]
    v_pk_mul_f32 v[66:67], v[66:67], v[74:75]
    v_pk_mul_f32 v[68:69], v[68:69], v[74:75]
    v_pk_mul_f32 v[70:71], v[70:71], v[74:75]
    v_pk_mul_f32 v[72:73], v[72:73], v[74:75]
    v_cvt_pk_bf16_f32 v144, v64, v65
    v_cvt_pk_bf16_f32 v145, v66, v67
    v_cvt_pk_bf16_f32 v146, v68, v69
    v_cvt_pk_bf16_f32 v147, v70, v71
    v_cvt_pk_bf16_f32 v149, v72, v73
    s_cmp_eq_u32 s23, 0
    s_cbranch_scc1 pk_slow44
    buffer_store_dwordx4 v[140:143], v138, s[8:11], s31 offen
    buffer_store_dwordx4 v[144:147], v138, s[8:11], s31 offen offset:512
    buffer_store_dwordx2 v[148:149], v139, s[8:11], s31 offen offset:1024
    s_branch pk_join45
pk_slow44:
    buffer_store_dwordx4 v[140:143], v138, s[8:11], s31 offen sc1
    buffer_store_dwordx4 v[144:147], v138, s[8:11], s31 offen offset:512 sc1
    buffer_store_dwordx2 v[148:149], v139, s[8:11], s31 offen offset:1024 sc1
    s_nop 0
pk_join45:
    v_lshlrev_b32 v168, 16, v20
    v_and_b32 v169, 0xffff0000, v20
    v_lshlrev_b32 v170, 16, v21
    v_and_b32 v171, 0xffff0000, v21
    v_lshlrev_b32 v172, 16, v22
    v_and_b32 v173, 0xffff0000, v22
    v_lshlrev_b32 v174, 16, v23
    v_and_b32 v175, 0xffff0000, v23
    v_lshlrev_b32 v176, 16, v24
    v_and_b32 v177, 0xffff0000, v24
    v_lshlrev_b32 v178, 16, v25
    v_and_b32 v179, 0xffff0000, v25
    v_lshlrev_b32 v180, 16, v26
    v_and_b32 v181, 0xffff0000, v26
    v_lshlrev_b32 v182, 16, v27
    v_and_b32 v183, 0xffff0000, v27
    v_lshlrev_b32 v184, 16, v28
    v_and_b32 v185, 0xffff0000, v28
    v_lshlrev_b32 v186, 16, v29
    v_and_b32 v187, 0xffff0000, v29
    v_and_b32 v6, 15, v0
    v_lshlrev_b32 v6, 7, v6
    s_lshr_b32 s32, s27, 1
    s_lshl_b32 s32, s32, 11
    s_add_u32 s32, s32, 29491200
    s_mul_i32 s33, s27, 20480
    s_add_u32 s33, s33, 17825792
    s_waitcnt vmcnt(0)
    s_mov_b64 exec, 1
    s_cmp_eq_u32 s23, 0
    s_cbranch_scc1 pk_slow47
    buffer_store_dword v188, off, s[8:11], s30
    s_branch pk_join48
pk_slow47:
    buffer_store_dword v188, off, s[8:11], s30 sc1
    s_nop 0
pk_join48:
    s_mov_b64 exec, -1
    ds_read_b128 v[128:131], v1 offset:56832
    ds_read_b128 v[132:135], v1 offset:57856
    ds_read_b128 v[136:139], v1 offset:58880
    ds_read_b128 v[140:143], v1 offset:59904
    ds_read_b128 v[144:147], v1 offset:60928
    ds_read_b128 v[148:151], v1 offset:61952
    ds_read_b128 v[152:155], v1 offset:62976
    ds_read_b128 v[156:159], v1 offset:64000
    ds_read_b128 v[160:163], v1 offset:65024
    s_nop 4
pk_poll49:
    buffer_load_dword v189, v6, s[8:11], s32 offen sc1
    s_waitcnt vmcnt(0)
    v_cmp_ne_u32 vcc, 2, v189
    s_sub_u32 s22, s22, 1
    s_cbranch_scc1 pk_go50
    s_mov_b64 exec, vcc
    s_cbranch_vccnz pk_poll49
pk_go50:
    s_mov_b64 exec, -1
    s_max_i32 s22, s22, 0
    buffer_load_dwordx4 v[48:51], v1, s[8:11], s33 offen offset:0 sc1
    buffer_load_dwordx4 v[52:55], v1, s[8:11], s33 offen offset:1024 sc1
    buffer_load_dwordx4 v[56:59], v1, s[8:11], s33 offen offset:2048 sc1
    buffer_load_dwordx4 v[60:63], v1, s[8:11], s33 offen offset:3072 sc1
    s_add_u32 s33, s33, 4096
    buffer_load_dwordx4 v[64:67], v1, s[8:11], s33 offen offset:0 sc1
    buffer_load_dwordx4 v[68:71], v1, s[8:11], s33 offen offset:1024 sc1
    buffer_load_dwordx4 v[72:75], v1, s[8:11], s33 offen offset:2048 sc1
    buffer_load_dwordx4 v[76:79], v1, s[8:11], s33 offen offset:3072 sc1
    s_add_u32 s33, s33, 4096
    buffer_load_dwordx4 v[80:83], v1, s[8:11], s33 offen offset:0 sc1
    buffer_load_dwordx4 v[84:87], v1, s[8:11], s33 offen offset:1024 sc1
    buffer_load_dwordx4 v[88:91], v1, s[8:11], s33 offen offset:2048 sc1
    buffer_load_dwordx4 v[92:95], v1, s[8:11], s33 offen offset:3072 sc1
    s_add_u32 s33, s33, 4096
    buffer_load_dwordx4 v[96:99], v1, s[8:11], s33 offen offset:0 sc1
    buffer_load_dwordx4 v[100:103], v1, s[8:11], s33 offen offset:1024 sc1
    buffer_load_dwordx4 v[104:107], v1, s[8:11], s33 offen offset:2048 sc1
    buffer_load_dwordx4 v[108:111], v1, s[8:11], s33 offen offset:3072 sc1
    s_add_u32 s33, s33, 4096
    buffer_load_dwordx4 v[112:115], v1, s[8:11], s33 offen offset:0 sc1
    buffer_load_dwordx4 v[116:119], v1, s[8:11], s33 offen offset:1024 sc1
    buffer_load_dwordx4 v[120:123], v1, s[8:11], s33 offen offset:2048 sc1
    buffer_load_dwordx4 v[124:127], v1, s[8:11], s33 offen offset:3072 sc1
    s_bfe_u32 s30, s27, 0x20001
    s_mul_i32 s30, s30, 40960
    s_mul_i32 s31, s28, 5120
    s_add_u32 s30, s30, s31
    s_lshl_b32 s31, s27, 10
    s_lshl_b32 s32, s28, 7
    s_add_u32 s31, s31, s32
    s_add_u32 s31, s31, 29360128
    v_lshlrev_b32 v6, 3, v0
    s_waitcnt vmcnt(19)
    ds_read_b128 v[164:167], v30 offset:512
    s_waitcnt lgkmcnt(9)
    v_mfma_f32_16x16x32_bf16 v[168:171], v[128:131], v[48:51], v[168:171]
    ds_read_b128 v[128:131], v30 offset:1536
    s_waitcnt lgkmcnt(9)
    v_mfma_f32_16x16x32_bf16 v[172:175], v[132:135], v[48:51], v[172:175]
    ds_read_b128 v[132:135], v30 offset:2560
    s_waitcnt lgkmcnt(9)
    v_mfma_f32_16x16x32_bf16 v[176:179], v[136:139], v[48:51], v[176:179]
    ds_read_b128 v[136:139], v30 offset:3584
    s_waitcnt lgkmcnt(9)
    v_mfma_f32_16x16x32_bf16 v[180:183], v[140:143], v[48:51], v[180:183]
    ds_read_b128 v[140:143], v30 offset:4608
    s_waitcnt lgkmcnt(9)
    v_mfma_f32_16x16x32_bf16 v[184:187], v[144:147], v[48:51], v[184:187]
    s_waitcnt vmcnt(18)
    ds_read_b128 v[144:147], v30 offset:5632
    s_waitcnt lgkmcnt(9)
    v_mfma_f32_16x16x32_bf16 v[168:171], v[148:151], v[52:55], v[168:171]
    ds_read_b128 v[148:151], v30 offset:6656
    s_waitcnt lgkmcnt(9)
    v_mfma_f32_16x16x32_bf16 v[172:175], v[152:155], v[52:55], v[172:175]
    ds_read_b128 v[152:155], v30 offset:7680
    s_waitcnt lgkmcnt(9)
    v_mfma_f32_16x16x32_bf16 v[176:179], v[156:159], v[52:55], v[176:179]
    ds_read_b128 v[156:159], v30 offset:8704
    s_waitcnt lgkmcnt(9)
    v_mfma_f32_16x16x32_bf16 v[180:183], v[160:163], v[52:55], v[180:183]
    ds_read_b128 v[160:163], v30 offset:9728
    s_waitcnt lgkmcnt(9)
    v_mfma_f32_16x16x32_bf16 v[184:187], v[164:167], v[52:55], v[184:187]
    s_waitcnt vmcnt(17)
    ds_read_b128 v[164:167], v30 offset:10752
    s_waitcnt lgkmcnt(9)
    v_mfma_f32_16x16x32_bf16 v[168:171], v[128:131], v[56:59], v[168:171]
    ds_read_b128 v[128:131], v30 offset:11776
    s_waitcnt lgkmcnt(9)
    v_mfma_f32_16x16x32_bf16 v[172:175], v[132:135], v[56:59], v[172:175]
    ds_read_b128 v[132:135], v30 offset:12800
    s_waitcnt lgkmcnt(9)
    v_mfma_f32_16x16x32_bf16 v[176:179], v[136:139], v[56:59], v[176:179]
    ds_read_b128 v[136:139], v30 offset:13824
    s_waitcnt lgkmcnt(9)
    v_mfma_f32_16x16x32_bf16 v[180:183], v[140:143], v[56:59], v[180:183]
    ds_read_b128 v[140:143], v30 offset:14848
    s_waitcnt lgkmcnt(9)
    v_mfma_f32_16x16x32_bf16 v[184:187], v[144:147], v[56:59], v[184:187]
    s_waitcnt vmcnt(16)
    ds_read_b128 v[144:147], v30 offset:15872
    s_waitcnt lgkmcnt(9)
    v_mfma_f32_16x16x32_bf16 v[168:171], v[148:151], v[60:63], v[168:171]
    ds_read_b128 v[148:151], v30 offset:16896
    s_waitcnt lgkmcnt(9)
    v_mfma_f32_16x16x32_bf16 v[172:175], v[152:155], v[60:63], v[172:175]
    ds_read_b128 v[152:155], v30 offset:17920
    s_waitcnt lgkmcnt(9)
    v_mfma_f32_16x16x32_bf16 v[176:179], v[156:159], v[60:63], v[176:179]
    ds_read_b128 v[156:159], v30 offset:18944
    s_waitcnt lgkmcnt(9)
    v_mfma_f32_16x16x32_bf16 v[180:183], v[160:163], v[60:63], v[180:183]
    ds_read_b128 v[160:163], v30 offset:19968
    s_waitcnt lgkmcnt(9)
    v_mfma_f32_16x16x32_bf16 v[184:187], v[164:167], v[60:63], v[184:187]
    s_waitcnt vmcnt(15)
    ds_read_b128 v[164:167], v30 offset:20992
    s_waitcnt lgkmcnt(9)
    v_mfma_f32_16x16x32_bf16 v[168:171], v[128:131], v[64:67], v[168:171]
    ds_read_b128 v[128:131], v30 offset:22016
    s_waitcnt lgkmcnt(9)
    v_mfma_f32_16x16x32_bf16 v[172:175], v[132:135], v[64:67], v[172:175]
    ds_read_b128 v[132:135], v30 offset:23040
    s_waitcnt lgkmcnt(9)
    v_mfma_f32_16x16x32_bf16 v[176:179], v[136:139], v[64:67], v[176:179]
    ds_read_b128 v[136:139], v30 offset:24064
    s_waitcnt lgkmcnt(9)
    v_mfma_f32_16x16x32_bf16 v[180:183], v[140:143], v[64:67], v[180:183]
    ds_read_b128 v[140:143], v30 offset:25088
    s_waitcnt lgkmcnt(9)
    v_mfma_f32_16x16x32_bf16 v[184:187], v[144:147], v[64:67], v[184:187]
    s_waitcnt vmcnt(14)
    ds_read_b128 v[144:147], v30 offset:26112
    s_waitcnt lgkmcnt(9)
    v_mfma_f32_16x16x32_bf16 v[168:171], v[148:151], v[68:71], v[168:171]
    ds_read_b128 v[148:151], v30 offset:27136
    s_waitcnt lgkmcnt(9)
    v_mfma_f32_16x16x32_bf16 v[172:175], v[152:155], v[68:71], v[172:175]
    ds_read_b128 v[152:155], v30 offset:28160
    s_waitcnt lgkmcnt(9)
    v_mfma_f32_16x16x32_bf16 v[176:179], v[156:159], v[68:71], v[176:179]
    ds_read_b128 v[156:159], v30 offset:29184
    s_waitcnt lgkmcnt(9)
    v_mfma_f32_16x16x32_bf16 v[180:183], v[160:163], v[68:71], v[180:183]
    ds_read_b128 v[160:163], v30 offset:30208
    s_waitcnt lgkmcnt(9)
    v_mfma_f32_16x16x32_bf16 v[184:187], v[164:167], v[68:71], v[184:187]
    s_waitcnt vmcnt(13)
    ds_read_b128 v[164:167], v30 offset:31232
    s_waitcnt lgkmcnt(9)
    v_mfma_f32_16x16x32_bf16 v[168:171], v[128:131], v[72:75], v[168:171]
    ds_read_b128 v[128:131], v30 offset:32256
    s_waitcnt lgkmcnt(9)
    v_mfma_f32_16x16x32_bf16 v[172:175], v[132:135], v[72:75], v[172:175]
    ds_read_b128 v[132:135], v30 offset:33280
    s_waitcnt lgkmcnt(9)
    v_mfma_f32_16x16x32_bf16 v[176:179], v[136:139], v[72:75], v[176:179]
    ds_read_b128 v[136:139], v30 offset:34304
    s_waitcnt lgkmcnt(9)
    v_mfma_f32_16x16x32_bf16 v[180:183], v[140:143], v[72:75], v[180:183]
    ds_read_b128 v[140:143], v30 offset:35328
    s_waitcnt lgkmcnt(9)
    v_mfma_f32_16x16x32_bf16 v[184:187], v[144:147], v[72:75], v[184:187]
    s_waitcnt vmcnt(12)
    ds_read_b128 v[144:147], v30 offset:36352
    s_waitcnt lgkmcnt(9)
    v_mfma_f32_16x16x32_bf16 v[168:171], v[148:151], v[76:79], v[168:171]
    ds_read_b128 v[148:151], v30 offset:37376
    s_waitcnt lgkmcnt(9)
    v_mfma_f32_16x16x32_bf16 v[172:175], v[152:155], v[76:79], v[172:175]
    ds_read_b128 v[152:155], v30 offset:38400
    s_waitcnt lgkmcnt(9)
    v_mfma_f32_16x16x32_bf16 v[176:179], v[156:159], v[76:79], v[176:179]
    ds_read_b128 v[156:159], v30 offset:39424
    s_waitcnt lgkmcnt(9)
    v_mfma_f32_16x16x32_bf16 v[180:183], v[160:163], v[76:79], v[180:183]
    ds_read_b128 v[160:163], v30 offset:40448
    s_waitcnt lgkmcnt(9)
    v_mfma_f32_16x16x32_bf16 v[184:187], v[164:167], v[76:79], v[184:187]
    s_waitcnt vmcnt(11)
    ds_read_b128 v[164:167], v30 offset:41472
    s_waitcnt lgkmcnt(9)
    v_mfma_f32_16x16x32_bf16 v[168:171], v[128:131], v[80:83], v[168:171]
    ds_read_b128 v[128:131], v30 offset:42496
    s_waitcnt lgkmcnt(9)
    v_mfma_f32_16x16x32_bf16 v[172:175], v[132:135], v[80:83], v[172:175]
    ds_read_b128 v[132:135], v30 offset:43520
    s_waitcnt lgkmcnt(9)
    v_mfma_f32_16x16x32_bf16 v[176:179], v[136:139], v[80:83], v[176:179]
    ds_read_b128 v[136:139], v30 offset:44544
    s_waitcnt lgkmcnt(9)
    v_mfma_f32_16x16x32_bf16 v[180:183], v[140:143], v[80:83], v[180:183]
    ds_read_b128 v[140:143], v30 offset:45568
    s_waitcnt lgkmcnt(9)
    v_mfma_f32_16x16x32_bf16 v[184:187], v[144:147], v[80:83], v[184:187]
    s_waitcnt vmcnt(10)
    ds_read_b128 v[144:147], v30 offset:46592
    s_waitcnt lgkmcnt(9)
    v_mfma_f32_16x16x32_bf16 v[168:171], v[148:151], v[84:87], v[168:171]
    ds_read_b128 v[148:151], v30 offset:47616
    s_waitcnt lgkmcnt(9)
    v_mfma_f32_16x16x32_bf16 v[172:175], v[152:155], v[84:87], v[172:175]
    ds_read_b128 v[152:155], v30 offset:48640
    s_waitcnt lgkmcnt(9)
    v_mfma_f32_16x16x32_bf16 v[176:179], v[156:159], v[84:87], v[176:179]
    ds_read_b128 v[156:159], v30 offset:49664
    s_waitcnt lgkmcnt(9)
    v_mfma_f32_16x16x32_bf16 v[180:183], v[160:163], v[84:87], v[180:183]
    ds_read_b128 v[160:163], v30 offset:50688
    s_waitcnt lgkmcnt(9)
    v_mfma_f32_16x16x32_bf16 v[184:187], v[164:167], v[84:87], v[184:187]
    s_waitcnt vmcnt(9)
    ds_read_b128 v[164:167], v30 offset:51712
    s_waitcnt lgkmcnt(9)
    v_mfma_f32_16x16x32_bf16 v[168:171], v[128:131], v[88:91], v[168:171]
    ds_read_b128 v[128:131], v30 offset:52736
    s_waitcnt lgkmcnt(9)
    v_mfma_f32_16x16x32_bf16 v[172:175], v[132:135], v[88:91], v[172:175]
    ds_read_b128 v[132:135], v30 offset:53760
    s_waitcnt lgkmcnt(9)
    v_mfma_f32_16x16x32_bf16 v[176:179], v[136:139], v[88:91], v[176:179]
    ds_read_b128 v[136:139], v30 offset:54784
    s_waitcnt lgkmcnt(9)
    v_mfma_f32_16x16x32_bf16 v[180:183], v[140:143], v[88:91], v[180:183]
    ds_read_b128 v[140:143], v30 offset:55808
    s_waitcnt lgkmcnt(9)
    v_mfma_f32_16x16x32_bf16 v[184:187], v[144:147], v[88:91], v[184:187]
    s_waitcnt vmcnt(8)
    ds_read_b128 v[144:147], v30 offset:56832
    s_waitcnt lgkmcnt(9)
    v_mfma_f32_16x16x32_bf16 v[168:171], v[148:151], v[92:95], v[168:171]
    ds_read_b128 v[148:151], v30 offset:57856
    s_waitcnt lgkmcnt(9)
    v_mfma_f32_16x16x32_bf16 v[172:175], v[152:155], v[92:95], v[172:175]
    ds_read_b128 v[152:155], v30 offset:58880
    s_waitcnt lgkmcnt(9)
    v_mfma_f32_16x16x32_bf16 v[176:179], v[156:159], v[92:95], v[176:179]
    ds_read_b128 v[156:159], v30 offset:59904
    s_waitcnt lgkmcnt(9)
    v_mfma_f32_16x16x32_bf16 v[180:183], v[160:163], v[92:95], v[180:183]
    ds_read_b128 v[160:163], v30 offset:60928
    s_waitcnt lgkmcnt(9)
    v_mfma_f32_16x16x32_bf16 v[184:187], v[164:167], v[92:95], v[184:187]
    s_waitcnt vmcnt(7)
    ds_read_b128 v[164:167], v30 offset:61952
    s_waitcnt lgkmcnt(9)
    v_mfma_f32_16x16x32_bf16 v[168:171], v[128:131], v[96:99], v[168:171]
    ds_read_b128 v[128:131], v30 offset:62976
    s_waitcnt lgkmcnt(9)
    v_mfma_f32_16x16x32_bf16 v[172:175], v[132:135], v[96:99], v[172:175]
    ds_read_b128 v[132:135], v30 offset:64000
    s_waitcnt lgkmcnt(9)
    v_mfma_f32_16x16x32_bf16 v[176:179], v[136:139], v[96:99], v[176:179]
    ds_read_b128 v[136:139], v30 offset:65024
    s_waitcnt lgkmcnt(9)
    v_mfma_f32_16x16x32_bf16 v[180:183], v[140:143], v[96:99], v[180:183]
    ds_read_b128 v[140:143], v31 offset:512
    s_waitcnt lgkmcnt(9)
    v_mfma_f32_16x16x32_bf16 v[184:187], v[144:147], v[96:99], v[184:187]
    s_waitcnt vmcnt(6)
    ds_read_b128 v[144:147], v31 offset:1536
    s_waitcnt lgkmcnt(9)
    v_mfma_f32_16x16x32_bf16 v[168:171], v[148:151], v[100:103], v[168:171]
    ds_read_b128 v[148:151], v31 offset:2560
    s_waitcnt lgkmcnt(9)
    v_mfma_f32_16x16x32_bf16 v[172:175], v[152:155], v[100:103], v[172:175]
    ds_read_b128 v[152:155], v31 offset:3584
    s_waitcnt lgkmcnt(9)
    v_mfma_f32_16x16x32_bf16 v[176:179], v[156:159], v[100:103], v[176:179]
    ds_read_b128 v[156:159], v31 offset:4608
    s_waitcnt lgkmcnt(9)
    v_mfma_f32_16x16x32_bf16 v[180:183], v[160:163], v[100:103], v[180:183]
    ds_read_b128 v[160:163], v31 offset:5632
    s_waitcnt lgkmcnt(9)
    v_mfma_f32_16x16x32_bf16 v[184:187], v[164:167], v[100:103], v[184:187]
    s_waitcnt vmcnt(5)
    ds_read_b128 v[164:167], v31 offset:6656
    s_waitcnt lgkmcnt(9)
    v_mfma_f32_16x16x32_bf16 v[168:171], v[128:131], v[104:107], v[168:171]
    ds_read_b128 v[128:131], v31 offset:7680
    s_waitcnt lgkmcnt(9)
    v_mfma_f32_16x16x32_bf16 v[172:175], v[132:135], v[104:107], v[172:175]
    ds_read_b128 v[132:135], v31 offset:8704
    s_waitcnt lgkmcnt(9)
    v_mfma_f32_16x16x32_bf16 v[176:179], v[136:139], v[104:107], v[176:179]
    ds_read_b128 v[136:139], v31 offset:9728
    s_waitcnt lgkmcnt(9)
    v_mfma_f32_16x16x32_bf16 v[180:183], v[140:143], v[104:107], v[180:183]
    ds_read_b128 v[140:143], v31 offset:10752
    s_waitcnt lgkmcnt(9)
    v_mfma_f32_16x16x32_bf16 v[184:187], v[144:147], v[104:107], v[184:187]
    s_waitcnt vmcnt(4)
    ds_read_b128 v[144:147], v31 offset:11776
    s_waitcnt lgkmcnt(9)
    v_mfma_f32_16x16x32_bf16 v[168:171], v[148:151], v[108:111], v[168:171]
    ds_read_b128 v[148:151], v31 offset:12800
    s_waitcnt lgkmcnt(9)
    v_mfma_f32_16x16x32_bf16 v[172:175], v[152:155], v[108:111], v[172:175]
    ds_read_b128 v[152:155], v31 offset:13824
    s_waitcnt lgkmcnt(9)
    v_mfma_f32_16x16x32_bf16 v[176:179], v[156:159], v[108:111], v[176:179]
    ds_read_b128 v[156:159], v31 offset:14848
    s_waitcnt lgkmcnt(9)
    v_mfma_f32_16x16x32_bf16 v[180:183], v[160:163], v[108:111], v[180:183]
    ds_read_b128 v[160:163], v31 offset:15872
    s_waitcnt lgkmcnt(9)
    v_mfma_f32_16x16x32_bf16 v[184:187], v[164:167], v[108:111], v[184:187]
    s_waitcnt vmcnt(3)
    ds_read_b128 v[164:167], v31 offset:16896
    s_waitcnt lgkmcnt(9)
    v_mfma_f32_16x16x32_bf16 v[168:171], v[128:131], v[112:115], v[168:171]
    ds_read_b128 v[128:131], v31 offset:17920
    s_waitcnt lgkmcnt(9)
    v_mfma_f32_16x16x32_bf16 v[172:175], v[132:135], v[112:115], v[172:175]
    ds_read_b128 v[132:135], v31 offset:18944
    s_waitcnt lgkmcnt(9)
    v_mfma_f32_16x16x32_bf16 v[176:179], v[136:139], v[112:115], v[176:179]
    ds_read_b128 v[136:139], v31 offset:19968
    s_waitcnt lgkmcnt(9)
    v_mfma_f32_16x16x32_bf16 v[180:183], v[140:143], v[112:115], v[180:183]
    ds_read_b128 v[140:143], v31 offset:20992
    s_waitcnt lgkmcnt(9)
    v_mfma_f32_16x16x32_bf16 v[184:187], v[144:147], v[112:115], v[184:187]
    s_waitcnt vmcnt(2)
    ds_read_b128 v[144:147], v31 offset:22016
    s_waitcnt lgkmcnt(9)
    v_mfma_f32_16x16x32_bf16 v[168:171], v[148:151], v[116:119], v[168:171]
    ds_read_b128 v[148:151], v31 offset:23040
    s_waitcnt lgkmcnt(9)
    v_mfma_f32_16x16x32_bf16 v[172:175], v[152:155], v[116:119], v[172:175]
    ds_read_b128 v[152:155], v31 offset:24064
    s_waitcnt lgkmcnt(9)
    v_mfma_f32_16x16x32_bf16 v[176:179], v[156:159], v[116:119], v[176:179]
    ds_read_b128 v[156:159], v31 offset:25088
    s_waitcnt lgkmcnt(9)
    v_mfma_f32_16x16x32_bf16 v[180:183], v[160:163], v[116:119], v[180:183]
    ds_read_b128 v[160:163], v31 offset:26112
    s_waitcnt lgkmcnt(9)
    v_mfma_f32_16x16x32_bf16 v[184:187], v[164:167], v[116:119], v[184:187]
    s_waitcnt vmcnt(1)
    ds_read_b128 v[164:167], v31 offset:27136
    s_waitcnt lgkmcnt(9)
    v_mfma_f32_16x16x32_bf16 v[168:171], v[128:131], v[120:123], v[168:171]
    s_waitcnt lgkmcnt(8)
    v_mfma_f32_16x16x32_bf16 v[172:175], v[132:135], v[120:123], v[172:175]
    s_waitcnt lgkmcnt(7)
    v_mfma_f32_16x16x32_bf16 v[176:179], v[136:139], v[120:123], v[176:179]
    s_waitcnt lgkmcnt(6)
    v_mfma_f32_16x16x32_bf16 v[180:183], v[140:143], v[120:123], v[180:183]
    s_waitcnt lgkmcnt(5)
    v_mfma_f32_16x16x32_bf16 v[184:187], v[144:147], v[120:123], v[184:187]
    s_waitcnt vmcnt(0)
    s_waitcnt lgkmcnt(4)
    v_mfma_f32_16x16x32_bf16 v[168:171], v[148:151], v[124:127], v[168:171]
    s_waitcnt lgkmcnt(3)
    v_mfma_f32_16x16x32_bf16 v[172:175], v[152:155], v[124:127], v[172:175]
    s_waitcnt lgkmcnt(2)
    v_mfma_f32_16x16x32_bf16 v[176:179], v[156:159], v[124:127], v[176:179]
    s_waitcnt lgkmcnt(1)
    v_mfma_f32_16x16x32_bf16 v[180:183], v[160:163], v[124:127], v[180:183]
    s_waitcnt lgkmcnt(0)
    v_mfma_f32_16x16x32_bf16 v[184:187], v[164:167], v[124:127], v[184:187]
    v_cvt_pk_bf16_f32 v20, v168, v169
    v_cvt_pk_bf16_f32 v21, v170, v171
    v_cvt_pk_bf16_f32 v22, v172, v173
    v_cvt_pk_bf16_f32 v23, v174, v175
    v_cvt_pk_bf16_f32 v24, v176, v177
    v_cvt_pk_bf16_f32 v25, v178, v179
    v_cvt_pk_bf16_f32 v26, v180, v181
    v_cvt_pk_bf16_f32 v27, v182, v183
    v_cvt_pk_bf16_f32 v28, v184, v185
    v_cvt_pk_bf16_f32 v29, v186, v187
    s_cmp_eq_u32 s23, 0
    s_cbranch_scc1 pk_slow51
    buffer_store_dwordx4 v[20:23], v43, s[12:15], s30 offen
    buffer_store_dwordx4 v[24:27], v43, s[12:15], s30 offen offset:2048
    buffer_store_dwordx2 v[28:29], v44, s[12:15], s30 offen
    s_branch pk_join52
pk_slow51:
    buffer_store_dwordx4 v[20:23], v43, s[12:15], s30 offen sc1
    buffer_store_dwordx4 v[24:27], v43, s[12:15], s30 offen offset:2048 sc1
    buffer_store_dwordx2 v[28:29], v44, s[12:15], s30 offen sc1
    s_nop 0
pk_join52:
    v_lshlrev_b32 v48, 16, v20
    v_and_b32 v49, 0xffff0000, v20
    v_lshlrev_b32 v50, 16, v21
    v_and_b32 v51, 0xffff0000, v21
    v_lshlrev_b32 v52, 16, v22
    v_and_b32 v53, 0xffff0000, v22
    v_lshlrev_b32 v54, 16, v23
    v_and_b32 v55, 0xffff0000, v23
    v_lshlrev_b32 v56, 16, v24
    v_and_b32 v57, 0xffff0000, v24
    v_lshlrev_b32 v58, 16, v25
    v_and_b32 v59, 0xffff0000, v25
    v_lshlrev_b32 v60, 16, v26
    v_and_b32 v61, 0xffff0000, v26
    v_lshlrev_b32 v62, 16, v27
    v_and_b32 v63, 0xffff0000, v27
    v_lshlrev_b32 v64, 16, v28
    v_and_b32 v65, 0xffff0000, v28
    v_lshlrev_b32 v66, 16, v29
    v_and_b32 v67, 0xffff0000, v29
    v_pk_add_f32 v[68:69], v[48:49], v[50:51]
    v_pk_add_f32 v[70:71], v[52:53], v[54:55]
    v_pk_add_f32 v[68:69], v[68:69], v[56:57]
    v_pk_add_f32 v[70:71], v[70:71], v[58:59]
    v_pk_add_f32 v[68:69], v[68:69], v[60:61]
    v_pk_add_f32 v[70:71], v[70:71], v[62:63]
    v_pk_add_f32 v[68:69], v[68:69], v[64:65]
    v_pk_add_f32 v[70:71], v[70:71], v[66:67]
    v_pk_add_f32 v[68:69], v[68:69], v[70:71]
    v_add_f32 v68, v68, v69
    v_mov_b32 v69, v68
    s_nop 1
    v_permlane16_swap_b32 v68, v69
    v_add_f32 v68, v68, v69
    v_mov_b32 v69, v68
    s_nop 1
    v_permlane32_swap_b32 v68, v69
    v_add_f32 v68, v68, v69
    v_mul_f32 v68, 0x3c4ccccd, v68
    v_mul_f32 v70, -1.0, v68
    v_mul_f32 v71, -1.0, v68
    v_pk_add_f32 v[48:49], v[48:49], v[70:71]
    v_pk_add_f32 v[50:51], v[50:51], v[70:71]
    v_pk_add_f32 v[52:53], v[52:53], v[70:71]
    v_pk_add_f32 v[54:55], v[54:55], v[70:71]
    v_pk_add_f32 v[56:57], v[56:57], v[70:71]
    v_pk_add_f32 v[58:59], v[58:59], v[70:71]
    v_pk_add_f32 v[60:61], v[60:61], v[70:71]
    v_pk_add_f32 v[62:63], v[62:63], v[70:71]
    v_pk_add_f32 v[64:65], v[64:65], v[70:71]
    v_pk_add_f32 v[66:67], v[66:67], v[70:71]
    v_pk_mul_f32 v[70:71], v[48:49], v[48:49]
    v_pk_mul_f32 v[72:73], v[50:51], v[50:51]
    v_pk_fma_f32 v[70:71], v[52:53], v[52:53], v[70:71]
    v_pk_fma_f32 v[72:73], v[54:55], v[54:55], v[72:73]
    v_pk_fma_f32 v[70:71], v[56:57], v[56:57], v[70:71]
    v_pk_fma_f32 v[72:73], v[58:59], v[58:59], v[72:73]
    v_pk_fma_f32 v[70:71], v[60:61], v[60:61], v[70:71]
    v_pk_fma_f32 v[72:73], v[62:63], v[62:63], v[72:73]
    v_pk_fma_f32 v[70:71], v[64:65], v[64:65], v[70:71]
    v_pk_fma_f32 v[72:73], v[66:67], v[66:67], v[72:73]
    v_pk_add_f32 v[70:71], v[70:71], v[72:73]
    v_add_f32 v69, v70, v71
    v_mov_b32 v70, v69
    s_nop 1
    v_permlane16_swap_b32 v69, v70
    v_add_f32 v69, v69, v70
    v_mov_b32 v70, v69
    s_nop 1
    v_permlane32_swap_b32 v69, v70
    v_add_f32 v69, v69, v70
    v_bfi_b32 v68, 15, 7, v68
    v_bfi_b32 v69, 15, 7, v69
    v_mov_b32 v151, 0x3f80
    v_mov_b32 v184, -1
    v_mov_b32 v185, -1
    v_mov_b32 v186, -1
    v_mov_b32 v187, -1
    s_waitcnt vmcnt(0)
    s_mov_b64 exec, 0xffff
    s_cmp_eq_u32 s23, 0
    s_cbranch_scc1 pk_slow53
    buffer_store_dwordx2 v[68:69], v6, s[8:11], s31 offen
    s_branch pk_join54
pk_slow53:
    buffer_store_dwordx2 v[68:69], v6, s[8:11], s31 offen sc1
    s_nop 0
pk_join54:
    s_mov_b64 exec, -1
    s_lshl_b32 s31, s20, 13
    s_add_u32 s31, s31, s25
    s_add_u32 s31, s31, 29360128
    s_nop 4
pk_poll55:
    buffer_load_dwordx2 v[112:113], v42, s[8:11], s31 offen offset:0 sc1
    buffer_load_dwordx2 v[114:115], v42, s[8:11], s31 offen offset:128 sc1
    buffer_load_dwordx2 v[116:117], v42, s[8:11], s31 offen offset:256 sc1
    buffer_load_dwordx2 v[118:119], v42, s[8:11], s31 offen offset:384 sc1
    s_waitcnt vmcnt(0)
    v_or3_b32 v132, v112, v113, v114
    v_or3_b32 v133, v115, v116, v117
    v_or3_b32 v132, v132, v118, v119
    v_or_b32 v132, v132, v133
    v_and_b32 v132, 8, v132
    v_cmp_ne_u32 vcc, 0, v132
    s_sub_u32 s22, s22, 1
    s_cbranch_scc1 pk_go56
    s_mov_b64 exec, vcc
    s_cbranch_vccnz pk_poll55
pk_go56:
    s_mov_b64 exec, -1
    s_max_i32 s22, s22, 0
    s_barrier
    s_add_u32 m0, s37, 0
    s_nop 0
    buffer_load_dwordx4 v1, s[12:15], m0 offen sc1 lds
    s_add_u32 m0, s37, 4096
    s_nop 0
    buffer_load_dwordx4 v1, s[12:15], m0 offen sc1 lds
    s_add_u32 m0, s37, 8192
    s_nop 0
    buffer_load_dwordx4 v1, s[12:15], m0 offen sc1 lds
    s_add_u32 m0, s37, 12288
    s_nop 0
    buffer_load_dwordx4 v1, s[12:15], m0 offen sc1 lds
    s_add_u32 m0, s37, 16384
    s_nop 0
    buffer_load_dwordx4 v1, s[12:15], m0 offen sc1 lds
    s_add_u32 m0, s37, 20480
    s_nop 0
    buffer_load_dwordx4 v1, s[12:15], m0 offen sc1 lds
    s_add_u32 m0, s37, 24576
    s_nop 0
    buffer_load_dwordx4 v1, s[12:15], m0 offen sc1 lds
    s_add_u32 m0, s37, 28672
    s_nop 0
    buffer_load_dwordx4 v1, s[12:15], m0 offen sc1 lds
    s_waitcnt vmcnt(6)
    s_barrier
    ds_read_b128 v[80:83], v1 offset:0
    ds_read_b128 v[84:87], v1 offset:1024
    ds_read_b128 v[88:91], v1 offset:2048
    ds_read_b128 v[92:95], v1 offset:3072
    ds_read_b128 v[96:99], v1 offset:4096
    ds_read_b128 v[100:103], v1 offset:5120
    ds_read_b128 v[104:107], v1 offset:6144
    s_waitcnt lgkmcnt(5)
    v_mfma_f32_32x32x16_bf16 v[48:63], a[160:163], v[80:83], 0
    ds_read_b128 v[108:111], v1 offset:7168
    v_add_f32 v132, v112, v114
    v_add_f32 v133, v116, v118
    v_add_f32 v132, v132, v133
    v_mov_b32 v133, v132
    v_add_f32 v134, v113, v115
    v_mfma_f32_32x32x16_bf16 v[48:63], a[164:167], v[84:87], v[48:63]
    s_waitcnt vmcnt(4)
    s_barrier
    ds_read_b128 v[80:83], v1 offset:8192
    v_add_f32 v135, v117, v119
    s_waitcnt lgkmcnt(4)
    v_mfma_f32_32x32x16_bf16 v[48:63], a[168:171], v[88:91], v[48:63]
    s_add_u32 m0, s37, 32768
    ds_read_b128 v[84:87], v1 offset:9216
    buffer_load_dwordx4 v1, s[12:15], m0 offen sc1 lds
    v_permlane32_swap_b32 v132, v133
    v_add_f32 v134, v134, v135
    v_add_f32 v132, v132, v133
    v_mfma_f32_32x32x16_bf16 v[48:63], a[172:175], v[92:95], v[48:63]
    ds_read_b128 v[88:91], v1 offset:10240
    v_mul_f32 v132, 0.125, v132
    v_sub_f32 v112, v112, v132
    v_sub_f32 v114, v114, v132
    v_sub_f32 v116, v116, v132
    v_sub_f32 v118, v118, v132
    v_mfma_f32_32x32x16_bf16 v[48:63], a[176:179], v[96:99], v[48:63]
    ds_read_b128 v[92:95], v1 offset:11264
    v_mul_f32 v133, v112, v112
    v_fmac_f32 v133, v114, v114
    v_fmac_f32 v133, v116, v116
    v_fmac_f32 v133, v118, v118
    s_waitcnt lgkmcnt(4)
    v_mfma_f32_32x32x16_bf16 v[48:63], a[180:183], v[100:103], v[48:63]
    s_add_u32 m0, s37, 36864
    ds_read_b128 v[96:99], v1 offset:12288
    buffer_load_dwordx4 v1, s[12:15], m0 offen sc1 lds
    v_fmac_f32 v134, 0x42a00000, v133
    v_mov_b32 v135, v134
    v_cvt_pk_bf16_f32 v136, -v132, -v132
    v_mfma_f32_32x32x16_bf16 v[48:63], a[184:187], v[104:107], v[48:63]
    ds_read_b128 v[100:103], v1 offset:13312
    s_lshl_b32 s30, s3, 8
    v_permlane32_swap_b32 v134, v135
    v_add_u32 v132, s30, v41
    v_add_f32 v134, v134, v135
    v_mul_f32 v134, 0x3acccccd, v134
    v_mfma_f32_32x32x16_bf16 v[48:63], a[188:191], v[108:111], v[48:63]
    ds_read_b128 v[104:107], v1 offset:14336
    v_cvt_pk_bf16_f32 v134, v134, v134
    v_lshlrev_b32 v134, 16, v134
    v_add_f32 v134, 0x3727c5ac, v134
    v_cvt_pk_bf16_f32 v134, v134, v134
    s_waitcnt lgkmcnt(4)
    v_mfma_f32_32x32x16_bf16 v[48:63], a[192:195], v[80:83], v[48:63]
    s_add_u32 m0, s37, 40960
    ds_read_b128 v[108:111], v1 offset:15360
    buffer_load_dwordx4 v1, s[12:15], m0 offen sc1 lds
    v_lshlrev_b32 v134, 16, v134
    v_sqrt_f32 v134, v134
    v_mfma_f32_32x32x16_bf16 v[48:63], a[196:199], v[84:87], v[48:63]
    s_waitcnt vmcnt(5)
    s_barrier
    ds_read_b128 v[80:83], v1 offset:16384
    v_cvt_pk_bf16_f32 v134, v134, v134
    v_lshlrev_b32 v134, 16, v134
    v_mfma_f32_32x32x16_bf16 v[48:63], a[200:203], v[88:91], v[48:63]
    ds_read_b128 v[84:87], v1 offset:17408
    v_rcp_f32 v137, v134
    s_nop 0
    v_and_b32 v137, 0xffffff7f, v137
    s_waitcnt lgkmcnt(4)
    v_mfma_f32_32x32x16_bf16 v[48:63], a[204:207], v[92:95], v[48:63]
    s_add_u32 m0, s37, 45056
    ds_read_b128 v[88:91], v1 offset:18432
    buffer_load_dwordx4 v1, s[12:15], m0 offen sc1 lds
    v_lshrrev_b32 v133, 5, v0
    s_and_b32 s30, s3, 1
    v_sub_u32 v133, s30, v133
    v_mfma_f32_32x32x16_bf16 v[48:63], a[208:211], v[96:99], v[48:63]
    ds_read_b128 v[92:95], v1 offset:19456
    ds_write_b64 v132, v[136:137]
    v_lshl_add_u32 v32, v133, 6, v32
    v_bfe_u32 v132, v0, 3, 1
    v_lshrrev_b32 v133, 4, v0
    v_mfma_f32_32x32x16_bf16 v[48:63], a[212:215], v[100:103], v[48:63]
    ds_read_b128 v[96:99], v1 offset:20480
    s_lshr_b32 s30, s3, 1
    s_mul_i32 s30, s30, 3
    s_and_b32 s31, s3, 1
    s_lshl_b32 s31, s31, 1
    v_add_u32 v132, s31, v132
    v_cmp_gt_u32 s[32:33], 3, v132
    v_add_u32 v132, s30, v132
    s_waitcnt lgkmcnt(5)
    v_mfma_f32_32x32x16_bf16 v[48:63], a[216:219], v[104:107], v[48:63]
    s_add_u32 m0, s37, 49152
    ds_read_b128 v[100:103], v1 offset:21504
    buffer_load_dwordx4 v1, s[12:15], m0 offen sc1 lds
    v_mul_u32_u24 v132, 10, v132
    v_add_u32 v132, v132, v133
    v_mov_b32 v136, 1073741824
    v_mfma_f32_32x32x16_bf16 v[48:63], a[220:223], v[108:111], v[48:63]
    ds_read_b128 v[104:107], v1 offset:22528
    v_and_b32 v134, 7, v0
    v_lshlrev_b32 v134, 4, v134
    v_lshl_add_u32 v132, v132, 11, v134
    v_cndmask_b32 v188, v136, v132, s[32:33]
    v_add_u32 v189, 8192, v188
    v_mfma_f32_32x32x16_bf16 v[48:63], a[224:227], v[80:83], v[48:63]
    ds_read_b128 v[108:111], v1 offset:23552
    v_add_u32 v190, 16384, v188
    v_cmp_gt_u32 vcc, 2, v133
    s_nop 1
    v_cndmask_b32 v190, v136, v190, vcc
    s_waitcnt lgkmcnt(5)
    v_mfma_f32_32x32x16_bf16 v[48:63], a[228:231], v[84:87], v[48:63]
    s_waitcnt vmcnt(5)
    s_waitcnt lgkmcnt(4)
    s_barrier
    s_add_u32 m0, s37, 53248
    ds_read_b128 v[80:83], v1 offset:24576
    buffer_load_dwordx4 v1, s[12:15], m0 offen sc1 lds
    ds_read_b64 v[8:9], v41 offset:0
    v_mfma_f32_32x32x16_bf16 v[48:63], a[232:235], v[88:91], v[48:63]
    ds_read_b128 v[84:87], v1 offset:25600
    s_mul_i32 s30, s28, 102400
    s_add_u32 s30, s30, 6169088
    s_add_u32 s16, s4, s30
    s_addc_u32 s17, s5, 0
    s_and_b32 s17, s17, 0xffff
    v_mfma_f32_32x32x16_bf16 v[48:63], a[236:239], v[92:95], v[48:63]
    ds_read_b128 v[88:91], v1 offset:26624
    s_waitcnt lgkmcnt(5)
    v_mfma_f32_32x32x16_bf16 v[48:63], a[240:243], v[96:99], v[48:63]
    s_add_u32 m0, s37, 57344
    ds_read_b128 v[92:95], v1 offset:27648
    buffer_load_dwordx4 v1, s[12:15], m0 offen sc1 lds
    v_mfma_f32_32x32x16_bf16 v[48:63], a[244:247], v[100:103], v[48:63]
    ds_read_b128 v[96:99], v1 offset:28672
    v_mfma_f32_32x32x16_bf16 v[48:63], a[248:251], v[104:107], v[48:63]
    ds_read_b128 v[100:103], v1 offset:29696
    s_waitcnt lgkmcnt(4)
    v_mfma_f32_32x32x16_bf16 v[48:63], a[252:255], v[108:111], v[48:63]
    s_add_u32 m0, s37, 61440
    ds_read_b128 v[104:107], v1 offset:30720
    buffer_load_dwordx4 v1, s[12:15], m0 offen sc1 lds
    v_mfma_f32_32x32x16_bf16 v[48:63], v[192:195], v[80:83], v[48:63]
    ds_read_b128 v[108:111], v1 offset:31744
    v_mfma_f32_32x32x16_bf16 v[48:63], v[196:199], v[84:87], v[48:63]
    s_waitcnt vmcnt(6)
    s_barrier
    ds_read_b128 v[80:83], v1 offset:32768
    s_waitcnt lgkmcnt(4)
    v_mfma_f32_32x32x16_bf16 v[48:63], v[200:203], v[88:91], v[48:63]
    s_add_u32 m0, s37, 65536
    ds_read_b128 v[84:87], v1 offset:33792
    buffer_load_dwordx4 v1, s[12:15], m0 offen sc1 lds
    v_mfma_f32_32x32x16_bf16 v[48:63], v[204:207], v[92:95], v[48:63]
    ds_read_b128 v[88:91], v1 offset:34816
    v_mfma_f32_32x32x16_bf16 v[48:63], v[208:211], v[96:99], v[48:63]
    ds_read_b128 v[92:95], v1 offset:35840
    s_waitcnt lgkmcnt(4)
    v_mfma_f32_32x32x16_bf16 v[48:63], v[212:215], v[100:103], v[48:63]
    s_add_u32 m0, s37, 69632
    ds_read_b128 v[96:99], v1 offset:36864
    buffer_load_dwordx4 v1, s[12:15], m0 offen sc1 lds
    v_mfma_f32_32x32x16_bf16 v[48:63], v[216:219], v[104:107], v[48:63]
    ds_read_b128 v[100:103], v1 offset:37888
    v_mfma_f32_32x32x16_bf16 v[48:63], v[220:223], v[108:111], v[48:63]
    ds_read_b128 v[104:107], v1 offset:38912
    s_waitcnt lgkmcnt(4)
    v_mfma_f32_32x32x16_bf16 v[48:63], v[224:227], v[80:83], v[48:63]
    s_add_u32 m0, s37, 73728
    ds_read_b128 v[108:111], v1 offset:39936
    buffer_load_dwordx4 v1, s[12:15], m0 offen sc1 lds
    v_mfma_f32_32x32x16_bf16 v[48:63], v[228:231], v[84:87], v[48:63]
    s_waitcnt vmcnt(5)
    s_barrier
    ds_read_b128 v[80:83], v1 offset:40960
    v_mfma_f32_32x32x16_bf16 v[48:63], v[232:235], v[88:91], v[48:63]
    ds_read_b128 v[84:87], v1 offset:41984
    s_waitcnt lgkmcnt(4)
    v_mfma_f32_32x32x16_bf16 v[48:63], v[236:239], v[92:95], v[48:63]
    s_add_u32 m0, s37, 77824
    ds_read_b128 v[88:91], v1 offset:43008
    buffer_load_dwordx4 v1, s[12:15], m0 offen sc1 lds
    v_mfma_f32_32x32x16_bf16 v[48:63], v[240:243], v[96:99], v[48:63]
    ds_read_b128 v[92:95], v1 offset:44032
    v_mfma_f32_32x32x16_bf16 v[48:63], v[244:247], v[100:103], v[48:63]
    ds_read_b128 v[96:99], v1 offset:45056
    v_mul_f32 v4, 0x3fb8aa3b, v9
    s_waitcnt lgkmcnt(4)
    v_mfma_f32_32x32x16_bf16 v[48:63], v[248:251], v[104:107], v[48:63]
    s_add_u32 m0, s37, 81920
    ds_read_b128 v[100:103], v1 offset:46080
    buffer_load_dwordx4 v1, s[12:15], m0 offen sc1 lds
    v_mfma_f32_32x32x16_bf16 v[48:63], v[252:255], v[108:111], v[48:63]
    ds_read_b128 v[104:107], v1 offset:47104
    v_mfma_f32_32x32x16_bf16 v[48:63], v[16:19], v[8:11], v[48:63]
    v_mfma_f32_32x32x16_bf16 v[64:79], a[160:163], v[80:83], 0
    ds_read_b128 v[108:111], v1 offset:48128
    s_cmp_ge_u32 s3, 2
    s_cselect_b32 s30, 18944, 0
    v_add_u32 v33, s30, v32
    s_nop 6
    v_mul_f32 v58, v58, v9
    s_waitcnt lgkmcnt(4)
    v_mfma_f32_32x32x16_bf16 v[64:79], a[164:167], v[84:87], v[64:79]
    s_add_u32 m0, s37, 86016
    ds_read_b128 v[80:83], v1 offset:49152
    buffer_load_dwordx4 v1, s[12:15], m0 offen sc1 lds
    ds_read_b64 v[10:11], v41 offset:256
    v_mul_f32 v59, v59, v9
    v_mul_f32 v60, v60, v9
    v_mfma_f32_32x32x16_bf16 v[64:79], a[168:171], v[88:91], v[64:79]
    ds_read_b128 v[84:87], v1 offset:50176
    v_mul_f32 v61, v61, v9
    v_mul_f32 v62, v62, v9
    v_mul_f32 v63, v63, v9
    v_cvt_pk_bf16_f32 v148, v58, v59
    v_cvt_pk_bf16_f32 v149, v60, v61
    v_mfma_f32_32x32x16_bf16 v[64:79], a[172:175], v[92:95], v[64:79]
    ds_read_b128 v[88:91], v1 offset:51200
    v_cvt_pk_bf16_f32 v150, v62, v63
    v_max3_f32 v132, v48, v49, v50
    v_max3_f32 v133, -v48, -v49, -v50
    v_max3_f32 v132, v132, v51, v52
    s_waitcnt lgkmcnt(5)
    v_mfma_f32_32x32x16_bf16 v[64:79], a[176:179], v[96:99], v[64:79]
    s_add_u32 m0, s37, 90112
    ds_read_b128 v[92:95], v1 offset:52224
    buffer_load_dwordx4 v1, s[12:15], m0 offen sc1 lds
    ds_write_b64 v33, v[148:149] offset:48
    v_max3_f32 v133, v133, -v51, -v52
    v_max3_f32 v132, v132, v53, v54
    v_mfma_f32_32x32x16_bf16 v[64:79], a[180:183], v[100:103], v[64:79]
    ds_read_b128 v[96:99], v1 offset:53248
    ds_write_b64 v33, v[150:151] offset:56
    v_max3_f32 v133, v133, -v53, -v54
    v_max3_f32 v132, v132, v55, v56
    v_max3_f32 v133, v133, -v55, -v56
    v_mfma_f32_32x32x16_bf16 v[64:79], a[184:187], v[104:107], v[64:79]
    ds_read_b128 v[100:103], v1 offset:54272
    v_max_f32 v132, v132, v57
    v_max_f32_e64 v133, v133, -v57
    s_nop 1
    v_permlane32_swap_b32 v132, v133
    s_waitcnt lgkmcnt(6)
    v_mfma_f32_32x32x16_bf16 v[64:79], a[188:191], v[108:111], v[64:79]
    s_add_u32 m0, s37, 94208
    ds_read_b128 v[104:107], v1 offset:55296
    buffer_load_dwordx4 v1, s[12:15], m0 offen sc1 lds
    v_max_f32 v132, v132, v133
    v_mul_f32_e64 v132, -v132, v4
    v_mov_b32 v133, v132
    v_mfma_f32_32x32x16_bf16 v[64:79], a[192:195], v[80:83], v[64:79]
    ds_read_b128 v[108:111], v1 offset:56320
    v_permlane32_swap_b32 v132, v133
    v_fma_f32 v112, v48, v4, v132
    v_fma_f32 v122, -v48, v4, v133
    v_fma_f32 v113, v49, v4, v132
    v_fma_f32 v123, -v49, v4, v133
    v_mfma_f32_32x32x16_bf16 v[64:79], a[196:199], v[84:87], v[64:79]
    s_waitcnt vmcnt(6)
    s_barrier
    ds_read_b128 v[80:83], v1 offset:57344
    v_fma_f32 v114, v50, v4, v132
    s_waitcnt lgkmcnt(5)
    v_mfma_f32_32x32x16_bf16 v[64:79], a[200:203], v[88:91], v[64:79]
    s_add_u32 m0, s37, 98304
    ds_read_b128 v[84:87], v1 offset:58368
    buffer_load_dwordx4 v1, s[12:15], m0 offen sc1 lds
    v_fma_f32 v124, -v50, v4, v133
    v_fma_f32 v115, v51, v4, v132
    v_fma_f32 v125, -v51, v4, v133
    v_mfma_f32_32x32x16_bf16 v[64:79], a[204:207], v[92:95], v[64:79]
    ds_read_b128 v[88:91], v1 offset:59392
    v_exp_f32 v112, v112
    v_exp_f32 v122, v122
    v_exp_f32 v113, v113
    v_mfma_f32_32x32x16_bf16 v[64:79], a[208:211], v[96:99], v[64:79]
    ds_read_b128 v[92:95], v1 offset:60416
    v_exp_f32 v123, v123
    v_exp_f32 v114, v114
    s_waitcnt lgkmcnt(4)
    v_mfma_f32_32x32x16_bf16 v[64:79], a[212:215], v[100:103], v[64:79]
    s_add_u32 m0, s37, 102400
    ds_read_b128 v[96:99], v1 offset:61440
    buffer_load_dwordx4 v1, s[12:15], m0 offen sc1 lds
    v_exp_f32 v124, v124
    v_exp_f32 v115, v115
    v_mfma_f32_32x32x16_bf16 v[64:79], a[216:219], v[104:107], v[64:79]
    ds_read_b128 v[100:103], v1 offset:62464
    v_exp_f32 v125, v125
    v_fma_f32 v116, v52, v4, v132
    v_fma_f32 v126, -v52, v4, v133
    v_fma_f32 v117, v53, v4, v132
    v_mfma_f32_32x32x16_bf16 v[64:79], a[220:223], v[108:111], v[64:79]
    ds_read_b128 v[104:107], v1 offset:63488
    v_fma_f32 v127, -v53, v4, v133
    v_fma_f32 v118, v54, v4, v132
    v_fma_f32 v128, -v54, v4, v133
    v_fma_f32 v119, v55, v4, v132
    s_waitcnt lgkmcnt(4)
    v_mfma_f32_32x32x16_bf16 v[64:79], a[224:227], v[80:83], v[64:79]
    s_add_u32 m0, s37, 106496
    ds_read_b128 v[108:111], v1 offset:64512
    buffer_load_dwordx4 v1, s[12:15], m0 offen sc1 lds
    v_fma_f32 v129, -v55, v4, v133
    v_exp_f32 v116, v116
    v_mfma_f32_32x32x16_bf16 v[64:79], a[228:231], v[84:87], v[64:79]
    ds_read_b128 v[80:83], v30 offset:0
    v_exp_f32 v126, v126
    v_exp_f32 v117, v117
    v_exp_f32 v127, v127
    v_mfma_f32_32x32x16_bf16 v[64:79], a[232:235], v[88:91], v[64:79]
    ds_read_b128 v[84:87], v30 offset:1024
    v_exp_f32 v118, v118
    v_exp_f32 v128, v128
    s_waitcnt lgkmcnt(4)
    v_mfma_f32_32x32x16_bf16 v[64:79], a[236:239], v[92:95], v[64:79]
    s_add_u32 m0, s37, 110592
    ds_read_b128 v[88:91], v30 offset:2048
    buffer_load_dwordx4 v1, s[12:15], m0 offen sc1 lds
    v_exp_f32 v119, v119
    v_exp_f32 v129, v129
    v_mfma_f32_32x32x16_bf16 v[64:79], a[240:243], v[96:99], v[64:79]
    ds_read_b128 v[92:95], v30 offset:3072
    v_add_f32 v134, v112, v113
    v_add_f32 v135, v122, v123
    v_add_f32 v134, v134, v114
    v_add_f32 v135, v135, v124
    v_add_f32 v134, v134, v115
    v_mfma_f32_32x32x16_bf16 v[64:79], a[244:247], v[100:103], v[64:79]
    ds_read_b128 v[96:99], v30 offset:4096
    v_add_f32 v135, v135, v125
    v_fma_f32 v120, v56, v4, v132
    v_fma_f32 v130, -v56, v4, v133
    v_fma_f32 v121, v57, v4, v132
    s_waitcnt lgkmcnt(4)
    v_mfma_f32_32x32x16_bf16 v[64:79], a[248:251], v[104:107], v[64:79]
    s_add_u32 m0, s37, 114688
    ds_read_b128 v[100:103], v30 offset:5120
    buffer_load_dwordx4 v1, s[12:15], m0 offen sc1 lds
    v_fma_f32 v131, -v57, v4, v133
    v_exp_f32 v120, v120
    v_mfma_f32_32x32x16_bf16 v[64:79], a[252:255], v[108:111], v[64:79]
    ds_read_b128 v[104:107], v30 offset:6144
    v_exp_f32 v130, v130
    v_exp_f32 v121, v121
    v_exp_f32 v131, v131
    v_mfma_f32_32x32x16_bf16 v[64:79], v[192:195], v[80:83], v[64:79]
    ds_read_b128 v[108:111], v30 offset:7168
    v_add_f32 v134, v134, v116
    v_add_f32 v135, v135, v126
    v_add_f32 v134, v134, v117
    v_add_f32 v135, v135, v127
    s_waitcnt lgkmcnt(4)
    v_mfma_f32_32x32x16_bf16 v[64:79], v[196:199], v[84:87], v[64:79]
    s_waitcnt vmcnt(7)
    s_barrier
    s_add_u32 m0, s37, 118784
    ds_read_b128 v[80:83], v30 offset:8192
    buffer_load_dwordx4 v1, s[12:15], m0 offen sc1 lds
    v_mfma_f32_32x32x16_bf16 v[64:79], v[200:203], v[88:91], v[64:79]
    ds_read_b128 v[84:87], v30 offset:9216
    v_add_f32 v134, v134, v118
    v_add_f32 v135, v135, v128
    v_add_f32 v134, v134, v119
    v_add_f32 v135, v135, v129
    v_add_f32 v134, v134, v120
    v_mfma_f32_32x32x16_bf16 v[64:79], v[204:207], v[92:95], v[64:79]
    ds_read_b128 v[88:91], v30 offset:10240
    v_add_f32 v135, v135, v130
    v_add_f32 v134, v134, v121
    v_add_f32 v135, v135, v131
    s_nop 1
    v_permlane32_swap_b32 v134, v135
    s_waitcnt lgkmcnt(4)
    v_mfma_f32_32x32x16_bf16 v[64:79], v[208:211], v[96:99], v[64:79]
    s_add_u32 m0, s37, 122880
    ds_read_b128 v[92:95], v30 offset:11264
    buffer_load_dwordx4 v1, s[12:15], m0 offen sc1 lds
    v_add_f32 v134, v134, v135
    v_rcp_f32 v134, v134
    v_mfma_f32_32x32x16_bf16 v[64:79], v[212:215], v[100:103], v[64:79]
    ds_read_b128 v[96:99], v30 offset:12288
    v_mov_b32 v135, v134
    s_nop 1
    v_permlane32_swap_b32 v134, v135
    v_mul_f32 v112, v112, v134
    v_mfma_f32_32x32x16_bf16 v[64:79], v[216:219], v[104:107], v[64:79]
    ds_read_b128 v[100:103], v30 offset:13312
    v_mul_f32 v113, v113, v134
    v_cvt_pk_bf16_f32 v138, v112, v113
    v_mul_f32 v114, v114, v134
    v_mul_f32 v115, v115, v134
    s_waitcnt lgkmcnt(4)
    v_mfma_f32_32x32x16_bf16 v[64:79], v[220:223], v[108:111], v[64:79]
    s_add_u32 m0, s37, 126976
    ds_read_b128 v[104:107], v30 offset:14336
    buffer_load_dwordx4 v1, s[12:15], m0 offen sc1 lds
    v_cvt_pk_bf16_f32 v139, v114, v115
    v_mul_f32 v116, v116, v134
    v_mul_f32 v117, v117, v134
    v_cvt_pk_bf16_f32 v140, v116, v117
    v_mfma_f32_32x32x16_bf16 v[64:79], v[224:227], v[80:83], v[64:79]
    ds_read_b128 v[108:111], v30 offset:15360
    ds_write_b64 v33, v[138:139] offset:0
    v_mul_f32 v118, v118, v134
    v_mul_f32 v119, v119, v134
    v_cvt_pk_bf16_f32 v141, v118, v119
    v_mfma_f32_32x32x16_bf16 v[64:79], v[228:231], v[84:87], v[64:79]
    ds_read_b128 v[80:83], v30 offset:16384
    v_mul_f32 v120, v120, v134
    v_mul_f32 v121, v121, v134
    v_cvt_pk_bf16_f32 v142, v120, v121
    v_mul_f32 v122, v122, v135
    s_waitcnt lgkmcnt(5)
    v_mfma_f32_32x32x16_bf16 v[64:79], v[232:235], v[88:91], v[64:79]
    s_add_u32 m0, s37, 131072
    ds_read_b128 v[84:87], v30 offset:17408
    buffer_load_dwordx4 v1, s[12:15], m0 offen sc1 lds
    ds_write_b64 v33, v[140:141] offset:8
    v_mul_f32 v123, v123, v135
    v_mfma_f32_32x32x16_bf16 v[64:79], v[236:239], v[92:95], v[64:79]
    ds_read_b128 v[88:91], v30 offset:18432
    v_cvt_pk_bf16_f32 v143, v122, v123
    v_mul_f32 v124, v124, v135
    v_mul_f32 v125, v125, v135
    v_cvt_pk_bf16_f32 v144, v124, v125
    v_mul_f32 v126, v126, v135
    v_mul_f32 v127, v127, v135
    v_mfma_f32_32x32x16_bf16 v[64:79], v[240:243], v[96:99], v[64:79]
    ds_read_b128 v[92:95], v30 offset:19456
    ds_write_b64 v33, v[142:143] offset:16
    v_cvt_pk_bf16_f32 v145, v126, v127
    v_mul_f32 v128, v128, v135
    s_waitcnt lgkmcnt(7)
    v_mfma_f32_32x32x16_bf16 v[64:79], v[244:247], v[100:103], v[64:79]
    s_add_u32 m0, s37, 135168
    ds_read_b128 v[96:99], v30 offset:20480
    buffer_load_dwordx4 v1, s[12:15], m0 offen sc1 lds
    ds_write_b64 v33, v[144:145] offset:24
    v_mul_f32 v129, v129, v135
    v_mfma_f32_32x32x16_bf16 v[64:79], v[248:251], v[104:107], v[64:79]
    ds_read_b128 v[100:103], v30 offset:21504
    v_cvt_pk_bf16_f32 v146, v128, v129
    v_mul_f32 v130, v130, v135
    v_mul_f32 v131, v131, v135
    v_cvt_pk_bf16_f32 v147, v130, v131
    v_mul_f32 v5, 0x3fb8aa3b, v11
    v_mfma_f32_32x32x16_bf16 v[64:79], v[252:255], v[108:111], v[64:79]
    ds_read_b128 v[104:107], v30 offset:22528
    ds_write_b64 v33, v[146:147] offset:32
    s_waitcnt lgkmcnt(7)
    v_mfma_f32_32x32x16_bf16 v[64:79], v[16:19], v[10:13], v[64:79]
    s_waitcnt vmcnt(8)
    s_waitcnt lgkmcnt(0)
    s_barrier
    v_mfma_f32_32x32x16_bf16 v[48:63], a[160:163], v[80:83], 0
    s_add_u32 m0, s37, 139264
    ds_read_b128 v[108:111], v30 offset:23552
    buffer_load_dwordx4 v1, s[12:15], m0 offen sc1 lds
    s_bitcmp1_b32 s3, 0
    s_cselect_b32 s30, 18944, 0
    v_add_u32 v40, s30, v39
    v_mfma_f32_32x32x16_bf16 v[48:63], a[164:167], v[84:87], v[48:63]
    ds_read_b128 v[80:83], v30 offset:24576
    v_mul_f32 v74, v74, v11
    v_mul_f32 v75, v75, v11
    v_mul_f32 v76, v76, v11
    v_mul_f32 v77, v77, v11
    v_mul_f32 v78, v78, v11
    v_mfma_f32_32x32x16_bf16 v[48:63], a[168:171], v[88:91], v[48:63]
    ds_read_b128 v[84:87], v30 offset:25600
    ds_read_b64_tr_b16 v[164:165], v40 offset:0
    ds_read_b64_tr_b16 v[166:167], v40 offset:4736
    v_mul_f32 v79, v79, v11
    v_cvt_pk_bf16_f32 v148, v74, v75
    v_cvt_pk_bf16_f32 v149, v76, v77
    v_mfma_f32_32x32x16_bf16 v[48:63], a[172:175], v[92:95], v[48:63]
    s_add_u32 m0, s37, 143360
    ds_read_b128 v[88:91], v30 offset:26624
    buffer_load_dwordx4 v1, s[12:15], m0 offen sc1 lds
    ds_read_b64_tr_b16 v[152:153], v34 offset:0
    ds_read_b64_tr_b16 v[154:155], v34 offset:4736
    v_cvt_pk_bf16_f32 v150, v78, v79
    v_mfma_f32_32x32x16_bf16 v[48:63], a[176:179], v[96:99], v[48:63]
    ds_read_b128 v[92:95], v30 offset:27648
    ds_read_b64_tr_b16 v[156:157], v35 offset:0
    ds_read_b64_tr_b16 v[158:159], v35 offset:4736
    v_max3_f32 v132, v64, v65, v66
    v_max3_f32 v133, -v64, -v65, -v66
    v_max3_f32 v132, v132, v67, v68
    v_max3_f32 v133, v133, -v67, -v68
    v_mfma_f32_32x32x16_bf16 v[48:63], a[180:183], v[100:103], v[48:63]
    ds_read_b128 v[96:99], v30 offset:28672
    ds_read_b64_tr_b16 v[160:161], v36 offset:0
    ds_read_b64_tr_b16 v[162:163], v36 offset:4736
    v_max3_f32 v132, v132, v69, v70
    v_max3_f32 v133, v133, -v69, -v70
    v_max3_f32 v132, v132, v71, v72
    v_mfma_f32_32x32x16_bf16 v[48:63], a[184:187], v[104:107], v[48:63]
    s_add_u32 m0, s37, 147456
    ds_read_b128 v[100:103], v30 offset:29696
    buffer_load_dwordx4 v1, s[12:15], m0 offen sc1 lds
    ds_read_b64 v[8:9], v41 offset:512
    ds_write_b64 v33, v[148:149] offset:9520
    s_waitcnt lgkmcnt(14)
    v_mfma_f32_32x32x16_bf16 v[48:63], a[188:191], v[108:111], v[48:63]
    ds_read_b128 v[104:107], v30 offset:30720
    ds_write_b64 v33, v[150:151] offset:9528
    v_max3_f32 v133, v133, -v71, -v72
    v_max_f32 v132, v132, v73
    v_max_f32_e64 v133, v133, -v73
    v_mfma_f32_32x32x16_bf16 v[48:63], a[192:195], v[80:83], v[48:63]
    ds_read_b128 v[108:111], v30 offset:31744
    v_permlane32_swap_b32 v132, v133
    v_max_f32 v132, v132, v133
    v_mul_f32_e64 v132, -v132, v5
    v_mov_b32 v133, v132
    s_nop 1
    v_permlane32_swap_b32 v132, v133
    s_waitcnt lgkmcnt(6)
    v_mfma_f32_16x16x32_bf16 v[168:171], v[152:155], v[164:167], 0
    v_fma_f32 v112, v64, v5, v132
    v_fma_f32 v122, -v64, v5, v133
    v_mfma_f32_16x16x32_bf16 v[172:175], v[156:159], v[164:167], 0
    v_fma_f32 v113, v65, v5, v132
    v_fma_f32 v123, -v65, v5, v133
    v_mfma_f32_16x16x32_bf16 v[176:179], v[160:163], v[164:167], 0
    v_fma_f32 v114, v66, v5, v132
    v_fma_f32 v124, -v66, v5, v133
    v_mfma_f32_32x32x16_bf16 v[48:63], a[196:199], v[84:87], v[48:63]
    s_add_u32 m0, s37, 151552
    ds_read_b128 v[80:83], v30 offset:32768
    buffer_load_dwordx4 v1, s[12:15], m0 offen sc1 lds
    v_fma_f32 v115, v67, v5, v132
    v_fma_f32 v125, -v67, v5, v133
    v_mfma_f32_32x32x16_bf16 v[48:63], a[200:203], v[88:91], v[48:63]
    ds_read_b128 v[84:87], v30 offset:33792
    v_exp_f32 v112, v112
    v_exp_f32 v122, v122
    v_exp_f32 v113, v113
    v_mfma_f32_32x32x16_bf16 v[48:63], a[204:207], v[92:95], v[48:63]
    ds_read_b128 v[88:91], v30 offset:34816
    v_exp_f32 v123, v123
    v_exp_f32 v114, v114
    v_exp_f32 v124, v124
    v_mfma_f32_32x32x16_bf16 v[48:63], a[208:211], v[96:99], v[48:63]
    s_add_u32 m0, s37, 155648
    ds_read_b128 v[92:95], v30 offset:35840
    buffer_load_dwordx4 v1, s[12:15], m0 offen sc1 lds
    v_exp_f32 v115, v115
    s_waitcnt lgkmcnt(4)
    v_mfma_f32_32x32x16_bf16 v[48:63], a[212:215], v[100:103], v[48:63]
    ds_read_b128 v[96:99], v30 offset:36864
    v_exp_f32 v125, v125
    v_fma_f32 v116, v68, v5, v132
    v_fma_f32 v126, -v68, v5, v133
    v_fma_f32 v117, v69, v5, v132
    v_mfma_f32_32x32x16_bf16 v[48:63], a[216:219], v[104:107], v[48:63]
    ds_read_b128 v[100:103], v30 offset:37888
    v_fma_f32 v127, -v69, v5, v133
    v_fma_f32 v118, v70, v5, v132
    v_fma_f32 v128, -v70, v5, v133
    v_fma_f32 v119, v71, v5, v132
    v_fma_f32 v129, -v71, v5, v133
    v_mfma_f32_32x32x16_bf16 v[48:63], a[220:223], v[108:111], v[48:63]
    s_add_u32 m0, s37, 159744
    s_min_u32 m0, m0, 161792
    ds_read_b128 v[104:107], v30 offset:38912
    buffer_load_dwordx4 v1, s[12:15], m0 offen sc1 lds
    s_mov_b32 s30, 162816
    buffer_load_dwordx4 v[180:183], v1, s[12:15], s30 offen sc1
    s_waitcnt lgkmcnt(4)
    v_mfma_f32_32x32x16_bf16 v[48:63], a[224:227], v[80:83], v[48:63]
    ds_read_b128 v[108:111], v30 offset:39936
    v_exp_f32 v116, v116
    v_exp_f32 v126, v126
    v_exp_f32 v117, v117
    v_mfma_f32_32x32x16_bf16 v[48:63], a[228:231], v[84:87], v[48:63]
    s_waitcnt vmcnt(9)
    s_barrier
    ds_read_b128 v[80:83], v30 offset:40960
    v_exp_f32 v127, v127
    v_mfma_f32_32x32x16_bf16 v[48:63], a[232:235], v[88:91], v[48:63]
    s_add_u32 m0, s37, 56832
    ds_read_b128 v[84:87], v30 offset:41984
    buffer_load_dwordx4 v1, s[16:19], m0 offen lds
    v_exp_f32 v118, v118
    s_waitcnt lgkmcnt(4)
    v_mfma_f32_32x32x16_bf16 v[48:63], a[236:239], v[92:95], v[48:63]
    ds_read_b128 v[88:91], v30 offset:43008
    v_exp_f32 v128, v128
    v_exp_f32 v119, v119
    v_exp_f32 v129, v129
    v_mfma_f32_32x32x16_bf16 v[48:63], a[240:243], v[96:99], v[48:63]
    ds_read_b128 v[92:95], v30 offset:44032
    v_add_f32 v134, v112, v113
    v_add_f32 v135, v122, v123
    v_add_f32 v134, v134, v114
    v_add_f32 v135, v135, v124
    v_add_f32 v134, v134, v115
    v_mfma_f32_32x32x16_bf16 v[48:63], a[244:247], v[100:103], v[48:63]
    s_add_u32 m0, s37, 60928
    ds_read_b128 v[96:99], v30 offset:45056
    buffer_load_dwordx4 v1, s[16:19], m0 offen lds
    v_add_f32 v135, v135, v125
    v_fma_f32 v120, v72, v5, v132
    s_waitcnt lgkmcnt(4)
    v_mfma_f32_32x32x16_bf16 v[48:63], a[248:251], v[104:107], v[48:63]
    ds_read_b128 v[100:103], v30 offset:46080
    v_fma_f32 v130, -v72, v5, v133
    v_fma_f32 v121, v73, v5, v132
    v_fma_f32 v131, -v73, v5, v133
    v_exp_f32 v120, v120
    v_mfma_f32_32x32x16_bf16 v[48:63], a[252:255], v[108:111], v[48:63]
    ds_read_b128 v[104:107], v30 offset:47104
    v_exp_f32 v130, v130
    v_exp_f32 v121, v121
    v_exp_f32 v131, v131
    v_mfma_f32_32x32x16_bf16 v[48:63], v[192:195], v[80:83], v[48:63]
    s_add_u32 m0, s37, 65024
    ds_read_b128 v[108:111], v30 offset:48128
    buffer_load_dwordx4 v1, s[16:19], m0 offen lds
    v_add_f32 v134, v134, v116
    v_add_f32 v135, v135, v126
    s_waitcnt lgkmcnt(4)
    v_mfma_f32_32x32x16_bf16 v[48:63], v[196:199], v[84:87], v[48:63]
    ds_read_b128 v[80:83], v30 offset:49152
    v_add_f32 v134, v134, v117
    v_add_f32 v135, v135, v127
    v_add_f32 v134, v134, v118
    v_add_f32 v135, v135, v128
    v_add_f32 v134, v134, v119
    v_mfma_f32_32x32x16_bf16 v[48:63], v[200:203], v[88:91], v[48:63]
    ds_read_b128 v[84:87], v30 offset:50176
    v_add_f32 v135, v135, v129
    v_add_f32 v134, v134, v120
    v_add_f32 v135, v135, v130
    v_add_f32 v134, v134, v121
    v_add_f32 v135, v135, v131
    s_nop 1
    v_permlane32_swap_b32 v134, v135
    v_mfma_f32_32x32x16_bf16 v[48:63], v[204:207], v[92:95], v[48:63]
    s_add_u32 m0, s37, 69120
    ds_read_b128 v[88:91], v30 offset:51200
    buffer_load_dwordx4 v1, s[16:19], m0 offen lds
    v_add_f32 v134, v134, v135
    s_waitcnt lgkmcnt(4)
    v_mfma_f32_32x32x16_bf16 v[48:63], v[208:211], v[96:99], v[48:63]
    ds_read_b128 v[92:95], v30 offset:52224
    v_rcp_f32 v134, v134
    s_nop 0
    v_mov_b32 v135, v134
    s_nop 1
    v_permlane32_swap_b32 v134, v135
    v_mfma_f32_32x32x16_bf16 v[48:63], v[212:215], v[100:103], v[48:63]
    ds_read_b128 v[96:99], v30 offset:53248
    v_mul_f32 v112, v112, v134
    v_mul_f32 v113, v113, v134
    v_cvt_pk_bf16_f32 v138, v112, v113
    v_mul_f32 v114, v114, v134
    v_mul_f32 v115, v115, v134
    v_mfma_f32_32x32x16_bf16 v[48:63], v[216:219], v[104:107], v[48:63]
    s_add_u32 m0, s37, 73216
    ds_read_b128 v[100:103], v30 offset:54272
    buffer_load_dwordx4 v1, s[16:19], m0 offen lds
    v_cvt_pk_bf16_f32 v139, v114, v115
    v_mul_f32 v116, v116, v134
    s_waitcnt lgkmcnt(4)
    v_mfma_f32_32x32x16_bf16 v[48:63], v[220:223], v[108:111], v[48:63]
    ds_read_b128 v[104:107], v30 offset:55296
    ds_write_b64 v33, v[138:139] offset:9472
    v_mul_f32 v117, v117, v134
    v_cvt_pk_bf16_f32 v140, v116, v117
    v_mul_f32 v118, v118, v134
    v_mfma_f32_32x32x16_bf16 v[48:63], v[224:227], v[80:83], v[48:63]
    ds_read_b128 v[108:111], v30 offset:56320
    v_mul_f32 v119, v119, v134
    v_cvt_pk_bf16_f32 v141, v118, v119
    v_mul_f32 v120, v120, v134
    v_mul_f32 v121, v121, v134
    v_cvt_pk_bf16_f32 v142, v120, v121
    v_mul_f32 v122, v122, v135
    v_mfma_f32_32x32x16_bf16 v[48:63], v[228:231], v[84:87], v[48:63]
    s_add_u32 m0, s37, 77312
    ds_read_b128 v[80:83], v30 offset:57344
    buffer_load_dwordx4 v1, s[16:19], m0 offen lds
    ds_write_b64 v33, v[140:141] offset:9480
    s_waitcnt lgkmcnt(6)
    v_mfma_f32_32x32x16_bf16 v[48:63], v[232:235], v[88:91], v[48:63]
    ds_read_b128 v[84:87], v30 offset:58368
    v_mul_f32 v123, v123, v135
    v_cvt_pk_bf16_f32 v143, v122, v123
    v_mul_f32 v124, v124, v135
    v_mul_f32 v125, v125, v135
    v_cvt_pk_bf16_f32 v144, v124, v125
    v_mfma_f32_32x32x16_bf16 v[48:63], v[236:239], v[92:95], v[48:63]
    ds_read_b128 v[88:91], v30 offset:59392
    ds_write_b64 v33, v[142:143] offset:9488
    v_mul_f32 v126, v126, v135
    v_mul_f32 v127, v127, v135
    v_cvt_pk_bf16_f32 v145, v126, v127
    v_mfma_f32_32x32x16_bf16 v[48:63], v[240:243], v[96:99], v[48:63]
    s_add_u32 m0, s37, 81408
    ds_read_b128 v[92:95], v30 offset:60416
    buffer_load_dwordx4 v1, s[16:19], m0 offen lds
    v_mul_f32 v128, v128, v135
    v_mul_f32 v129, v129, v135
    v_cvt_pk_bf16_f32 v146, v128, v129
    s_waitcnt lgkmcnt(6)
    v_mfma_f32_32x32x16_bf16 v[48:63], v[244:247], v[100:103], v[48:63]
    ds_read_b128 v[96:99], v30 offset:61440
    ds_write_b64 v33, v[144:145] offset:9496
    v_mul_f32 v130, v130, v135
    v_mul_f32 v131, v131, v135
    v_cvt_pk_bf16_f32 v147, v130, v131
    v_mfma_f32_32x32x16_bf16 v[48:63], v[248:251], v[104:107], v[48:63]
    ds_read_b128 v[100:103], v30 offset:62464
    v_mul_f32 v4, 0x3fb8aa3b, v9
    v_mfma_f32_32x32x16_bf16 v[48:63], v[252:255], v[108:111], v[48:63]
    s_add_u32 m0, s37, 85504
    ds_read_b128 v[104:107], v30 offset:63488
    buffer_load_dwordx4 v1, s[16:19], m0 offen lds
    ds_write_b64 v33, v[146:147] offset:9504
    s_waitcnt lgkmcnt(7)
    v_mfma_f32_32x32x16_bf16 v[48:63], v[16:19], v[8:11], v[48:63]
    s_waitcnt vmcnt(13)
    s_waitcnt lgkmcnt(0)
    s_barrier
    v_mfma_f32_32x32x16_bf16 v[64:79], a[160:163], v[80:83], 0
    ds_read_b128 v[108:111], v30 offset:64512
    s_cmp_ge_u32 s3, 2
    s_cselect_b32 s30, 37888, 0
    v_add_u32 v33, s30, v32
    s_nop 3
    v_mul_f32 v58, v58, v9
    v_mfma_f32_32x32x16_bf16 v[64:79], a[164:167], v[84:87], v[64:79]
    ds_read_b128 v[80:83], v31 offset:0
    ds_read_b64_tr_b16 v[164:165], v40 offset:9472
    ds_read_b64_tr_b16 v[166:167], v40 offset:14208
    v_mul_f32 v59, v59, v9
    v_mul_f32 v60, v60, v9
    v_mul_f32 v61, v61, v9
    v_mfma_f32_32x32x16_bf16 v[64:79], a[168:171], v[88:91], v[64:79]
    s_add_u32 m0, s37, 89600
    ds_read_b128 v[84:87], v31 offset:1024
    buffer_load_dwordx4 v1, s[16:19], m0 offen lds
    ds_read_b64_tr_b16 v[152:153], v34 offset:9472
    ds_read_b64_tr_b16 v[154:155], v34 offset:14208
    v_mul_f32 v62, v62, v9
    v_mfma_f32_32x32x16_bf16 v[64:79], a[172:175], v[92:95], v[64:79]
    ds_read_b128 v[88:91], v31 offset:2048
    ds_read_b64_tr_b16 v[156:157], v35 offset:9472
    ds_read_b64_tr_b16 v[158:159], v35 offset:14208
    v_mul_f32 v63, v63, v9
    v_cvt_pk_bf16_f32 v148, v58, v59
    v_cvt_pk_bf16_f32 v149, v60, v61
    v_mfma_f32_32x32x16_bf16 v[64:79], a[176:179], v[96:99], v[64:79]
    ds_read_b128 v[92:95], v31 offset:3072
    ds_read_b64_tr_b16 v[160:161], v36 offset:9472
    ds_read_b64_tr_b16 v[162:163], v36 offset:14208
    v_cvt_pk_bf16_f32 v150, v62, v63
    v_max3_f32 v132, v48, v49, v50
    v_max3_f32 v133, -v48, -v49, -v50
    v_max3_f32 v132, v132, v51, v52
    v_mfma_f32_32x32x16_bf16 v[64:79], a[180:183], v[100:103], v[64:79]
    s_add_u32 m0, s37, 93696
    ds_read_b128 v[96:99], v31 offset:4096
    buffer_load_dwordx4 v1, s[16:19], m0 offen lds
    ds_read_b64 v[10:11], v41 offset:768
    ds_write_b64 v33, v[148:149] offset:48
    v_mfma_f32_32x32x16_bf16 v[64:79], a[184:187], v[104:107], v[64:79]
    ds_read_b128 v[100:103], v31 offset:5120
    ds_write_b64 v33, v[150:151] offset:56
    v_max3_f32 v133, v133, -v51, -v52
    v_max3_f32 v132, v132, v53, v54
    s_waitcnt lgkmcnt(13)
    v_mfma_f32_32x32x16_bf16 v[64:79], a[188:191], v[108:111], v[64:79]
    ds_read_b128 v[104:107], v31 offset:6144
    v_max3_f32 v133, v133, -v53, -v54
    v_max3_f32 v132, v132, v55, v56
    v_max3_f32 v133, v133, -v55, -v56
    v_max_f32 v132, v132, v57
    v_max_f32_e64 v133, v133, -v57
    s_waitcnt lgkmcnt(6)
    v_mfma_f32_16x16x32_bf16 v[168:171], v[152:155], v[164:167], v[168:171]
    v_permlane32_swap_b32 v132, v133
    v_max_f32 v132, v132, v133
    v_mfma_f32_16x16x32_bf16 v[172:175], v[156:159], v[164:167], v[172:175]
    v_mul_f32_e64 v132, -v132, v4
    v_mov_b32 v133, v132
    v_mfma_f32_16x16x32_bf16 v[176:179], v[160:163], v[164:167], v[176:179]
    s_nop 0
    v_permlane32_swap_b32 v132, v133
    v_mfma_f32_32x32x16_bf16 v[64:79], a[192:195], v[80:83], v[64:79]
    s_add_u32 m0, s37, 97792
    ds_read_b128 v[108:111], v31 offset:7168
    buffer_load_dwordx4 v1, s[16:19], m0 offen lds
    v_fma_f32 v112, v48, v4, v132
    v_fma_f32 v122, -v48, v4, v133
    v_fma_f32 v113, v49, v4, v132
    v_fma_f32 v123, -v49, v4, v133
    v_mfma_f32_32x32x16_bf16 v[64:79], a[196:199], v[84:87], v[64:79]
    ds_read_b128 v[80:83], v31 offset:8192
    v_fma_f32 v114, v50, v4, v132
    v_fma_f32 v124, -v50, v4, v133
    v_fma_f32 v115, v51, v4, v132
    v_fma_f32 v125, -v51, v4, v133
    v_exp_f32 v112, v112
    v_mfma_f32_32x32x16_bf16 v[64:79], a[200:203], v[88:91], v[64:79]
    ds_read_b128 v[84:87], v31 offset:9216
    v_exp_f32 v122, v122
    v_exp_f32 v113, v113
    v_mfma_f32_32x32x16_bf16 v[64:79], a[204:207], v[92:95], v[64:79]
    s_add_u32 m0, s37, 101888
    ds_read_b128 v[88:91], v31 offset:10240
    buffer_load_dwordx4 v1, s[16:19], m0 offen lds
    v_exp_f32 v123, v123
    s_waitcnt lgkmcnt(4)
    v_mfma_f32_32x32x16_bf16 v[64:79], a[208:211], v[96:99], v[64:79]
    ds_read_b128 v[92:95], v31 offset:11264
    v_exp_f32 v114, v114
    v_exp_f32 v124, v124
    v_exp_f32 v115, v115
    v_mfma_f32_32x32x16_bf16 v[64:79], a[212:215], v[100:103], v[64:79]
    ds_read_b128 v[96:99], v31 offset:12288
    v_exp_f32 v125, v125
    v_fma_f32 v116, v52, v4, v132
    v_fma_f32 v126, -v52, v4, v133
    v_fma_f32 v117, v53, v4, v132
    v_mfma_f32_32x32x16_bf16 v[64:79], a[216:219], v[104:107], v[64:79]
    s_add_u32 m0, s37, 105984
    ds_read_b128 v[100:103], v31 offset:13312
    buffer_load_dwordx4 v1, s[16:19], m0 offen lds
    v_fma_f32 v127, -v53, v4, v133
    v_fma_f32 v118, v54, v4, v132
    s_waitcnt lgkmcnt(4)
    v_mfma_f32_32x32x16_bf16 v[64:79], a[220:223], v[108:111], v[64:79]
    ds_read_b128 v[104:107], v31 offset:14336
    v_fma_f32 v128, -v54, v4, v133
    v_fma_f32 v119, v55, v4, v132
    v_fma_f32 v129, -v55, v4, v133
    v_exp_f32 v116, v116
    v_mfma_f32_32x32x16_bf16 v[64:79], a[224:227], v[80:83], v[64:79]
    ds_read_b128 v[108:111], v31 offset:15360
    v_exp_f32 v126, v126
    v_exp_f32 v117, v117
    v_exp_f32 v127, v127
    v_mfma_f32_32x32x16_bf16 v[64:79], a[228:231], v[84:87], v[64:79]
    s_waitcnt vmcnt(13)
    s_barrier
    s_add_u32 m0, s37, 110080
    ds_read_b128 v[80:83], v31 offset:16384
    buffer_load_dwordx4 v1, s[16:19], m0 offen lds
    s_waitcnt lgkmcnt(4)
    v_mfma_f32_32x32x16_bf16 v[64:79], a[232:235], v[88:91], v[64:79]
    ds_read_b128 v[84:87], v31 offset:17408
    v_exp_f32 v118, v118
    v_exp_f32 v128, v128
    v_mfma_f32_32x32x16_bf16 v[64:79], a[236:239], v[92:95], v[64:79]
    ds_read_b128 v[88:91], v31 offset:18432
    v_exp_f32 v119, v119
    v_exp_f32 v129, v129
    v_add_f32 v134, v112, v113
    v_add_f32 v135, v122, v123
    v_mfma_f32_32x32x16_bf16 v[64:79], a[240:243], v[96:99], v[64:79]
    s_add_u32 m0, s37, 114176
    ds_read_b128 v[92:95], v31 offset:19456
    buffer_load_dwordx4 v1, s[16:19], m0 offen lds
    v_add_f32 v134, v134, v114
    v_add_f32 v135, v135, v124
    s_waitcnt lgkmcnt(4)
    v_mfma_f32_32x32x16_bf16 v[64:79], a[244:247], v[100:103], v[64:79]
    ds_read_b128 v[96:99], v31 offset:20480
    v_add_f32 v134, v134, v115
    v_add_f32 v135, v135, v125
    v_fma_f32 v120, v56, v4, v132
    v_fma_f32 v130, -v56, v4, v133
    v_fma_f32 v121, v57, v4, v132
    v_mfma_f32_32x32x16_bf16 v[64:79], a[248:251], v[104:107], v[64:79]
    ds_read_b128 v[100:103], v31 offset:21504
    v_fma_f32 v131, -v57, v4, v133
    v_exp_f32 v120, v120
    v_exp_f32 v130, v130
    v_mfma_f32_32x32x16_bf16 v[64:79], a[252:255], v[108:111], v[64:79]
    s_add_u32 m0, s37, 118272
    ds_read_b128 v[104:107], v31 offset:22528
    buffer_load_dwordx4 v1, s[16:19], m0 offen lds
    v_exp_f32 v121, v121
    s_waitcnt lgkmcnt(4)
    v_mfma_f32_32x32x16_bf16 v[64:79], v[192:195], v[80:83], v[64:79]
    ds_read_b128 v[108:111], v31 offset:23552
    v_exp_f32 v131, v131
    v_add_f32 v134, v134, v116
    v_add_f32 v135, v135, v126
    v_add_f32 v134, v134, v117
    v_add_f32 v135, v135, v127
    v_mfma_f32_32x32x16_bf16 v[64:79], v[196:199], v[84:87], v[64:79]
    ds_read_b128 v[80:83], v31 offset:24576
    v_add_f32 v134, v134, v118
    v_add_f32 v135, v135, v128
    v_add_f32 v134, v134, v119
    v_add_f32 v135, v135, v129
    v_add_f32 v134, v134, v120
    v_mfma_f32_32x32x16_bf16 v[64:79], v[200:203], v[88:91], v[64:79]
    s_add_u32 m0, s37, 122368
    ds_read_b128 v[84:87], v31 offset:25600
    buffer_load_dwordx4 v1, s[16:19], m0 offen lds
    v_add_f32 v135, v135, v130
    v_add_f32 v134, v134, v121
    s_waitcnt lgkmcnt(4)
    v_mfma_f32_32x32x16_bf16 v[64:79], v[204:207], v[92:95], v[64:79]
    ds_read_b128 v[88:91], v31 offset:26624
    v_add_f32 v135, v135, v131
    s_nop 1
    v_permlane32_swap_b32 v134, v135
    v_add_f32 v134, v134, v135
    v_mfma_f32_32x32x16_bf16 v[64:79], v[208:211], v[96:99], v[64:79]
    ds_read_b128 v[92:95], v31 offset:27648
    v_rcp_f32 v134, v134
    s_nop 0
    v_mov_b32 v135, v134
    s_nop 1
    v_permlane32_swap_b32 v134, v135
    v_mfma_f32_32x32x16_bf16 v[64:79], v[212:215], v[100:103], v[64:79]
    s_add_u32 m0, s37, 126464
    ds_read_b128 v[96:99], v31 offset:28672
    buffer_load_dwordx4 v1, s[16:19], m0 offen lds
    v_mul_f32 v112, v112, v134
    v_mul_f32 v113, v113, v134
    s_waitcnt lgkmcnt(4)
    v_mfma_f32_32x32x16_bf16 v[64:79], v[216:219], v[104:107], v[64:79]
    ds_read_b128 v[100:103], v31 offset:29696
    v_cvt_pk_bf16_f32 v138, v112, v113
    v_mul_f32 v114, v114, v134
    v_mul_f32 v115, v115, v134
    v_cvt_pk_bf16_f32 v139, v114, v115
    v_mul_f32 v116, v116, v134
    v_mfma_f32_32x32x16_bf16 v[64:79], v[220:223], v[108:111], v[64:79]
    ds_read_b128 v[104:107], v31 offset:30720
    ds_write_b64 v33, v[138:139] offset:0
    v_mul_f32 v117, v117, v134
    v_cvt_pk_bf16_f32 v140, v116, v117
    v_mul_f32 v118, v118, v134
    v_mfma_f32_32x32x16_bf16 v[64:79], v[224:227], v[80:83], v[64:79]
    s_add_u32 m0, s37, 130560
    s_nop 0
    buffer_load_dwordx4 v1, s[16:19], m0 offen lds
    v_mul_f32 v119, v119, v134
    v_cvt_pk_bf16_f32 v141, v118, v119
    s_waitcnt lgkmcnt(4)
    v_mfma_f32_32x32x16_bf16 v[64:79], v[228:231], v[84:87], v[64:79]
    v_mul_f32 v120, v120, v134
    v_mul_f32 v121, v121, v134
    v_cvt_pk_bf16_f32 v142, v120, v121
    v_mul_f32 v122, v122, v135
    v_mul_f32 v123, v123, v135
    v_cvt_pk_bf16_f32 v143, v122, v123
    v_mfma_f32_32x32x16_bf16 v[64:79], v[232:235], v[88:91], v[64:79]
    ds_write_b64 v33, v[140:141] offset:8
    v_mul_f32 v124, v124, v135
    v_mul_f32 v125, v125, v135
    v_cvt_pk_bf16_f32 v144, v124, v125
    v_mul_f32 v126, v126, v135
    v_mul_f32 v127, v127, v135
    v_mfma_f32_32x32x16_bf16 v[64:79], v[236:239], v[92:95], v[64:79]
    s_add_u32 m0, s37, 134656
    s_nop 0
    buffer_load_dwordx4 v1, s[16:19], m0 offen lds
    ds_write_b64 v33, v[142:143] offset:16
    s_waitcnt lgkmcnt(3)
    v_mfma_f32_32x32x16_bf16 v[64:79], v[240:243], v[96:99], v[64:79]
    v_cvt_pk_bf16_f32 v145, v126, v127
    v_mul_f32 v128, v128, v135
    v_mul_f32 v129, v129, v135
    v_cvt_pk_bf16_f32 v146, v128, v129
    v_mul_f32 v130, v130, v135
    v_mul_f32 v131, v131, v135
    v_mfma_f32_32x32x16_bf16 v[64:79], v[244:247], v[100:103], v[64:79]
    ds_write_b64 v33, v[144:145] offset:24
    v_cvt_pk_bf16_f32 v147, v130, v131
    v_mul_f32 v5, 0x3fb8aa3b, v11
    v_mfma_f32_32x32x16_bf16 v[64:79], v[248:251], v[104:107], v[64:79]
    ds_write_b64 v33, v[146:147] offset:32
    v_mfma_f32_32x32x16_bf16 v[64:79], v[252:255], v[180:183], v[64:79]
    v_mfma_f32_32x32x16_bf16 v[64:79], v[16:19], v[10:13], v[64:79]
    s_waitcnt lgkmcnt(0)
    s_barrier
    s_mul_i32 s34, s21, 131072
    s_add_u32 s34, s34, 48234496
    s_lshl_b32 s31, s20, 7
    s_add_u32 s35, s34, s31
    v_mov_b32 v136, 1073741824
    s_bitcmp1_b32 s3, 0
    s_cselect_b32 s30, 37888, 0
    v_add_u32 v40, s30, v39
    ds_read_b64_tr_b16 v[164:165], v40 offset:0
    ds_read_b64_tr_b16 v[166:167], v40 offset:4736
    ds_read_b64_tr_b16 v[152:153], v34 offset:0
    ds_read_b64_tr_b16 v[154:155], v34 offset:4736
    ds_read_b64_tr_b16 v[156:157], v35 offset:0
    ds_read_b64_tr_b16 v[158:159], v35 offset:4736
    ds_read_b64_tr_b16 v[160:161], v36 offset:0
    ds_read_b64_tr_b16 v[162:163], v36 offset:4736
    v_pk_mul_f32 v[74:75], v[74:75], v[10:11] op_sel:[0,1] op_sel_hi:[1,1]
    v_pk_mul_f32 v[76:77], v[76:77], v[10:11] op_sel:[0,1] op_sel_hi:[1,1]
    v_pk_mul_f32 v[78:79], v[78:79], v[10:11] op_sel:[0,1] op_sel_hi:[1,1]
    v_cvt_pk_bf16_f32 v148, v74, v75
    v_cvt_pk_bf16_f32 v149, v76, v77
    v_cvt_pk_bf16_f32 v150, v78, v79
    ds_write_b64 v33, v[148:149] offset:9520
    ds_write_b64 v33, v[150:151] offset:9528
    v_max3_f32 v132, v64, v65, v66
    v_max3_f32 v133, -v64, -v65, -v66
    v_max3_f32 v132, v132, v67, v68
    v_max3_f32 v133, v133, -v67, -v68
    v_max3_f32 v132, v132, v69, v70
    v_max3_f32 v133, v133, -v69, -v70
    v_max3_f32 v132, v132, v71, v72
    v_max3_f32 v133, v133, -v71, -v72
    v_max_f32 v132, v132, v73
    v_max_f32_e64 v133, v133, -v73
    s_nop 1
    v_permlane32_swap_b32 v132, v133
    v_max_f32 v132, v132, v133
    v_mul_f32_e64 v132, -v132, v5
    v_mov_b32 v133, v132
    s_nop 1
    v_permlane32_swap_b32 v132, v133
    v_pk_fma_f32 v[112:113], v[64:65], v[4:5], v[132:133] op_sel:[0,1,0] op_sel_hi:[1,1,0]
    v_pk_fma_f32 v[122:123], v[64:65], v[4:5], v[132:133] op_sel:[0,1,1] op_sel_hi:[1,1,1] neg_lo:[1,0,0] neg_hi:[1,0,0]
    v_pk_fma_f32 v[114:115], v[66:67], v[4:5], v[132:133] op_sel:[0,1,0] op_sel_hi:[1,1,0]
    v_pk_fma_f32 v[124:125], v[66:67], v[4:5], v[132:133] op_sel:[0,1,1] op_sel_hi:[1,1,1] neg_lo:[1,0,0] neg_hi:[1,0,0]
    v_exp_f32 v112, v112
    v_exp_f32 v122, v122
    v_exp_f32 v113, v113
    v_exp_f32 v123, v123
    v_exp_f32 v114, v114
    v_exp_f32 v124, v124
    v_exp_f32 v115, v115
    v_exp_f32 v125, v125
    v_pk_fma_f32 v[116:117], v[68:69], v[4:5], v[132:133] op_sel:[0,1,0] op_sel_hi:[1,1,0]
    v_pk_fma_f32 v[126:127], v[68:69], v[4:5], v[132:133] op_sel:[0,1,1] op_sel_hi:[1,1,1] neg_lo:[1,0,0] neg_hi:[1,0,0]
    v_pk_fma_f32 v[118:119], v[70:71], v[4:5], v[132:133] op_sel:[0,1,0] op_sel_hi:[1,1,0]
    v_pk_fma_f32 v[128:129], v[70:71], v[4:5], v[132:133] op_sel:[0,1,1] op_sel_hi:[1,1,1] neg_lo:[1,0,0] neg_hi:[1,0,0]
    v_exp_f32 v116, v116
    v_exp_f32 v126, v126
    v_exp_f32 v117, v117
    v_exp_f32 v127, v127
    v_exp_f32 v118, v118
    v_exp_f32 v128, v128
    v_exp_f32 v119, v119
    v_exp_f32 v129, v129
    v_pk_add_f32 v[138:139], v[112:113], v[114:115]
    v_pk_add_f32 v[140:141], v[122:123], v[124:125]
    v_pk_fma_f32 v[120:121], v[72:73], v[4:5], v[132:133] op_sel:[0,1,0] op_sel_hi:[1,1,0]
    v_pk_fma_f32 v[130:131], v[72:73], v[4:5], v[132:133] op_sel:[0,1,1] op_sel_hi:[1,1,1] neg_lo:[1,0,0] neg_hi:[1,0,0]
    v_exp_f32 v120, v120
    v_exp_f32 v130, v130
    v_exp_f32 v121, v121
    v_exp_f32 v131, v131
    v_pk_add_f32 v[138:139], v[138:139], v[116:117]
    v_pk_add_f32 v[140:141], v[140:141], v[126:127]
    v_pk_add_f32 v[138:139], v[138:139], v[118:119]
    v_pk_add_f32 v[140:141], v[140:141], v[128:129]
    v_pk_add_f32 v[138:139], v[138:139], v[120:121]
    v_pk_add_f32 v[140:141], v[140:141], v[130:131]
    v_add_f32 v134, v138, v139
    v_add_f32 v135, v140, v141
    s_nop 1
    v_permlane32_swap_b32 v134, v135
    v_add_f32 v134, v134, v135
    v_rcp_f32 v134, v134
    s_nop 0
    v_mov_b32 v135, v134
    s_nop 1
    v_permlane32_swap_b32 v134, v135
    v_pk_mul_f32 v[112:113], v[112:113], v[134:135] op_sel:[0,0] op_sel_hi:[1,0]
    v_pk_mul_f32 v[114:115], v[114:115], v[134:135] op_sel:[0,0] op_sel_hi:[1,0]
    v_pk_mul_f32 v[116:117], v[116:117], v[134:135] op_sel:[0,0] op_sel_hi:[1,0]
    v_pk_mul_f32 v[118:119], v[118:119], v[134:135] op_sel:[0,0] op_sel_hi:[1,0]
    v_pk_mul_f32 v[120:121], v[120:121], v[134:135] op_sel:[0,0] op_sel_hi:[1,0]
    v_cvt_pk_bf16_f32 v138, v112, v113
    v_cvt_pk_bf16_f32 v139, v114, v115
    ds_write_b64 v33, v[138:139] offset:9472
    v_cvt_pk_bf16_f32 v140, v116, v117
    v_cvt_pk_bf16_f32 v141, v118, v119
    ds_write_b64 v33, v[140:141] offset:9480
    v_cvt_pk_bf16_f32 v142, v120, v121
    v_pk_mul_f32 v[122:123], v[122:123], v[134:135] op_sel:[0,1] op_sel_hi:[1,1]
    v_pk_mul_f32 v[124:125], v[124:125], v[134:135] op_sel:[0,1] op_sel_hi:[1,1]
    v_pk_mul_f32 v[126:127], v[126:127], v[134:135] op_sel:[0,1] op_sel_hi:[1,1]
    v_pk_mul_f32 v[128:129], v[128:129], v[134:135] op_sel:[0,1] op_sel_hi:[1,1]
    v_pk_mul_f32 v[130:131], v[130:131], v[134:135] op_sel:[0,1] op_sel_hi:[1,1]
    v_cvt_pk_bf16_f32 v143, v122, v123
    ds_write_b64 v33, v[142:143] offset:9488
    v_cvt_pk_bf16_f32 v144, v124, v125
    v_cvt_pk_bf16_f32 v145, v126, v127
    ds_write_b64 v33, v[144:145] offset:9496
    v_cvt_pk_bf16_f32 v146, v128, v129
    v_cvt_pk_bf16_f32 v147, v130, v131
    ds_write_b64 v33, v[146:147] offset:9504
    s_waitcnt lgkmcnt(0)
    s_barrier
    ds_read_b64_tr_b16 v[92:93], v40 offset:9472
    ds_read_b64_tr_b16 v[94:95], v40 offset:14208
    ds_read_b64_tr_b16 v[80:81], v34 offset:9472
    ds_read_b64_tr_b16 v[82:83], v34 offset:14208
    ds_read_b64_tr_b16 v[84:85], v35 offset:9472
    ds_read_b64_tr_b16 v[86:87], v35 offset:14208
    ds_read_b64_tr_b16 v[88:89], v36 offset:9472
    ds_read_b64_tr_b16 v[90:91], v36 offset:14208
    v_mfma_f32_16x16x32_bf16 v[168:171], v[152:155], v[164:167], v[168:171]
    v_mfma_f32_16x16x32_bf16 v[172:175], v[156:159], v[164:167], v[172:175]
    v_mfma_f32_16x16x32_bf16 v[176:179], v[160:163], v[164:167], v[176:179]
    s_waitcnt lgkmcnt(0)
    v_mfma_f32_16x16x32_bf16 v[168:171], v[80:83], v[92:95], v[168:171]
    v_mfma_f32_16x16x32_bf16 v[172:175], v[84:87], v[92:95], v[172:175]
    v_mfma_f32_16x16x32_bf16 v[176:179], v[88:91], v[92:95], v[176:179]
    s_nop 5
    buffer_store_dwordx4 v[168:171], v188, s[8:11], s35 offen sc1
    buffer_store_dwordx4 v[172:175], v189, s[8:11], s35 offen sc1
    buffer_store_dwordx4 v[176:179], v190, s[8:11], s35 offen sc1
    s_add_u32 m0, s37, 138752
    s_nop 0
    buffer_load_dwordx4 v1, s[16:19], m0 offen lds
    s_add_u32 m0, s37, 142848
    s_nop 0
    buffer_load_dwordx4 v1, s[16:19], m0 offen lds
    s_add_u32 m0, s37, 146944
    s_nop 0
    buffer_load_dwordx4 v1, s[16:19], m0 offen lds
    s_add_u32 m0, s37, 151040
    s_nop 0
    buffer_load_dwordx4 v1, s[16:19], m0 offen lds
    s_add_u32 m0, s37, 155136
    s_nop 0
    buffer_load_dwordx4 v1, s[16:19], m0 offen lds
    ds_read_b64 v[80:81], v47 offset:0
    ds_read_b64 v[82:83], v47 offset:8
    ds_read_b64 v[84:85], v47 offset:16
    ds_read_b64 v[86:87], v47 offset:24
    ds_read_b64 v[88:89], v47 offset:32
    v_mov_b32 v90, 0
    v_mov_b32 v91, 0
    ds_read_b64 v[92:93], v47 offset:128
    ds_read_b64 v[94:95], v47 offset:136
    ds_read_b64 v[96:97], v47 offset:144
    ds_read_b64 v[98:99], v47 offset:152
    ds_read_b64 v[100:101], v47 offset:160
    v_mov_b32 v102, 0
    v_mov_b32 v103, 0
    s_lshl_b32 s30, s3, 4
    s_add_u32 s30, s30, s20
    s_lshl_b32 s31, s30, 11
    s_add_u32 s34, s34, s31
    s_lshl_b32 s35, s21, 13
    s_add_u32 s35, s35, 53477376
    s_lshl_b32 s31, s30, 7
    s_add_u32 s36, s35, s31
    v_and_b32 v132, 7, v0
    v_lshrrev_b32 v133, 5, v0
    v_lshlrev_b32 v132, 3, v132
    v_lshl_add_u32 v132, v133, 2, v132
    v_bfe_u32 v133, v0, 3, 2
    v_lshl_add_u32 v138, v133, 17, v132
    v_add_u32 v141, 524288, v138
    v_lshrrev_b32 v132, 2, v0
    v_and_b32 v133, 3, v0
    v_lshlrev_b32 v133, 4, v133
    v_lshl_add_u32 v132, v132, 7, v133
    v_cmp_gt_u32 vcc, 60, v0
    s_nop 1
    v_cndmask_b32 v139, v136, v132, vcc
    s_mul_i32 s31, s3, 960
    s_add_u32 s35, s35, s31
    s_add_u32 s35, s35, s31
    s_lshr_b32 s32, s20, 1
    s_lshl_b32 s32, s32, 17
    s_add_u32 s35, s35, s32
    v_add_u32 v132, s31, v1
    v_add_u32 v133, 0x1000, v1
    v_cndmask_b32 v140, v133, v132, vcc
    v_mov_b32 v122, 0
    v_mov_b32 v123, 0
    v_mov_b32 v134, 0
    v_mov_b32 v135, 0
    s_cmp_ge_u32 s30, 60
    s_cbranch_scc1 pk_nored57
    s_nop 4
    s_sleep 12
pk_poll58:
    buffer_load_dwordx4 v[56:59], v1, s[8:11], s34 offen sc1
    buffer_load_dwordx4 v[60:63], v1, s[8:11], s34 offen offset:1024 sc1
    s_waitcnt vmcnt(0)
    v_max3_u32 v132, v56, v57, v58
    v_max3_u32 v132, v132, v59, v60
    v_max3_u32 v132, v132, v61, v62
    v_max_u32 v132, v132, v63
    v_cmp_eq_u32 vcc, -1, v132
    s_sub_u32 s22, s22, 1
    s_cbranch_scc1 pk_go59
    s_mov_b64 exec, vcc
    s_cbranch_vccnz pk_poll58
pk_go59:
    s_mov_b64 exec, -1
    s_max_i32 s22, s22, 0
    v_add_f32 v48, v56, v60
    v_add_f32 v49, v57, v61
    v_add_f32 v50, v58, v62
    v_add_f32 v51, v59, v63
    s_nop 0
    v_permlane32_swap_b32 v48, v50
    v_permlane32_swap_b32 v49, v51
    v_add_f32 v48, v48, v50
    v_add_f32 v49, v49, v51
    s_nop 0
    v_add_f32_dpp v50, v48, v48 row_ror:8 row_mask:0xf bank_mask:0xf
    v_add_f32_dpp v51, v49, v49 row_ror:8 row_mask:0xf bank_mask:0xf
    v_mov_b32 v48, v50
    v_mov_b32 v49, v51
    s_nop 0
    v_permlane16_swap_b32 v48, v50
    v_permlane16_swap_b32 v49, v51
    v_add_f32 v48, v48, v50
    v_add_f32 v49, v49, v51
    v_cvt_pk_bf16_f32 v48, v48, v49
    buffer_store_dword v48, v138, s[8:11], s36 offen sc1
    buffer_store_dword v48, v141, s[8:11], s36 offen sc1
pk_nored57:
    s_barrier
    s_nop 4
    s_sleep 14
pk_poll60:
    buffer_load_dwordx4 v[108:111], v139, s[8:11], s35 offen sc1
    s_waitcnt vmcnt(0)
    v_max3_u32 v132, v108, v109, v110
    v_max_u32 v132, v132, v111
    v_cmp_eq_u32 vcc, -1, v132
    s_sub_u32 s22, s22, 1
    s_cbranch_scc1 pk_go61
    s_mov_b64 exec, vcc
    s_cbranch_vccnz pk_poll60
pk_go61:
    s_mov_b64 exec, -1
    s_max_i32 s22, s22, 0
    ds_write_b128 v140, v[108:111]
    v_bfe_u32 v132, v0, 4, 1
    v_mul_u32_u24 v132, 20480, v132
    v_and_b32 v133, 15, v0
    v_lshl_add_u32 v132, v133, 4, v132
    v_lshrrev_b32 v133, 5, v0
    v_lshl_add_u32 v138, v133, 8, v132
    v_lshl_add_u32 v139, v133, 3, v132
    s_waitcnt lgkmcnt(0)
    s_barrier
    ds_read_b64 v[112:113], v46 offset:0
    ds_read_b64 v[114:115], v46 offset:64
    ds_read_b64 v[116:117], v46 offset:128
    ds_read_b64 v[118:119], v46 offset:192
    ds_read_b64 v[120:121], v46 offset:256
    ds_read_b64 v[124:125], v46 offset:1920
    ds_read_b64 v[126:127], v46 offset:1984
    ds_read_b64 v[128:129], v46 offset:2048
    ds_read_b64 v[130:131], v46 offset:2112
    ds_read_b64 v[132:133], v46 offset:2176
    s_lshl_b32 s30, s20, 2
    s_add_u32 s30, s30, s3
    s_mul_i32 s31, s30, 40960
    s_mul_i32 s32, s21, 1280
    s_add_u32 s31, s31, s32
    s_add_u32 s31, s31, 17825792
    s_lshl_b32 s30, s30, 11
    s_lshl_b32 s32, s21, 7
    s_add_u32 s30, s30, s32
    s_add_u32 s30, s30, 29491200
    v_mov_b32 v188, 3
    s_waitcnt lgkmcnt(8)
    v_mfma_f32_32x32x16_bf16 v[48:63], v[112:115], v[80:83], 0
    s_waitcnt lgkmcnt(3)
    v_mfma_f32_32x32x16_bf16 v[64:79], v[124:127], v[92:95], 0
    v_mfma_f32_32x32x16_bf16 v[48:63], v[116:119], v[84:87], v[48:63]
    s_waitcnt lgkmcnt(1)
    v_mfma_f32_32x32x16_bf16 v[64:79], v[128:131], v[96:99], v[64:79]
    v_mfma_f32_32x32x16_bf16 v[48:63], v[120:123], v[88:91], v[48:63]
    s_waitcnt lgkmcnt(0)
    v_mfma_f32_32x32x16_bf16 v[64:79], v[132:135], v[100:103], v[64:79]
    s_nop 7
    s_nop 1
    v_add_f32 v58, s24, v58
    v_rcp_f32 v58, v58
    s_nop 0
    v_mov_b32 v59, v58
    v_pk_mul_f32 v[48:49], v[48:49], v[58:59]
    v_pk_mul_f32 v[50:51], v[50:51], v[58:59]
    v_pk_mul_f32 v[52:53], v[52:53], v[58:59]
    v_pk_mul_f32 v[54:55], v[54:55], v[58:59]
    v_pk_mul_f32 v[56:57], v[56:57], v[58:59]
    v_cvt_pk_bf16_f32 v140, v48, v49
    v_cvt_pk_bf16_f32 v141, v50, v51
    v_cvt_pk_bf16_f32 v142, v52, v53
    v_cvt_pk_bf16_f32 v143, v54, v55
    v_cvt_pk_bf16_f32 v148, v56, v57
    v_add_f32 v74, s24, v74
    v_rcp_f32 v74, v74
    s_nop 0
    v_mov_b32 v75, v74
    v_pk_mul_f32 v[64:65], v[64:65], v[74:75]
    v_pk_mul_f32 v[66:67], v[66:67], v[74:75]
    v_pk_mul_f32 v[68:69], v[68:69], v[74:75]
    v_pk_mul_f32 v[70:71], v[70:71], v[74:75]
    v_pk_mul_f32 v[72:73], v[72:73], v[74:75]
    v_cvt_pk_bf16_f32 v144, v64, v65
    v_cvt_pk_bf16_f32 v145, v66, v67
    v_cvt_pk_bf16_f32 v146, v68, v69
    v_cvt_pk_bf16_f32 v147, v70, v71
    v_cvt_pk_bf16_f32 v149, v72, v73
    s_cmp_eq_u32 s23, 0
    s_cbranch_scc1 pk_slow62
    buffer_store_dwordx4 v[140:143], v138, s[8:11], s31 offen
    buffer_store_dwordx4 v[144:147], v138, s[8:11], s31 offen offset:512
    buffer_store_dwordx2 v[148:149], v139, s[8:11], s31 offen offset:1024
    s_branch pk_join63
pk_slow62:
    buffer_store_dwordx4 v[140:143], v138, s[8:11], s31 offen sc1
    buffer_store_dwordx4 v[144:147], v138, s[8:11], s31 offen offset:512 sc1
    buffer_store_dwordx2 v[148:149], v139, s[8:11], s31 offen offset:1024 sc1
    s_nop 0
pk_join63:
    v_lshlrev_b32 v168, 16, v20
    v_and_b32 v169, 0xffff0000, v20
    v_lshlrev_b32 v170, 16, v21
    v_and_b32 v171, 0xffff0000, v21
    v_lshlrev_b32 v172, 16, v22
    v_and_b32 v173, 0xffff0000, v22
    v_lshlrev_b32 v174, 16, v23
    v_and_b32 v175, 0xffff0000, v23
    v_lshlrev_b32 v176, 16, v24
    v_and_b32 v177, 0xffff0000, v24
    v_lshlrev_b32 v178, 16, v25
    v_and_b32 v179, 0xffff0000, v25
    v_lshlrev_b32 v180, 16, v26
    v_and_b32 v181, 0xffff0000, v26
    v_lshlrev_b32 v182, 16, v27
    v_and_b32 v183, 0xffff0000, v27
    v_lshlrev_b32 v184, 16, v28
    v_and_b32 v185, 0xffff0000, v28
    v_lshlrev_b32 v186, 16, v29
    v_and_b32 v187, 0xffff0000, v29
    v_and_b32 v6, 15, v0
    v_lshlrev_b32 v6, 7, v6
    s_lshr_b32 s32, s27, 1
    s_lshl_b32 s32, s32, 11
    s_add_u32 s32, s32, 29491200
    s_mul_i32 s33, s27, 20480
    s_add_u32 s33, s33, 17825792
    s_waitcnt vmcnt(0)
    s_mov_b64 exec, 1
    s_cmp_eq_u32 s23, 0
    s_cbranch_scc1 pk_slow65
    buffer_store_dword v188, off, s[8:11], s30
    s_branch pk_join66
pk_slow65:
    buffer_store_dword v188, off, s[8:11], s30 sc1
    s_nop 0
pk_join66:
    s_mov_b64 exec, -1
    ds_read_b128 v[128:131], v1 offset:56832
    ds_read_b128 v[132:135], v1 offset:57856
    ds_read_b128 v[136:139], v1 offset:58880
    ds_read_b128 v[140:143], v1 offset:59904
    ds_read_b128 v[144:147], v1 offset:60928
    ds_read_b128 v[148:151], v1 offset:61952
    ds_read_b128 v[152:155], v1 offset:62976
    ds_read_b128 v[156:159], v1 offset:64000
    ds_read_b128 v[160:163], v1 offset:65024
    s_nop 4
pk_poll67:
    buffer_load_dword v189, v6, s[8:11], s32 offen sc1
    s_waitcnt vmcnt(0)
    v_cmp_ne_u32 vcc, 3, v189
    s_sub_u32 s22, s22, 1
    s_cbranch_scc1 pk_go68
    s_mov_b64 exec, vcc
    s_cbranch_vccnz pk_poll67
pk_go68:
    s_mov_b64 exec, -1
    s_max_i32 s22, s22, 0
    buffer_load_dwordx4 v[48:51], v1, s[8:11], s33 offen offset:0 sc1
    buffer_load_dwordx4 v[52:55], v1, s[8:11], s33 offen offset:1024 sc1
    buffer_load_dwordx4 v[56:59], v1, s[8:11], s33 offen offset:2048 sc1
    buffer_load_dwordx4 v[60:63], v1, s[8:11], s33 offen offset:3072 sc1
    s_add_u32 s33, s33, 4096
    buffer_load_dwordx4 v[64:67], v1, s[8:11], s33 offen offset:0 sc1
    buffer_load_dwordx4 v[68:71], v1, s[8:11], s33 offen offset:1024 sc1
    buffer_load_dwordx4 v[72:75], v1, s[8:11], s33 offen offset:2048 sc1
    buffer_load_dwordx4 v[76:79], v1, s[8:11], s33 offen offset:3072 sc1
    s_add_u32 s33, s33, 4096
    buffer_load_dwordx4 v[80:83], v1, s[8:11], s33 offen offset:0 sc1
    buffer_load_dwordx4 v[84:87], v1, s[8:11], s33 offen offset:1024 sc1
    buffer_load_dwordx4 v[88:91], v1, s[8:11], s33 offen offset:2048 sc1
    buffer_load_dwordx4 v[92:95], v1, s[8:11], s33 offen offset:3072 sc1
    s_add_u32 s33, s33, 4096
    buffer_load_dwordx4 v[96:99], v1, s[8:11], s33 offen offset:0 sc1
    buffer_load_dwordx4 v[100:103], v1, s[8:11], s33 offen offset:1024 sc1
    buffer_load_dwordx4 v[104:107], v1, s[8:11], s33 offen offset:2048 sc1
    buffer_load_dwordx4 v[108:111], v1, s[8:11], s33 offen offset:3072 sc1
    s_add_u32 s33, s33, 4096
    buffer_load_dwordx4 v[112:115], v1, s[8:11], s33 offen offset:0 sc1
    buffer_load_dwordx4 v[116:119], v1, s[8:11], s33 offen offset:1024 sc1
    buffer_load_dwordx4 v[120:123], v1, s[8:11], s33 offen offset:2048 sc1
    buffer_load_dwordx4 v[124:127], v1, s[8:11], s33 offen offset:3072 sc1
    s_mov_b32 s16, s78
    s_and_b32 s17, s79, 0xffff
    s_mov_b32 s18, 2621440
    v_and_b32 v6, 15, v0
    v_mul_u32_u24 v6, 1280, v6
    v_lshrrev_b32 v7, 4, v0
    v_lshl_add_u32 v2, v7, 4, v6
    v_lshl_add_u32 v3, v7, 3, v6
    s_mul_i32 s30, s27, 20480
    s_mul_i32 s31, s28, 160
    s_add_u32 s30, s30, s31
    s_waitcnt vmcnt(19)
    ds_read_b128 v[164:167], v30 offset:512
    s_waitcnt lgkmcnt(9)
    v_mfma_f32_16x16x32_bf16 v[168:171], v[128:131], v[48:51], v[168:171]
    ds_read_b128 v[128:131], v30 offset:1536
    s_waitcnt lgkmcnt(9)
    v_mfma_f32_16x16x32_bf16 v[172:175], v[132:135], v[48:51], v[172:175]
    ds_read_b128 v[132:135], v30 offset:2560
    s_waitcnt lgkmcnt(9)
    v_mfma_f32_16x16x32_bf16 v[176:179], v[136:139], v[48:51], v[176:179]
    ds_read_b128 v[136:139], v30 offset:3584
    s_waitcnt lgkmcnt(9)
    v_mfma_f32_16x16x32_bf16 v[180:183], v[140:143], v[48:51], v[180:183]
    ds_read_b128 v[140:143], v30 offset:4608
    s_waitcnt lgkmcnt(9)
    v_mfma_f32_16x16x32_bf16 v[184:187], v[144:147], v[48:51], v[184:187]
    s_waitcnt vmcnt(18)
    ds_read_b128 v[144:147], v30 offset:5632
    s_waitcnt lgkmcnt(9)
    v_mfma_f32_16x16x32_bf16 v[168:171], v[148:151], v[52:55], v[168:171]
    ds_read_b128 v[148:151], v30 offset:6656
    s_waitcnt lgkmcnt(9)
    v_mfma_f32_16x16x32_bf16 v[172:175], v[152:155], v[52:55], v[172:175]
    ds_read_b128 v[152:155], v30 offset:7680
    s_waitcnt lgkmcnt(9)
    v_mfma_f32_16x16x32_bf16 v[176:179], v[156:159], v[52:55], v[176:179]
    ds_read_b128 v[156:159], v30 offset:8704
    s_waitcnt lgkmcnt(9)
    v_mfma_f32_16x16x32_bf16 v[180:183], v[160:163], v[52:55], v[180:183]
    ds_read_b128 v[160:163], v30 offset:9728
    s_waitcnt lgkmcnt(9)
    v_mfma_f32_16x16x32_bf16 v[184:187], v[164:167], v[52:55], v[184:187]
    s_waitcnt vmcnt(17)
    ds_read_b128 v[164:167], v30 offset:10752
    s_waitcnt lgkmcnt(9)
    v_mfma_f32_16x16x32_bf16 v[168:171], v[128:131], v[56:59], v[168:171]
    ds_read_b128 v[128:131], v30 offset:11776
    s_waitcnt lgkmcnt(9)
    v_mfma_f32_16x16x32_bf16 v[172:175], v[132:135], v[56:59], v[172:175]
    ds_read_b128 v[132:135], v30 offset:12800
    s_waitcnt lgkmcnt(9)
    v_mfma_f32_16x16x32_bf16 v[176:179], v[136:139], v[56:59], v[176:179]
    ds_read_b128 v[136:139], v30 offset:13824
    s_waitcnt lgkmcnt(9)
    v_mfma_f32_16x16x32_bf16 v[180:183], v[140:143], v[56:59], v[180:183]
    ds_read_b128 v[140:143], v30 offset:14848
    s_waitcnt lgkmcnt(9)
    v_mfma_f32_16x16x32_bf16 v[184:187], v[144:147], v[56:59], v[184:187]
    s_waitcnt vmcnt(16)
    ds_read_b128 v[144:147], v30 offset:15872
    s_waitcnt lgkmcnt(9)
    v_mfma_f32_16x16x32_bf16 v[168:171], v[148:151], v[60:63], v[168:171]
    ds_read_b128 v[148:151], v30 offset:16896
    s_waitcnt lgkmcnt(9)
    v_mfma_f32_16x16x32_bf16 v[172:175], v[152:155], v[60:63], v[172:175]
    ds_read_b128 v[152:155], v30 offset:17920
    s_waitcnt lgkmcnt(9)
    v_mfma_f32_16x16x32_bf16 v[176:179], v[156:159], v[60:63], v[176:179]
    ds_read_b128 v[156:159], v30 offset:18944
    s_waitcnt lgkmcnt(9)
    v_mfma_f32_16x16x32_bf16 v[180:183], v[160:163], v[60:63], v[180:183]
    ds_read_b128 v[160:163], v30 offset:19968
    s_waitcnt lgkmcnt(9)
    v_mfma_f32_16x16x32_bf16 v[184:187], v[164:167], v[60:63], v[184:187]
    s_waitcnt vmcnt(15)
    ds_read_b128 v[164:167], v30 offset:20992
    s_waitcnt lgkmcnt(9)
    v_mfma_f32_16x16x32_bf16 v[168:171], v[128:131], v[64:67], v[168:171]
    ds_read_b128 v[128:131], v30 offset:22016
    s_waitcnt lgkmcnt(9)
    v_mfma_f32_16x16x32_bf16 v[172:175], v[132:135], v[64:67], v[172:175]
    ds_read_b128 v[132:135], v30 offset:23040
    s_waitcnt lgkmcnt(9)
    v_mfma_f32_16x16x32_bf16 v[176:179], v[136:139], v[64:67], v[176:179]
    ds_read_b128 v[136:139], v30 offset:24064
    s_waitcnt lgkmcnt(9)
    v_mfma_f32_16x16x32_bf16 v[180:183], v[140:143], v[64:67], v[180:183]
    ds_read_b128 v[140:143], v30 offset:25088
    s_waitcnt lgkmcnt(9)
    v_mfma_f32_16x16x32_bf16 v[184:187], v[144:147], v[64:67], v[184:187]
    s_waitcnt vmcnt(14)
    ds_read_b128 v[144:147], v30 offset:26112
    s_waitcnt lgkmcnt(9)
    v_mfma_f32_16x16x32_bf16 v[168:171], v[148:151], v[68:71], v[168:171]
    ds_read_b128 v[148:151], v30 offset:27136
    s_waitcnt lgkmcnt(9)
    v_mfma_f32_16x16x32_bf16 v[172:175], v[152:155], v[68:71], v[172:175]
    ds_read_b128 v[152:155], v30 offset:28160
    s_waitcnt lgkmcnt(9)
    v_mfma_f32_16x16x32_bf16 v[176:179], v[156:159], v[68:71], v[176:179]
    ds_read_b128 v[156:159], v30 offset:29184
    s_waitcnt lgkmcnt(9)
    v_mfma_f32_16x16x32_bf16 v[180:183], v[160:163], v[68:71], v[180:183]
    ds_read_b128 v[160:163], v30 offset:30208
    s_waitcnt lgkmcnt(9)
    v_mfma_f32_16x16x32_bf16 v[184:187], v[164:167], v[68:71], v[184:187]
    s_waitcnt vmcnt(13)
    ds_read_b128 v[164:167], v30 offset:31232
    s_waitcnt lgkmcnt(9)
    v_mfma_f32_16x16x32_bf16 v[168:171], v[128:131], v[72:75], v[168:171]
    ds_read_b128 v[128:131], v30 offset:32256
    s_waitcnt lgkmcnt(9)
    v_mfma_f32_16x16x32_bf16 v[172:175], v[132:135], v[72:75], v[172:175]
    ds_read_b128 v[132:135], v30 offset:33280
    s_waitcnt lgkmcnt(9)
    v_mfma_f32_16x16x32_bf16 v[176:179], v[136:139], v[72:75], v[176:179]
    ds_read_b128 v[136:139], v30 offset:34304
    s_waitcnt lgkmcnt(9)
    v_mfma_f32_16x16x32_bf16 v[180:183], v[140:143], v[72:75], v[180:183]
    ds_read_b128 v[140:143], v30 offset:35328
    s_waitcnt lgkmcnt(9)
    v_mfma_f32_16x16x32_bf16 v[184:187], v[144:147], v[72:75], v[184:187]
    s_waitcnt vmcnt(12)
    ds_read_b128 v[144:147], v30 offset:36352
    s_waitcnt lgkmcnt(9)
    v_mfma_f32_16x16x32_bf16 v[168:171], v[148:151], v[76:79], v[168:171]
    ds_read_b128 v[148:151], v30 offset:37376
    s_waitcnt lgkmcnt(9)
    v_mfma_f32_16x16x32_bf16 v[172:175], v[152:155], v[76:79], v[172:175]
    ds_read_b128 v[152:155], v30 offset:38400
    s_waitcnt lgkmcnt(9)
    v_mfma_f32_16x16x32_bf16 v[176:179], v[156:159], v[76:79], v[176:179]
    ds_read_b128 v[156:159], v30 offset:39424
    s_waitcnt lgkmcnt(9)
    v_mfma_f32_16x16x32_bf16 v[180:183], v[160:163], v[76:79], v[180:183]
    ds_read_b128 v[160:163], v30 offset:40448
    s_waitcnt lgkmcnt(9)
    v_mfma_f32_16x16x32_bf16 v[184:187], v[164:167], v[76:79], v[184:187]
    s_waitcnt vmcnt(11)
    ds_read_b128 v[164:167], v30 offset:41472
    s_waitcnt lgkmcnt(9)
    v_mfma_f32_16x16x32_bf16 v[168:171], v[128:131], v[80:83], v[168:171]
    ds_read_b128 v[128:131], v30 offset:42496
    s_waitcnt lgkmcnt(9)
    v_mfma_f32_16x16x32_bf16 v[172:175], v[132:135], v[80:83], v[172:175]
    ds_read_b128 v[132:135], v30 offset:43520
    s_waitcnt lgkmcnt(9)
    v_mfma_f32_16x16x32_bf16 v[176:179], v[136:139], v[80:83], v[176:179]
    ds_read_b128 v[136:139], v30 offset:44544
    s_waitcnt lgkmcnt(9)
    v_mfma_f32_16x16x32_bf16 v[180:183], v[140:143], v[80:83], v[180:183]
    ds_read_b128 v[140:143], v30 offset:45568
    s_waitcnt lgkmcnt(9)
    v_mfma_f32_16x16x32_bf16 v[184:187], v[144:147], v[80:83], v[184:187]
    s_waitcnt vmcnt(10)
    ds_read_b128 v[144:147], v30 offset:46592
    s_waitcnt lgkmcnt(9)
    v_mfma_f32_16x16x32_bf16 v[168:171], v[148:151], v[84:87], v[168:171]
    ds_read_b128 v[148:151], v30 offset:47616
    s_waitcnt lgkmcnt(9)
    v_mfma_f32_16x16x32_bf16 v[172:175], v[152:155], v[84:87], v[172:175]
    ds_read_b128 v[152:155], v30 offset:48640
    s_waitcnt lgkmcnt(9)
    v_mfma_f32_16x16x32_bf16 v[176:179], v[156:159], v[84:87], v[176:179]
    ds_read_b128 v[156:159], v30 offset:49664
    s_waitcnt lgkmcnt(9)
    v_mfma_f32_16x16x32_bf16 v[180:183], v[160:163], v[84:87], v[180:183]
    ds_read_b128 v[160:163], v30 offset:50688
    s_waitcnt lgkmcnt(9)
    v_mfma_f32_16x16x32_bf16 v[184:187], v[164:167], v[84:87], v[184:187]
    s_waitcnt vmcnt(9)
    ds_read_b128 v[164:167], v30 offset:51712
    s_waitcnt lgkmcnt(9)
    v_mfma_f32_16x16x32_bf16 v[168:171], v[128:131], v[88:91], v[168:171]
    ds_read_b128 v[128:131], v30 offset:52736
    s_waitcnt lgkmcnt(9)
    v_mfma_f32_16x16x32_bf16 v[172:175], v[132:135], v[88:91], v[172:175]
    ds_read_b128 v[132:135], v30 offset:53760
    s_waitcnt lgkmcnt(9)
    v_mfma_f32_16x16x32_bf16 v[176:179], v[136:139], v[88:91], v[176:179]
    ds_read_b128 v[136:139], v30 offset:54784
    s_waitcnt lgkmcnt(9)
    v_mfma_f32_16x16x32_bf16 v[180:183], v[140:143], v[88:91], v[180:183]
    ds_read_b128 v[140:143], v30 offset:55808
    s_waitcnt lgkmcnt(9)
    v_mfma_f32_16x16x32_bf16 v[184:187], v[144:147], v[88:91], v[184:187]
    s_waitcnt vmcnt(8)
    ds_read_b128 v[144:147], v30 offset:56832
    s_waitcnt lgkmcnt(9)
    v_mfma_f32_16x16x32_bf16 v[168:171], v[148:151], v[92:95], v[168:171]
    ds_read_b128 v[148:151], v30 offset:57856
    s_waitcnt lgkmcnt(9)
    v_mfma_f32_16x16x32_bf16 v[172:175], v[152:155], v[92:95], v[172:175]
    ds_read_b128 v[152:155], v30 offset:58880
    s_waitcnt lgkmcnt(9)
    v_mfma_f32_16x16x32_bf16 v[176:179], v[156:159], v[92:95], v[176:179]
    ds_read_b128 v[156:159], v30 offset:59904
    s_waitcnt lgkmcnt(9)
    v_mfma_f32_16x16x32_bf16 v[180:183], v[160:163], v[92:95], v[180:183]
    ds_read_b128 v[160:163], v30 offset:60928
    s_waitcnt lgkmcnt(9)
    v_mfma_f32_16x16x32_bf16 v[184:187], v[164:167], v[92:95], v[184:187]
    s_waitcnt vmcnt(7)
    ds_read_b128 v[164:167], v30 offset:61952
    s_waitcnt lgkmcnt(9)
    v_mfma_f32_16x16x32_bf16 v[168:171], v[128:131], v[96:99], v[168:171]
    ds_read_b128 v[128:131], v30 offset:62976
    s_waitcnt lgkmcnt(9)
    v_mfma_f32_16x16x32_bf16 v[172:175], v[132:135], v[96:99], v[172:175]
    ds_read_b128 v[132:135], v30 offset:64000
    s_waitcnt lgkmcnt(9)
    v_mfma_f32_16x16x32_bf16 v[176:179], v[136:139], v[96:99], v[176:179]
    ds_read_b128 v[136:139], v30 offset:65024
    s_waitcnt lgkmcnt(9)
    v_mfma_f32_16x16x32_bf16 v[180:183], v[140:143], v[96:99], v[180:183]
    ds_read_b128 v[140:143], v31 offset:512
    s_waitcnt lgkmcnt(9)
    v_mfma_f32_16x16x32_bf16 v[184:187], v[144:147], v[96:99], v[184:187]
    s_waitcnt vmcnt(6)
    ds_read_b128 v[144:147], v31 offset:1536
    s_waitcnt lgkmcnt(9)
    v_mfma_f32_16x16x32_bf16 v[168:171], v[148:151], v[100:103], v[168:171]
    ds_read_b128 v[148:151], v31 offset:2560
    s_waitcnt lgkmcnt(9)
    v_mfma_f32_16x16x32_bf16 v[172:175], v[152:155], v[100:103], v[172:175]
    ds_read_b128 v[152:155], v31 offset:3584
    s_waitcnt lgkmcnt(9)
    v_mfma_f32_16x16x32_bf16 v[176:179], v[156:159], v[100:103], v[176:179]
    ds_read_b128 v[156:159], v31 offset:4608
    s_waitcnt lgkmcnt(9)
    v_mfma_f32_16x16x32_bf16 v[180:183], v[160:163], v[100:103], v[180:183]
    ds_read_b128 v[160:163], v31 offset:5632
    s_waitcnt lgkmcnt(9)
    v_mfma_f32_16x16x32_bf16 v[184:187], v[164:167], v[100:103], v[184:187]
    s_waitcnt vmcnt(5)
    ds_read_b128 v[164:167], v31 offset:6656
    s_waitcnt lgkmcnt(9)
    v_mfma_f32_16x16x32_bf16 v[168:171], v[128:131], v[104:107], v[168:171]
    ds_read_b128 v[128:131], v31 offset:7680
    s_waitcnt lgkmcnt(9)
    v_mfma_f32_16x16x32_bf16 v[172:175], v[132:135], v[104:107], v[172:175]
    ds_read_b128 v[132:135], v31 offset:8704
    s_waitcnt lgkmcnt(9)
    v_mfma_f32_16x16x32_bf16 v[176:179], v[136:139], v[104:107], v[176:179]
    ds_read_b128 v[136:139], v31 offset:9728
    s_waitcnt lgkmcnt(9)
    v_mfma_f32_16x16x32_bf16 v[180:183], v[140:143], v[104:107], v[180:183]
    ds_read_b128 v[140:143], v31 offset:10752
    s_waitcnt lgkmcnt(9)
    v_mfma_f32_16x16x32_bf16 v[184:187], v[144:147], v[104:107], v[184:187]
    s_waitcnt vmcnt(4)
    ds_read_b128 v[144:147], v31 offset:11776
    s_waitcnt lgkmcnt(9)
    v_mfma_f32_16x16x32_bf16 v[168:171], v[148:151], v[108:111], v[168:171]
    ds_read_b128 v[148:151], v31 offset:12800
    s_waitcnt lgkmcnt(9)
    v_mfma_f32_16x16x32_bf16 v[172:175], v[152:155], v[108:111], v[172:175]
    ds_read_b128 v[152:155], v31 offset:13824
    s_waitcnt lgkmcnt(9)
    v_mfma_f32_16x16x32_bf16 v[176:179], v[156:159], v[108:111], v[176:179]
    ds_read_b128 v[156:159], v31 offset:14848
    s_waitcnt lgkmcnt(9)
    v_mfma_f32_16x16x32_bf16 v[180:183], v[160:163], v[108:111], v[180:183]
    ds_read_b128 v[160:163], v31 offset:15872
    s_waitcnt lgkmcnt(9)
    v_mfma_f32_16x16x32_bf16 v[184:187], v[164:167], v[108:111], v[184:187]
    s_waitcnt vmcnt(3)
    ds_read_b128 v[164:167], v31 offset:16896
    s_waitcnt lgkmcnt(9)
    v_mfma_f32_16x16x32_bf16 v[168:171], v[128:131], v[112:115], v[168:171]
    ds_read_b128 v[128:131], v31 offset:17920
    s_waitcnt lgkmcnt(9)
    v_mfma_f32_16x16x32_bf16 v[172:175], v[132:135], v[112:115], v[172:175]
    ds_read_b128 v[132:135], v31 offset:18944
    s_waitcnt lgkmcnt(9)
    v_mfma_f32_16x16x32_bf16 v[176:179], v[136:139], v[112:115], v[176:179]
    ds_read_b128 v[136:139], v31 offset:19968
    s_waitcnt lgkmcnt(9)
    v_mfma_f32_16x16x32_bf16 v[180:183], v[140:143], v[112:115], v[180:183]
    ds_read_b128 v[140:143], v31 offset:20992
    s_waitcnt lgkmcnt(9)
    v_mfma_f32_16x16x32_bf16 v[184:187], v[144:147], v[112:115], v[184:187]
    s_waitcnt vmcnt(2)
    ds_read_b128 v[144:147], v31 offset:22016
    s_waitcnt lgkmcnt(9)
    v_mfma_f32_16x16x32_bf16 v[168:171], v[148:151], v[116:119], v[168:171]
    ds_read_b128 v[148:151], v31 offset:23040
    s_waitcnt lgkmcnt(9)
    v_mfma_f32_16x16x32_bf16 v[172:175], v[152:155], v[116:119], v[172:175]
    ds_read_b128 v[152:155], v31 offset:24064
    s_waitcnt lgkmcnt(9)
    v_mfma_f32_16x16x32_bf16 v[176:179], v[156:159], v[116:119], v[176:179]
    ds_read_b128 v[156:159], v31 offset:25088
    s_waitcnt lgkmcnt(9)
    v_mfma_f32_16x16x32_bf16 v[180:183], v[160:163], v[116:119], v[180:183]
    ds_read_b128 v[160:163], v31 offset:26112
    s_waitcnt lgkmcnt(9)
    v_mfma_f32_16x16x32_bf16 v[184:187], v[164:167], v[116:119], v[184:187]
    s_waitcnt vmcnt(1)
    ds_read_b128 v[164:167], v31 offset:27136
    s_waitcnt lgkmcnt(9)
    v_mfma_f32_16x16x32_bf16 v[168:171], v[128:131], v[120:123], v[168:171]
    s_waitcnt lgkmcnt(8)
    v_mfma_f32_16x16x32_bf16 v[172:175], v[132:135], v[120:123], v[172:175]
    s_waitcnt lgkmcnt(7)
    v_mfma_f32_16x16x32_bf16 v[176:179], v[136:139], v[120:123], v[176:179]
    s_waitcnt lgkmcnt(6)
    v_mfma_f32_16x16x32_bf16 v[180:183], v[140:143], v[120:123], v[180:183]
    s_waitcnt lgkmcnt(5)
    v_mfma_f32_16x16x32_bf16 v[184:187], v[144:147], v[120:123], v[184:187]
    s_waitcnt vmcnt(0)
    s_waitcnt lgkmcnt(4)
    v_mfma_f32_16x16x32_bf16 v[168:171], v[148:151], v[124:127], v[168:171]
    s_waitcnt lgkmcnt(3)
    v_mfma_f32_16x16x32_bf16 v[172:175], v[152:155], v[124:127], v[172:175]
    s_waitcnt lgkmcnt(2)
    v_mfma_f32_16x16x32_bf16 v[176:179], v[156:159], v[124:127], v[176:179]
    s_waitcnt lgkmcnt(1)
    v_mfma_f32_16x16x32_bf16 v[180:183], v[160:163], v[124:127], v[180:183]
    s_waitcnt lgkmcnt(0)
    v_mfma_f32_16x16x32_bf16 v[184:187], v[164:167], v[124:127], v[184:187]
    v_cvt_pk_bf16_f32 v20, v168, v169
    v_cvt_pk_bf16_f32 v21, v170, v171
    v_cvt_pk_bf16_f32 v22, v172, v173
    v_cvt_pk_bf16_f32 v23, v174, v175
    v_cvt_pk_bf16_f32 v24, v176, v177
    v_cvt_pk_bf16_f32 v25, v178, v179
    v_cvt_pk_bf16_f32 v26, v180, v181
    v_cvt_pk_bf16_f32 v27, v182, v183
    v_cvt_pk_bf16_f32 v28, v184, v185
    v_cvt_pk_bf16_f32 v29, v186, v187
    buffer_store_dwordx4 v[20:23], v2, s[16:19], s30 offen
    buffer_store_dwordx4 v[24:27], v2, s[16:19], s30 offen offset:64
    buffer_store_dwordx2 v[28:29], v3, s[16:19], s30 offen offset:128
pk_END:
    s_endpgm
.section .rodata,"a"
.p2align 6
.amdhsa_kernel pk_kernel
  .amdhsa_next_free_vgpr 512
  .amdhsa_next_free_sgpr 102
  .amdhsa_accum_offset 256
  .amdhsa_group_segment_fixed_size 0
  .amdhsa_kernarg_size 80
  .amdhsa_user_sgpr_count 2
  .amdhsa_user_sgpr_kernarg_segment_ptr 1
  .amdhsa_system_sgpr_workgroup_id_x 1
.end_amdhsa_kernel
```
